```python
import torch

def _softmax(x, axis=-1):
    return torch.softmax(x, dim=axis)
def _gelu(x):
    return torch.nn.functional.gelu(x, approximate="tanh")
def _silu(x):
    return torch.nn.functional.silu(x)
def _sigmoid(x):
    return torch.sigmoid(x)
def _layernorm(x, axis=-1, eps=1e-5):
    m = x.mean(dim=axis, keepdim=True)
    v = x.var(dim=axis, keepdim=True, unbiased=False)
    return (x - m) / torch.sqrt(v + eps)
def _scatter_add(tgt, idx, src, axis=0):
    return tgt.clone().index_add_(axis, idx, src)
def _segment_sum(src, seg, n):
    out = torch.zeros((n,) + src.shape[1:], dtype=src.dtype)
    return out.index_add_(0, seg, src)
def _pad(x, pw):
    flat = tuple(v for pair in reversed(pw) for v in pair)
    return torch.nn.functional.pad(x, flat)

kernel_name = 'gated_mix__mha_block__ssm_conv_s5__prompt'

def setup_inputs():

    _w = (lambda a: (lambda t: t.to(torch.bfloat16) if t.is_floating_point() else t)(torch.as_tensor(a)))
    def _A_setup():
        B, S, D, H = 1, 2048, 576, 32
        return {
            "x": _w((lambda *s: torch.randn(*s, dtype=torch.bfloat16) * 0.05)(B, S, D)),
            "wqkv": _w((lambda *s: torch.randn(*s, dtype=torch.bfloat16) * 0.8)(D, 3 * D)),
            "wo": _w((lambda *s: torch.randn(*s, dtype=torch.bfloat16) * 0.05)(D, D)),
        }
    _A_in = _A_setup()

    def _B_setup():
        B, S, D = 1, 2048, 576
        P = D
        Lambda_re = -0.5 * (lambda _x: torch.exp(torch.as_tensor(_x)))((lambda *s: torch.randn(*s, dtype=torch.bfloat16) * 0.4)(P))
        Lambda_im = (lambda *s: torch.randn(*s, dtype=torch.bfloat16) * 0.8)(P) * 1.0
        B_re = (lambda *s: torch.randn(*s, dtype=torch.bfloat16) * 0.8)(P, D) * (D ** -0.5)
        B_im = (lambda *s: torch.randn(*s, dtype=torch.bfloat16) * 0.8)(P, D) * (D ** -0.5)
        C_re = (lambda *s: torch.randn(*s, dtype=torch.bfloat16) * 0.8)(D, P) * (P ** -0.5)
        C_im = (lambda *s: torch.randn(*s, dtype=torch.bfloat16) * 0.8)(D, P) * (P ** -0.5)
        log_dt = (lambda *s: torch.randn(*s, dtype=torch.bfloat16) * 0.4)(P) * 0.3 - 2.0
        Dskip = (lambda *s: torch.randn(*s, dtype=torch.bfloat16) * 0.1)(D)
        return {
            "x": _w((lambda *s: torch.randn(*s, dtype=torch.bfloat16) * 0.05)(B, S, D)),
            "Lambda_re": _w(Lambda_re),
            "Lambda_im": _w(Lambda_im),
            "B_re": _w(B_re),
            "B_im": _w(B_im),
            "C_re": _w(C_re),
            "C_im": _w(C_im),
            "log_dt": _w(log_dt),
            "Dskip": _w(Dskip),
        }
    _B_in = _B_setup()

    return {
        "A_x": _A_in["x"],
        "A_wqkv": _A_in["wqkv"],
        "A_wo": _A_in["wo"],
        "B_x": _B_in["x"],
        "B_Lambda_re": _B_in["Lambda_re"],
        "B_Lambda_im": _B_in["Lambda_im"],
        "B_B_re": _B_in["B_re"],
        "B_B_im": _B_in["B_im"],
        "B_C_re": _B_in["C_re"],
        "B_C_im": _B_in["C_im"],
        "B_log_dt": _B_in["log_dt"],
        "B_Dskip": _B_in["Dskip"],
        "gate_w": _w((lambda *s: torch.randn(*s, dtype=torch.bfloat16) * 0.05)(576) * 16.0),
    }

def reference(A_x, A_wqkv, A_wo, B_x, B_Lambda_re, B_Lambda_im, B_B_re, B_B_im, B_C_re, B_C_im, B_log_dt, B_Dskip, gate_w):
    def _A_ref(x, wqkv, wo):
        B, S, D = x.shape
        H = 32
        Dh = D // H
        qkv = (lambda x, *d: x.permute(*d))((x @ wqkv).reshape(B, S, 3, H, Dh), 2, 0, 3, 1, 4)
        q, k, v = qkv[0], qkv[1], qkv[2]
        scores = torch.einsum("bhqd,bhkd->bhqk", q, k) * (Dh ** -0.5)
        p = _softmax(scores, axis=-1)
        o = torch.einsum("bhqk,bhkd->bhqd", p, v)
        return (lambda x, *d: x.permute(*d))(o, 0, 2, 1, 3).reshape(B, S, D) @ wo

    def _B_ref(x, Lambda_re, Lambda_im, B_re, B_im, C_re, C_im, log_dt, Dskip):
        Bsz, L, H = x.shape
        Lam = Lambda_re + 1j * Lambda_im
        Bmat = B_re + 1j * B_im
        Cmat = C_re + 1j * C_im
        dt = torch.exp(log_dt)
        Lam_bar = torch.exp(dt * Lam)
        B_bar = ((Lam_bar - 1.0) / Lam)[:, None] * Bmat
        Bu = torch.einsum("bld,pd->blp", x + 0j, B_bar)
        h = torch.zeros_like(Bu[:, 0, :])
        hs = []
        for t in range(L):
            h = Lam_bar[None, :] * h + Bu[:, t, :]
            hs.append(h)
        hseq = torch.stack(hs, 1)
        y = 2.0 * torch.einsum("blp,dp->bld", hseq, Cmat).real + x * Dskip[None, None, :]
        return y

    x = A_x
    g = _sigmoid((x * gate_w).sum(-1, keepdims=True))
    a = _A_ref(x, A_wqkv, A_wo)
    b = _B_ref(x, B_Lambda_re, B_Lambda_im, B_B_re, B_B_im, B_C_re, B_C_im, B_log_dt, B_Dskip)
    return g * a + (1 - g) * b
```

```asm
; @launch grid=(256,1,1) block=(768,1,1) lds=163840
.amdgcn_target "amdgcn-amd-amdhsa--gfx950"
.text
.globl gated_mix__mha_block__ssm_conv_s5__prompt_kernel
.p2align 8
.type gated_mix__mha_block__ssm_conv_s5__prompt_kernel,@function
gated_mix__mha_block__ssm_conv_s5__prompt_kernel:
    s_cmp_ge_u32 s2, 256
    s_cbranch_scc1 the_end
    s_load_dwordx2 s[8:9], s[0:1], 0
    s_mov_b32 s10, 2359296
    s_mov_b32 s11, 0x20000
    v_lshrrev_b32 v2, 6, v0
    v_and_b32 v1, 63, v0
    v_readfirstlane_b32 s3, v2
    s_load_dwordx2 s[4:5], s[0:1], 120
    s_mov_b32 s6, 33554432
    s_mov_b32 s7, 0x20000
    s_load_dwordx2 s[64:65], s[0:1], 104
    s_mov_b32 s66, 4718592
    s_mov_b32 s67, 0x20000
    s_lshl_b32 s24, s2, 4
    s_or_b32 s24, s24, s3
    s_cmp_lg_u32 s24, 9
    s_cbranch_scc1 p1_start
    s_load_dwordx2 s[20:21], s[0:1], 112
    s_mov_b32 s22, 256
    s_mov_b32 s23, 0x20000
    v_lshlrev_b32 v2, 8, v1
    v_mov_b32 v3, 0
    s_mov_b32 s24, 17465344
    s_waitcnt lgkmcnt(0)
    buffer_store_dword v3, v2, s[4:7], s24 offen sc1
    s_add_u32 s24, s24, 16384
    buffer_store_dword v3, v2, s[4:7], s24 offen sc1
    s_add_u32 s24, s24, 16384
    buffer_store_dword v3, v2, s[4:7], s24 offen sc1
    v_mov_b32 v2, 1
    s_mov_b64 exec, 1
    s_waitcnt vmcnt(0)
    buffer_store_dword v2, v3, s[20:23], 0 offen sc1
    s_mov_b64 exec, -1
    s_mov_b32 s6, 33554432
p1_start:
    s_load_dwordx2 s[12:13], s[0:1], 8
    s_mov_b32 s14, 1990656
    s_mov_b32 s15, 0x20000
    s_cmp_ge_u32 s3, 4
    s_cbranch_scc1 p1_nopf
    s_lshl_b32 s24, s2, 2
    s_add_u32 s24, s24, s3
    s_mul_i32 s25, s24, 2304
    s_lshl_b32 s24, s24, 11
    v_lshlrev_b32 v164, 7, v1
    s_mov_b64 exec, 0x3ffff
    s_waitcnt lgkmcnt(0)
    buffer_load_dword v165, v164, s[8:11], s25 offen
    s_mov_b64 exec, 0xffff
    buffer_load_dword v166, v164, s[12:15], s24 offen
    s_mov_b64 exec, -1
p1_nopf:
    s_and_b32 s24, s2, 3
    s_bfe_u32 s25, s2, 0x20003
    s_lshl_b32 s16, s24, 2
    s_add_u32 s16, s16, s25
    s_bfe_u32 s24, s2, 0x10002
    s_lshr_b32 s26, s2, 5
    s_mul_i32 s17, s24, 7
    s_add_u32 s17, s17, s26
    s_lshl_b32 s18, s16, 1
    s_add_u32 s18, s18, s24
    s_mov_b32 s23, s26
    s_mul_i32 s19, s23, 9
    s_add_u32 s19, s19, 1
    s_and_b32 s20, s19, 1
    s_lshr_b32 s19, s19, 1
    s_cmp_eq_u32 s26, 7
    s_cbranch_scc1 p1_aux
    s_cmp_ge_u32 s3, 4
    s_cbranch_scc1 p1_nl
    s_and_b32 s24, s3, 1
    s_lshr_b32 s25, s3, 1
    s_lshl_b32 s26, s25, 3
    s_add_u32 s26, s26, 48
    s_load_dwordx2 s[48:49], s[0:1], s26
    s_mov_b32 s50, 663552
    s_mov_b32 s51, 0x20000
    v_lshrrev_b32 v3, 3, v1
    v_and_b32 v4, 7, v1
    v_lshrrev_b32 v2, 4, v1
    s_lshl_b32 s26, s24, 2
    v_xor_b32 v2, s26, v2
    v_xor_b32 v2, v2, v4
    v_lshlrev_b32 v2, 4, v2
    s_lshl_b32 s26, s24, 5
    s_lshl_b32 s27, s25, 2
    s_add_u32 s26, s26, s27
    v_lshrrev_b32 v5, 5, v1
    v_and_b32 v6, 3, v3
    v_lshl_add_u32 v5, v5, 4, v6
    v_add_u32 v5, s26, v5
    v_mul_u32_u24 v5, 1152, v5
    s_lshl_b32 s26, s25, 6
    v_xor_b32 v6, s26, v2
    v_add_u32 v8, v5, v6
    s_mul_i32 s52, s18, 73728
    s_xor_b32 s53, s18, 1
    s_mul_i32 s53, s53, 73728
    s_lshl_b32 s44, s3, 10
    v_mov_b32 v12, 0
    s_setprio 3
    v_bfe_u32 v7, v1, 4, 1
    v_lshlrev_b32 v7, 1, v7
    s_lshl_b32 s26, s24, 2
    v_or_b32 v7, s26, v7
    v_xor_b32 v7, v7, v4
    v_lshlrev_b32 v7, 4, v7
    v_mul_u32_u24 v5, 3456, v3
    s_mul_i32 s26, s3, 27648
    s_lshl_b32 s27, s17, 8
    s_add_u32 s27, s27, s26
    v_add3_u32 v9, v5, v7, s27
    s_waitcnt lgkmcnt(0)
    s_add_u32 m0, s44, 73728
    s_mov_b32 s29, 0
    buffer_load_dwordx4 v9, s[12:15], s29 offen lds
    s_add_u32 m0, s44, 0
    s_add_u32 s29, s52, 0
    buffer_load_dwordx4 v8, s[8:11], s29 offen lds
    s_add_u32 m0, s44, 81920
    s_mov_b32 s29, 128
    buffer_load_dwordx4 v9, s[12:15], s29 offen lds
    s_add_u32 m0, s44, 139264
    s_add_u32 s29, s53, 0
    buffer_load_dwordx4 v8, s[8:11], s29 offen lds
    s_add_u32 m0, s44, 4096
    s_add_u32 s29, s52, 9216
    buffer_load_dwordx4 v8, s[8:11], s29 offen lds
    s_add_u32 m0, s44, 143360
    s_add_u32 s29, s53, 9216
    buffer_load_dwordx4 v8, s[8:11], s29 offen lds
    s_add_u32 m0, s44, 77824
    s_mov_b32 s29, 110592
    buffer_load_dwordx4 v9, s[12:15], s29 offen lds
    s_add_u32 m0, s44, 86016
    s_mov_b32 s29, 110720
    buffer_load_dwordx4 v9, s[12:15], s29 offen lds
    s_add_u32 m0, s44, 90112
    s_mov_b32 s29, 221184
    buffer_load_dwordx4 v9, s[12:15], s29 offen lds
    s_add_u32 m0, s44, 8192
    s_add_u32 s29, s52, 128
    buffer_load_dwordx4 v8, s[8:11], s29 offen lds
    s_add_u32 m0, s44, 98304
    s_mov_b32 s29, 221312
    buffer_load_dwordx4 v9, s[12:15], s29 offen lds
    s_add_u32 m0, s44, 147456
    s_add_u32 s29, s53, 128
    buffer_load_dwordx4 v8, s[8:11], s29 offen lds
    s_add_u32 m0, s44, 12288
    s_add_u32 s29, s52, 9344
    buffer_load_dwordx4 v8, s[8:11], s29 offen lds
    s_add_u32 m0, s44, 151552
    s_add_u32 s29, s53, 9344
    buffer_load_dwordx4 v8, s[8:11], s29 offen lds
    s_add_u32 m0, s44, 94208
    s_mov_b32 s29, 331776
    buffer_load_dwordx4 v9, s[12:15], s29 offen lds
    s_add_u32 m0, s44, 102400
    s_mov_b32 s29, 331904
    buffer_load_dwordx4 v9, s[12:15], s29 offen lds
    s_lshl_b32 s27, s19, 4
    s_lshl_b32 s26, s24, 3
    s_add_u32 s27, s27, s26
    s_mul_i32 s27, s27, 1152
    v_mul_u32_u24 v5, 1152, v3
    v_add3_u32 v11, v5, v2, s27
    s_waitcnt vmcnt(8)
    s_barrier
    s_add_u32 m0, s44, 106496
    s_mov_b32 s29, 442368
    buffer_load_dwordx4 v9, s[12:15], s29 offen lds
    s_add_u32 m0, s44, 16384
    s_add_u32 s29, s52, 256
    buffer_load_dwordx4 v8, s[8:11], s29 offen lds
    s_add_u32 m0, s44, 114688
    s_mov_b32 s29, 442496
    buffer_load_dwordx4 v9, s[12:15], s29 offen lds
    s_add_u32 m0, s44, 155648
    s_add_u32 s29, s53, 256
    buffer_load_dwordx4 v8, s[8:11], s29 offen lds
    s_add_u32 m0, s44, 20480
    s_add_u32 s29, s52, 9472
    buffer_load_dwordx4 v8, s[8:11], s29 offen lds
    s_add_u32 m0, s44, 159744
    s_add_u32 s29, s53, 9472
    buffer_load_dwordx4 v8, s[8:11], s29 offen lds
    s_add_u32 m0, s44, 110592
    s_mov_b32 s29, 552960
    buffer_load_dwordx4 v9, s[12:15], s29 offen lds
    s_add_u32 m0, s44, 118784
    s_mov_b32 s29, 553088
    buffer_load_dwordx4 v9, s[12:15], s29 offen lds
    s_waitcnt vmcnt(8)
    s_barrier
    s_add_u32 m0, s44, 122880
    s_mov_b32 s29, 663552
    buffer_load_dwordx4 v9, s[12:15], s29 offen lds
    s_add_u32 m0, s44, 24576
    s_add_u32 s29, s52, 384
    buffer_load_dwordx4 v8, s[8:11], s29 offen lds
    s_add_u32 m0, s44, 131072
    s_mov_b32 s29, 663680
    buffer_load_dwordx4 v9, s[12:15], s29 offen lds
    s_add_u32 m0, s44, 139264
    s_add_u32 s29, s53, 384
    buffer_load_dwordx4 v8, s[8:11], s29 offen lds
    s_add_u32 m0, s44, 28672
    s_add_u32 s29, s52, 9600
    buffer_load_dwordx4 v8, s[8:11], s29 offen lds
    s_add_u32 m0, s44, 143360
    s_add_u32 s29, s53, 9600
    buffer_load_dwordx4 v8, s[8:11], s29 offen lds
    s_add_u32 m0, s44, 126976
    s_mov_b32 s29, 774144
    buffer_load_dwordx4 v9, s[12:15], s29 offen lds
    s_add_u32 m0, s44, 135168
    s_mov_b32 s29, 774272
    buffer_load_dwordx4 v9, s[12:15], s29 offen lds
    s_waitcnt vmcnt(8)
    s_barrier
    s_add_u32 m0, s44, 73728
    s_mov_b32 s29, 884736
    buffer_load_dwordx4 v9, s[12:15], s29 offen lds
    s_add_u32 m0, s44, 32768
    s_add_u32 s29, s52, 512
    buffer_load_dwordx4 v8, s[8:11], s29 offen lds
    s_add_u32 m0, s44, 81920
    s_mov_b32 s29, 884864
    buffer_load_dwordx4 v9, s[12:15], s29 offen lds
    s_add_u32 m0, s44, 147456
    s_add_u32 s29, s53, 512
    buffer_load_dwordx4 v8, s[8:11], s29 offen lds
    s_add_u32 m0, s44, 36864
    s_add_u32 s29, s52, 9728
    buffer_load_dwordx4 v8, s[8:11], s29 offen lds
    s_add_u32 m0, s44, 151552
    s_add_u32 s29, s53, 9728
    buffer_load_dwordx4 v8, s[8:11], s29 offen lds
    s_add_u32 m0, s44, 77824
    s_mov_b32 s29, 995328
    buffer_load_dwordx4 v9, s[12:15], s29 offen lds
    s_add_u32 m0, s44, 86016
    s_mov_b32 s29, 995456
    buffer_load_dwordx4 v9, s[12:15], s29 offen lds
    s_waitcnt vmcnt(8)
    s_barrier
    s_add_u32 m0, s44, 90112
    s_mov_b32 s29, 1105920
    buffer_load_dwordx4 v9, s[12:15], s29 offen lds
    s_add_u32 m0, s44, 40960
    s_add_u32 s29, s52, 640
    buffer_load_dwordx4 v8, s[8:11], s29 offen lds
    s_add_u32 m0, s44, 98304
    s_mov_b32 s29, 1106048
    buffer_load_dwordx4 v9, s[12:15], s29 offen lds
    s_add_u32 m0, s44, 155648
    s_add_u32 s29, s53, 640
    buffer_load_dwordx4 v8, s[8:11], s29 offen lds
    s_add_u32 m0, s44, 45056
    s_add_u32 s29, s52, 9856
    buffer_load_dwordx4 v8, s[8:11], s29 offen lds
    s_add_u32 m0, s44, 159744
    s_add_u32 s29, s53, 9856
    buffer_load_dwordx4 v8, s[8:11], s29 offen lds
    s_add_u32 m0, s44, 94208
    s_mov_b32 s29, 1216512
    buffer_load_dwordx4 v9, s[12:15], s29 offen lds
    s_add_u32 m0, s44, 102400
    s_mov_b32 s29, 1216640
    buffer_load_dwordx4 v9, s[12:15], s29 offen lds
    s_waitcnt vmcnt(8)
    s_barrier
    s_add_u32 m0, s44, 106496
    s_mov_b32 s29, 1327104
    buffer_load_dwordx4 v9, s[12:15], s29 offen lds
    s_add_u32 m0, s44, 49152
    s_add_u32 s29, s52, 768
    buffer_load_dwordx4 v8, s[8:11], s29 offen lds
    s_add_u32 m0, s44, 114688
    s_mov_b32 s29, 1327232
    buffer_load_dwordx4 v9, s[12:15], s29 offen lds
    s_add_u32 m0, s44, 139264
    s_add_u32 s29, s53, 768
    buffer_load_dwordx4 v8, s[8:11], s29 offen lds
    s_add_u32 m0, s44, 53248
    s_add_u32 s29, s52, 9984
    buffer_load_dwordx4 v8, s[8:11], s29 offen lds
    s_add_u32 m0, s44, 143360
    s_add_u32 s29, s53, 9984
    buffer_load_dwordx4 v8, s[8:11], s29 offen lds
    s_add_u32 m0, s44, 110592
    s_mov_b32 s29, 1437696
    buffer_load_dwordx4 v9, s[12:15], s29 offen lds
    s_add_u32 m0, s44, 118784
    s_mov_b32 s29, 1437824
    buffer_load_dwordx4 v9, s[12:15], s29 offen lds
    s_waitcnt vmcnt(8)
    s_barrier
    s_add_u32 m0, s44, 122880
    s_mov_b32 s29, 1548288
    buffer_load_dwordx4 v9, s[12:15], s29 offen lds
    s_add_u32 m0, s44, 57344
    s_add_u32 s29, s52, 896
    buffer_load_dwordx4 v8, s[8:11], s29 offen lds
    s_add_u32 m0, s44, 131072
    s_mov_b32 s29, 1548416
    buffer_load_dwordx4 v9, s[12:15], s29 offen lds
    s_add_u32 m0, s44, 147456
    s_add_u32 s29, s53, 896
    buffer_load_dwordx4 v8, s[8:11], s29 offen lds
    s_add_u32 m0, s44, 61440
    s_add_u32 s29, s52, 10112
    buffer_load_dwordx4 v8, s[8:11], s29 offen lds
    s_add_u32 m0, s44, 151552
    s_add_u32 s29, s53, 10112
    buffer_load_dwordx4 v8, s[8:11], s29 offen lds
    s_add_u32 m0, s44, 126976
    s_mov_b32 s29, 1658880
    buffer_load_dwordx4 v9, s[12:15], s29 offen lds
    s_add_u32 m0, s44, 135168
    s_mov_b32 s29, 1659008
    buffer_load_dwordx4 v9, s[12:15], s29 offen lds
    s_waitcnt vmcnt(8)
    s_barrier
    s_add_u32 m0, s44, 73728
    s_mov_b32 s29, 1769472
    buffer_load_dwordx4 v9, s[12:15], s29 offen lds
    s_add_u32 m0, s44, 65536
    s_add_u32 s29, s52, 1024
    buffer_load_dwordx4 v8, s[8:11], s29 offen lds
    s_add_u32 m0, s44, 81920
    s_mov_b32 s29, 1769600
    buffer_load_dwordx4 v9, s[12:15], s29 offen lds
    s_add_u32 m0, s44, 155648
    s_add_u32 s29, s53, 1024
    buffer_load_dwordx4 v8, s[8:11], s29 offen lds
    s_add_u32 m0, s44, 69632
    s_add_u32 s29, s52, 10240
    buffer_load_dwordx4 v8, s[8:11], s29 offen lds
    s_add_u32 m0, s44, 159744
    s_add_u32 s29, s53, 10240
    buffer_load_dwordx4 v8, s[8:11], s29 offen lds
    s_add_u32 m0, s44, 77824
    s_mov_b32 s29, 1880064
    buffer_load_dwordx4 v9, s[12:15], s29 offen lds
    s_add_u32 m0, s44, 86016
    s_mov_b32 s29, 1880192
    buffer_load_dwordx4 v9, s[12:15], s29 offen lds
    s_waitcnt vmcnt(8)
    s_barrier
    s_waitcnt vmcnt(0)
    s_barrier
    s_cmp_eq_u32 s20, 0
    s_cbranch_scc1 p1_no5_9
    s_add_u32 m0, s44, 110592
    s_mov_b32 s29, 73728
    buffer_load_dwordx4 v11, s[48:51], s29 offen lds
    s_branch p1_has5_9
p1_no5_9:
    buffer_load_dword v13, v12, s[8:11], 0 offen
p1_has5_9:
    s_add_u32 m0, s44, 94208
    s_mov_b32 s29, 0
    buffer_load_dwordx4 v11, s[48:51], s29 offen lds
    s_add_u32 m0, s44, 98304
    s_mov_b32 s29, 18432
    buffer_load_dwordx4 v11, s[48:51], s29 offen lds
    s_add_u32 m0, s44, 102400
    s_mov_b32 s29, 36864
    buffer_load_dwordx4 v11, s[48:51], s29 offen lds
    s_add_u32 m0, s44, 106496
    s_mov_b32 s29, 55296
    buffer_load_dwordx4 v11, s[48:51], s29 offen lds
p1_ld_b:
    s_waitcnt vmcnt(0)
    s_barrier
    s_cmp_eq_u32 s20, 0
    s_cbranch_scc1 p1_no5_10
    s_add_u32 m0, s44, 131072
    s_mov_b32 s29, 73856
    buffer_load_dwordx4 v11, s[48:51], s29 offen lds
    s_branch p1_has5_10
p1_no5_10:
    buffer_load_dword v13, v12, s[8:11], 0 offen
p1_has5_10:
    s_add_u32 m0, s44, 114688
    s_mov_b32 s29, 128
    buffer_load_dwordx4 v11, s[48:51], s29 offen lds
    s_add_u32 m0, s44, 118784
    s_mov_b32 s29, 18560
    buffer_load_dwordx4 v11, s[48:51], s29 offen lds
    s_add_u32 m0, s44, 122880
    s_mov_b32 s29, 36992
    buffer_load_dwordx4 v11, s[48:51], s29 offen lds
    s_add_u32 m0, s44, 126976
    s_mov_b32 s29, 55424
    buffer_load_dwordx4 v11, s[48:51], s29 offen lds
    s_cmp_eq_u32 s20, 0
    s_cbranch_scc1 p1_no5_11
    s_add_u32 m0, s44, 151552
    s_mov_b32 s29, 73984
    buffer_load_dwordx4 v11, s[48:51], s29 offen lds
    s_branch p1_has5_11
p1_no5_11:
    buffer_load_dword v13, v12, s[8:11], 0 offen
p1_has5_11:
    s_add_u32 m0, s44, 135168
    s_mov_b32 s29, 256
    buffer_load_dwordx4 v11, s[48:51], s29 offen lds
    s_add_u32 m0, s44, 139264
    s_mov_b32 s29, 18688
    buffer_load_dwordx4 v11, s[48:51], s29 offen lds
    s_add_u32 m0, s44, 143360
    s_mov_b32 s29, 37120
    buffer_load_dwordx4 v11, s[48:51], s29 offen lds
    s_add_u32 m0, s44, 147456
    s_mov_b32 s29, 55552
    buffer_load_dwordx4 v11, s[48:51], s29 offen lds
    s_waitcnt vmcnt(5)
    s_barrier
    s_cmp_eq_u32 s20, 0
    s_cbranch_scc1 p1_no5_12
    s_add_u32 m0, s44, 90112
    s_mov_b32 s29, 74112
    buffer_load_dwordx4 v11, s[48:51], s29 offen lds
    s_branch p1_has5_12
p1_no5_12:
    buffer_load_dword v13, v12, s[8:11], 0 offen
p1_has5_12:
    s_add_u32 m0, s44, 73728
    s_mov_b32 s29, 384
    buffer_load_dwordx4 v11, s[48:51], s29 offen lds
    s_add_u32 m0, s44, 77824
    s_mov_b32 s29, 18816
    buffer_load_dwordx4 v11, s[48:51], s29 offen lds
    s_add_u32 m0, s44, 81920
    s_mov_b32 s29, 37248
    buffer_load_dwordx4 v11, s[48:51], s29 offen lds
    s_add_u32 m0, s44, 86016
    s_mov_b32 s29, 55680
    buffer_load_dwordx4 v11, s[48:51], s29 offen lds
    s_waitcnt vmcnt(5)
    s_barrier
    s_cmp_eq_u32 s20, 0
    s_cbranch_scc1 p1_no5_13
    s_add_u32 m0, s44, 110592
    s_mov_b32 s29, 74240
    buffer_load_dwordx4 v11, s[48:51], s29 offen lds
    s_branch p1_has5_13
p1_no5_13:
    buffer_load_dword v13, v12, s[8:11], 0 offen
p1_has5_13:
    s_add_u32 m0, s44, 94208
    s_mov_b32 s29, 512
    buffer_load_dwordx4 v11, s[48:51], s29 offen lds
    s_add_u32 m0, s44, 98304
    s_mov_b32 s29, 18944
    buffer_load_dwordx4 v11, s[48:51], s29 offen lds
    s_add_u32 m0, s44, 102400
    s_mov_b32 s29, 37376
    buffer_load_dwordx4 v11, s[48:51], s29 offen lds
    s_add_u32 m0, s44, 106496
    s_mov_b32 s29, 55808
    buffer_load_dwordx4 v11, s[48:51], s29 offen lds
    s_waitcnt vmcnt(5)
    s_barrier
    s_cmp_eq_u32 s20, 0
    s_cbranch_scc1 p1_no5_14
    s_add_u32 m0, s44, 131072
    s_mov_b32 s29, 74368
    buffer_load_dwordx4 v11, s[48:51], s29 offen lds
    s_branch p1_has5_14
p1_no5_14:
    buffer_load_dword v13, v12, s[8:11], 0 offen
p1_has5_14:
    s_add_u32 m0, s44, 114688
    s_mov_b32 s29, 640
    buffer_load_dwordx4 v11, s[48:51], s29 offen lds
    s_add_u32 m0, s44, 118784
    s_mov_b32 s29, 19072
    buffer_load_dwordx4 v11, s[48:51], s29 offen lds
    s_add_u32 m0, s44, 122880
    s_mov_b32 s29, 37504
    buffer_load_dwordx4 v11, s[48:51], s29 offen lds
    s_add_u32 m0, s44, 126976
    s_mov_b32 s29, 55936
    buffer_load_dwordx4 v11, s[48:51], s29 offen lds
    s_waitcnt vmcnt(5)
    s_barrier
    s_cmp_eq_u32 s20, 0
    s_cbranch_scc1 p1_no5_15
    s_add_u32 m0, s44, 151552
    s_mov_b32 s29, 74496
    buffer_load_dwordx4 v11, s[48:51], s29 offen lds
    s_branch p1_has5_15
p1_no5_15:
    buffer_load_dword v13, v12, s[8:11], 0 offen
p1_has5_15:
    s_add_u32 m0, s44, 135168
    s_mov_b32 s29, 768
    buffer_load_dwordx4 v11, s[48:51], s29 offen lds
    s_add_u32 m0, s44, 139264
    s_mov_b32 s29, 19200
    buffer_load_dwordx4 v11, s[48:51], s29 offen lds
    s_add_u32 m0, s44, 143360
    s_mov_b32 s29, 37632
    buffer_load_dwordx4 v11, s[48:51], s29 offen lds
    s_add_u32 m0, s44, 147456
    s_mov_b32 s29, 56064
    buffer_load_dwordx4 v11, s[48:51], s29 offen lds
    s_waitcnt vmcnt(5)
    s_barrier
    s_cmp_eq_u32 s20, 0
    s_cbranch_scc1 p1_no5_16
    s_add_u32 m0, s44, 90112
    s_mov_b32 s29, 74624
    buffer_load_dwordx4 v11, s[48:51], s29 offen lds
    s_branch p1_has5_16
p1_no5_16:
    buffer_load_dword v13, v12, s[8:11], 0 offen
p1_has5_16:
    s_add_u32 m0, s44, 73728
    s_mov_b32 s29, 896
    buffer_load_dwordx4 v11, s[48:51], s29 offen lds
    s_add_u32 m0, s44, 77824
    s_mov_b32 s29, 19328
    buffer_load_dwordx4 v11, s[48:51], s29 offen lds
    s_add_u32 m0, s44, 81920
    s_mov_b32 s29, 37760
    buffer_load_dwordx4 v11, s[48:51], s29 offen lds
    s_add_u32 m0, s44, 86016
    s_mov_b32 s29, 56192
    buffer_load_dwordx4 v11, s[48:51], s29 offen lds
    s_waitcnt vmcnt(5)
    s_barrier
    s_cmp_eq_u32 s20, 0
    s_cbranch_scc1 p1_no5_17
    s_add_u32 m0, s44, 110592
    s_mov_b32 s29, 74752
    buffer_load_dwordx4 v11, s[48:51], s29 offen lds
    s_branch p1_has5_17
p1_no5_17:
    buffer_load_dword v13, v12, s[8:11], 0 offen
p1_has5_17:
    s_add_u32 m0, s44, 94208
    s_mov_b32 s29, 1024
    buffer_load_dwordx4 v11, s[48:51], s29 offen lds
    s_add_u32 m0, s44, 98304
    s_mov_b32 s29, 19456
    buffer_load_dwordx4 v11, s[48:51], s29 offen lds
    s_add_u32 m0, s44, 102400
    s_mov_b32 s29, 37888
    buffer_load_dwordx4 v11, s[48:51], s29 offen lds
    s_add_u32 m0, s44, 106496
    s_mov_b32 s29, 56320
    buffer_load_dwordx4 v11, s[48:51], s29 offen lds
    s_waitcnt vmcnt(5)
    s_barrier
    s_waitcnt vmcnt(0)
    s_barrier
    s_setprio 0
    s_branch p1_done
p1_nl:
    s_cmp_ge_u32 s3, 8
    s_cbranch_scc1 p1_h
    s_bfe_u32 s45, s3, 0x10001
    s_and_b32 s46, s3, 1
    s_lshl_b32 s47, s17, 1
    s_add_u32 s47, s47, s46
    s_cmp_eq_u32 s47, 27
    s_cbranch_scc1 p1_w_idle
    v_and_b32 v12, 15, v1
    v_lshrrev_b32 v13, 4, v1
    v_bfe_u32 v14, v1, 2, 1
    v_bfe_u32 v15, v1, 3, 1
    v_and_b32 v16, 3, v1
    v_lshl_add_u32 v16, v15, 2, v16
    v_lshrrev_b32 v17, 1, v16
    v_lshl_add_u32 v17, v14, 2, v17
    v_lshl_add_u32 v16, v14, 4, v16
    v_xor_b32 v17, v17, v13
    v_lshlrev_b32 v17, 4, v17
    v_lshl_add_u32 v16, v16, 7, v17
    s_and_b32 s24, s18, 1
    s_cmp_eq_u32 s24, s45
    s_cselect_b32 s24, 0, 139264
    s_movk_i32 s25, 8192
    s_cselect_b32 s54, s25, 4294950912
    v_add_u32 v2, s24, v16
    v_xor_b32 v3, 64, v2
    v_bfe_u32 v15, v1, 2, 2
    v_lshl_add_u32 v16, v13, 3, v15
    v_lshlrev_b32 v16, 7, v16
    v_and_b32 v17, 3, v1
    v_lshl_add_u32 v16, v17, 3, v16
    v_lshrrev_b32 v15, 1, v15
    v_and_b32 v17, 1, v13
    v_lshl_add_u32 v15, v17, 1, v15
    v_lshl_add_u32 v16, v15, 5, v16
    s_lshl_b32 s25, s46, 13
    s_add_u32 s25, s25, 73728
    v_xor_b32 v17, 0, v16
    v_add_u32 v4, s25, v17
    v_xor_b32 v17, 32, v16
    v_add_u32 v5, s25, v17
    v_xor_b32 v17, 64, v16
    v_add_u32 v6, s25, v17
    v_xor_b32 v17, 96, v16
    v_add_u32 v7, s25, v17
    s_mul_i32 s51, s47, 57
    s_lshr_b32 s51, s51, 9
    s_cmp_eq_u32 s51, 0
    s_cselect_b32 s52, 0x3eae1a93, 1.0
    s_mov_b32 s53, s52
    s_cmp_eq_u32 s51, 2
    s_movk_i32 s27, 9216
    s_cselect_b32 s48, 9344, s27
    s_mul_i32 s49, s51, 2359296
    s_lshl_b32 s25, s16, 4
    s_lshl_b32 s26, s45, 3
    s_add_u32 s25, s25, s26
    s_mul_i32 s25, s25, s48
    s_add_u32 s49, s49, s25
    s_lshl_b32 s26, s48, 2
    s_add_u32 s50, s49, s26
    s_mul_i32 s25, s51, 9
    s_sub_u32 s25, s47, s25
    s_lshl_b32 s25, s25, 10
    v_mul_u32_u24 v15, s48, v13
    v_lshl_add_u32 v15, v12, 4, v15
    v_add_u32 v8, s25, v15
    s_waitcnt lgkmcnt(0)
    s_barrier
    ds_read_b64_tr_b16 v[44:45], v4 offset:0
    ds_read_b64_tr_b16 v[46:47], v4 offset:512
    ds_read_b128 v[12:15], v2 offset:0
    ds_read_b128 v[16:19], v2 offset:4096
    ds_read_b128 v[20:23], v3 offset:1024
    ds_read_b128 v[24:27], v3 offset:5120
    ds_read_b64_tr_b16 v[48:49], v5 offset:0
    ds_read_b64_tr_b16 v[50:51], v5 offset:512
    ds_read_b64_tr_b16 v[52:53], v6 offset:0
    ds_read_b64_tr_b16 v[54:55], v6 offset:512
    ds_read_b64_tr_b16 v[56:57], v7 offset:0
    ds_read_b64_tr_b16 v[58:59], v7 offset:512
    s_waitcnt lgkmcnt(9)
    v_mfma_f32_16x16x32_bf16 v[60:63], v[12:15], v[44:47], 0
    ds_read_b128 v[28:31], v3 offset:0
    s_waitcnt lgkmcnt(9)
    v_mfma_f32_16x16x32_bf16 v[64:67], v[16:19], v[44:47], 0
    ds_read_b128 v[32:35], v3 offset:4096
    s_waitcnt lgkmcnt(9)
    v_mfma_f32_16x16x32_bf16 v[68:71], v[20:23], v[44:47], 0
    ds_read_b128 v[36:39], v2 offset:1024
    s_waitcnt lgkmcnt(9)
    v_mfma_f32_16x16x32_bf16 v[72:75], v[24:27], v[44:47], 0
    ds_read_b64_tr_b16 v[44:45], v4 offset:4096
    s_waitcnt lgkmcnt(8)
    v_mfma_f32_16x16x32_bf16 v[76:79], v[12:15], v[48:51], 0
    ds_read_b64_tr_b16 v[46:47], v4 offset:4608
    v_mfma_f32_16x16x32_bf16 v[80:83], v[16:19], v[48:51], 0
    ds_read_b128 v[40:43], v2 offset:5120
    v_mfma_f32_16x16x32_bf16 v[84:87], v[20:23], v[48:51], 0
    v_mfma_f32_16x16x32_bf16 v[88:91], v[24:27], v[48:51], 0
    ds_read_b64_tr_b16 v[48:49], v5 offset:4096
    s_waitcnt lgkmcnt(9)
    v_mfma_f32_16x16x32_bf16 v[92:95], v[12:15], v[52:55], 0
    ds_read_b64_tr_b16 v[50:51], v5 offset:4608
    v_mfma_f32_16x16x32_bf16 v[96:99], v[16:19], v[52:55], 0
    v_mfma_f32_16x16x32_bf16 v[100:103], v[20:23], v[52:55], 0
    v_mfma_f32_16x16x32_bf16 v[104:107], v[24:27], v[52:55], 0
    ds_read_b64_tr_b16 v[52:53], v6 offset:4096
    s_waitcnt lgkmcnt(9)
    v_mfma_f32_16x16x32_bf16 v[108:111], v[12:15], v[56:59], 0
    ds_read_b64_tr_b16 v[54:55], v6 offset:4608
    v_mfma_f32_16x16x32_bf16 v[112:115], v[16:19], v[56:59], 0
    v_mfma_f32_16x16x32_bf16 v[116:119], v[20:23], v[56:59], 0
    v_mfma_f32_16x16x32_bf16 v[120:123], v[24:27], v[56:59], 0
    ds_read_b64_tr_b16 v[56:57], v7 offset:4096
    ds_read_b64_tr_b16 v[58:59], v7 offset:4608
    s_waitcnt lgkmcnt(4)
    v_mfma_f32_16x16x32_bf16 v[60:63], v[28:31], v[44:47], v[60:63]
    s_barrier
    v_mfma_f32_16x16x32_bf16 v[64:67], v[32:35], v[44:47], v[64:67]
    v_add_u32 v2, 8192, v2
    ds_read_b128 v[12:15], v2 offset:0
    v_mfma_f32_16x16x32_bf16 v[68:71], v[36:39], v[44:47], v[68:71]
    ds_read_b128 v[16:19], v2 offset:4096
    v_mfma_f32_16x16x32_bf16 v[72:75], v[40:43], v[44:47], v[72:75]
    v_add_u32 v4, 16384, v4
    ds_read_b64_tr_b16 v[44:45], v4 offset:0
    v_mfma_f32_16x16x32_bf16 v[76:79], v[28:31], v[48:51], v[76:79]
    ds_read_b64_tr_b16 v[46:47], v4 offset:512
    v_mfma_f32_16x16x32_bf16 v[80:83], v[32:35], v[48:51], v[80:83]
    v_add_u32 v3, 8192, v3
    ds_read_b128 v[20:23], v3 offset:1024
    v_mfma_f32_16x16x32_bf16 v[84:87], v[36:39], v[48:51], v[84:87]
    ds_read_b128 v[24:27], v3 offset:5120
    v_mfma_f32_16x16x32_bf16 v[88:91], v[40:43], v[48:51], v[88:91]
    v_add_u32 v5, 16384, v5
    ds_read_b64_tr_b16 v[48:49], v5 offset:0
    s_waitcnt lgkmcnt(7)
    v_mfma_f32_16x16x32_bf16 v[92:95], v[28:31], v[52:55], v[92:95]
    ds_read_b64_tr_b16 v[50:51], v5 offset:512
    v_mfma_f32_16x16x32_bf16 v[96:99], v[32:35], v[52:55], v[96:99]
    v_mfma_f32_16x16x32_bf16 v[100:103], v[36:39], v[52:55], v[100:103]
    v_mfma_f32_16x16x32_bf16 v[104:107], v[40:43], v[52:55], v[104:107]
    v_add_u32 v6, 16384, v6
    ds_read_b64_tr_b16 v[52:53], v6 offset:0
    v_mfma_f32_16x16x32_bf16 v[108:111], v[28:31], v[56:59], v[108:111]
    ds_read_b64_tr_b16 v[54:55], v6 offset:512
    v_mfma_f32_16x16x32_bf16 v[112:115], v[32:35], v[56:59], v[112:115]
    v_mfma_f32_16x16x32_bf16 v[116:119], v[36:39], v[56:59], v[116:119]
    v_mfma_f32_16x16x32_bf16 v[120:123], v[40:43], v[56:59], v[120:123]
    v_add_u32 v7, 16384, v7
    ds_read_b64_tr_b16 v[56:57], v7 offset:0
    ds_read_b64_tr_b16 v[58:59], v7 offset:512
    s_waitcnt lgkmcnt(4)
    v_mfma_f32_16x16x32_bf16 v[60:63], v[12:15], v[44:47], v[60:63]
    ds_read_b128 v[28:31], v3 offset:0
    v_mfma_f32_16x16x32_bf16 v[64:67], v[16:19], v[44:47], v[64:67]
    ds_read_b128 v[32:35], v3 offset:4096
    v_mfma_f32_16x16x32_bf16 v[68:71], v[20:23], v[44:47], v[68:71]
    ds_read_b128 v[36:39], v2 offset:1024
    v_mfma_f32_16x16x32_bf16 v[72:75], v[24:27], v[44:47], v[72:75]
    ds_read_b64_tr_b16 v[44:45], v4 offset:4096
    v_mfma_f32_16x16x32_bf16 v[76:79], v[12:15], v[48:51], v[76:79]
    ds_read_b64_tr_b16 v[46:47], v4 offset:4608
    v_mfma_f32_16x16x32_bf16 v[80:83], v[16:19], v[48:51], v[80:83]
    ds_read_b128 v[40:43], v2 offset:5120
    v_mfma_f32_16x16x32_bf16 v[84:87], v[20:23], v[48:51], v[84:87]
    v_mfma_f32_16x16x32_bf16 v[88:91], v[24:27], v[48:51], v[88:91]
    ds_read_b64_tr_b16 v[48:49], v5 offset:4096
    s_waitcnt lgkmcnt(7)
    v_mfma_f32_16x16x32_bf16 v[92:95], v[12:15], v[52:55], v[92:95]
    ds_read_b64_tr_b16 v[50:51], v5 offset:4608
    v_mfma_f32_16x16x32_bf16 v[96:99], v[16:19], v[52:55], v[96:99]
    v_mfma_f32_16x16x32_bf16 v[100:103], v[20:23], v[52:55], v[100:103]
    v_mfma_f32_16x16x32_bf16 v[104:107], v[24:27], v[52:55], v[104:107]
    ds_read_b64_tr_b16 v[52:53], v6 offset:4096
    v_mfma_f32_16x16x32_bf16 v[108:111], v[12:15], v[56:59], v[108:111]
    ds_read_b64_tr_b16 v[54:55], v6 offset:4608
    v_mfma_f32_16x16x32_bf16 v[112:115], v[16:19], v[56:59], v[112:115]
    v_mfma_f32_16x16x32_bf16 v[116:119], v[20:23], v[56:59], v[116:119]
    v_mfma_f32_16x16x32_bf16 v[120:123], v[24:27], v[56:59], v[120:123]
    ds_read_b64_tr_b16 v[56:57], v7 offset:4096
    ds_read_b64_tr_b16 v[58:59], v7 offset:4608
    s_waitcnt lgkmcnt(4)
    v_mfma_f32_16x16x32_bf16 v[60:63], v[28:31], v[44:47], v[60:63]
    s_barrier
    v_mfma_f32_16x16x32_bf16 v[64:67], v[32:35], v[44:47], v[64:67]
    v_add_u32 v2, 8192, v2
    ds_read_b128 v[12:15], v2 offset:0
    v_mfma_f32_16x16x32_bf16 v[68:71], v[36:39], v[44:47], v[68:71]
    ds_read_b128 v[16:19], v2 offset:4096
    v_mfma_f32_16x16x32_bf16 v[72:75], v[40:43], v[44:47], v[72:75]
    v_add_u32 v4, 16384, v4
    ds_read_b64_tr_b16 v[44:45], v4 offset:0
    v_mfma_f32_16x16x32_bf16 v[76:79], v[28:31], v[48:51], v[76:79]
    ds_read_b64_tr_b16 v[46:47], v4 offset:512
    v_mfma_f32_16x16x32_bf16 v[80:83], v[32:35], v[48:51], v[80:83]
    v_add_u32 v3, 8192, v3
    ds_read_b128 v[20:23], v3 offset:1024
    v_mfma_f32_16x16x32_bf16 v[84:87], v[36:39], v[48:51], v[84:87]
    ds_read_b128 v[24:27], v3 offset:5120
    v_mfma_f32_16x16x32_bf16 v[88:91], v[40:43], v[48:51], v[88:91]
    v_add_u32 v5, 16384, v5
    ds_read_b64_tr_b16 v[48:49], v5 offset:0
    s_waitcnt lgkmcnt(7)
    v_mfma_f32_16x16x32_bf16 v[92:95], v[28:31], v[52:55], v[92:95]
    ds_read_b64_tr_b16 v[50:51], v5 offset:512
    v_mfma_f32_16x16x32_bf16 v[96:99], v[32:35], v[52:55], v[96:99]
    v_mfma_f32_16x16x32_bf16 v[100:103], v[36:39], v[52:55], v[100:103]
    v_mfma_f32_16x16x32_bf16 v[104:107], v[40:43], v[52:55], v[104:107]
    v_add_u32 v6, 16384, v6
    ds_read_b64_tr_b16 v[52:53], v6 offset:0
    v_mfma_f32_16x16x32_bf16 v[108:111], v[28:31], v[56:59], v[108:111]
    ds_read_b64_tr_b16 v[54:55], v6 offset:512
    v_mfma_f32_16x16x32_bf16 v[112:115], v[32:35], v[56:59], v[112:115]
    v_mfma_f32_16x16x32_bf16 v[116:119], v[36:39], v[56:59], v[116:119]
    v_mfma_f32_16x16x32_bf16 v[120:123], v[40:43], v[56:59], v[120:123]
    v_add_u32 v7, 16384, v7
    ds_read_b64_tr_b16 v[56:57], v7 offset:0
    ds_read_b64_tr_b16 v[58:59], v7 offset:512
    s_waitcnt lgkmcnt(4)
    v_mfma_f32_16x16x32_bf16 v[60:63], v[12:15], v[44:47], v[60:63]
    ds_read_b128 v[28:31], v3 offset:0
    v_mfma_f32_16x16x32_bf16 v[64:67], v[16:19], v[44:47], v[64:67]
    ds_read_b128 v[32:35], v3 offset:4096
    v_mfma_f32_16x16x32_bf16 v[68:71], v[20:23], v[44:47], v[68:71]
    ds_read_b128 v[36:39], v2 offset:1024
    v_mfma_f32_16x16x32_bf16 v[72:75], v[24:27], v[44:47], v[72:75]
    ds_read_b64_tr_b16 v[44:45], v4 offset:4096
    v_mfma_f32_16x16x32_bf16 v[76:79], v[12:15], v[48:51], v[76:79]
    ds_read_b64_tr_b16 v[46:47], v4 offset:4608
    v_mfma_f32_16x16x32_bf16 v[80:83], v[16:19], v[48:51], v[80:83]
    ds_read_b128 v[40:43], v2 offset:5120
    v_mfma_f32_16x16x32_bf16 v[84:87], v[20:23], v[48:51], v[84:87]
    v_mfma_f32_16x16x32_bf16 v[88:91], v[24:27], v[48:51], v[88:91]
    ds_read_b64_tr_b16 v[48:49], v5 offset:4096
    s_waitcnt lgkmcnt(7)
    v_mfma_f32_16x16x32_bf16 v[92:95], v[12:15], v[52:55], v[92:95]
    ds_read_b64_tr_b16 v[50:51], v5 offset:4608
    v_mfma_f32_16x16x32_bf16 v[96:99], v[16:19], v[52:55], v[96:99]
    v_mfma_f32_16x16x32_bf16 v[100:103], v[20:23], v[52:55], v[100:103]
    v_mfma_f32_16x16x32_bf16 v[104:107], v[24:27], v[52:55], v[104:107]
    ds_read_b64_tr_b16 v[52:53], v6 offset:4096
    v_mfma_f32_16x16x32_bf16 v[108:111], v[12:15], v[56:59], v[108:111]
    ds_read_b64_tr_b16 v[54:55], v6 offset:4608
    v_mfma_f32_16x16x32_bf16 v[112:115], v[16:19], v[56:59], v[112:115]
    v_mfma_f32_16x16x32_bf16 v[116:119], v[20:23], v[56:59], v[116:119]
    v_mfma_f32_16x16x32_bf16 v[120:123], v[24:27], v[56:59], v[120:123]
    ds_read_b64_tr_b16 v[56:57], v7 offset:4096
    ds_read_b64_tr_b16 v[58:59], v7 offset:4608
    s_waitcnt lgkmcnt(4)
    v_mfma_f32_16x16x32_bf16 v[60:63], v[28:31], v[44:47], v[60:63]
    s_barrier
    v_mfma_f32_16x16x32_bf16 v[64:67], v[32:35], v[44:47], v[64:67]
    v_add_u32 v2, s54, v2
    ds_read_b128 v[12:15], v2 offset:0
    v_mfma_f32_16x16x32_bf16 v[68:71], v[36:39], v[44:47], v[68:71]
    ds_read_b128 v[16:19], v2 offset:4096
    v_mfma_f32_16x16x32_bf16 v[72:75], v[40:43], v[44:47], v[72:75]
    v_add_u32 v4, 16384, v4
    ds_read_b64_tr_b16 v[44:45], v4 offset:0
    v_mfma_f32_16x16x32_bf16 v[76:79], v[28:31], v[48:51], v[76:79]
    ds_read_b64_tr_b16 v[46:47], v4 offset:512
    v_mfma_f32_16x16x32_bf16 v[80:83], v[32:35], v[48:51], v[80:83]
    v_add_u32 v3, s54, v3
    ds_read_b128 v[20:23], v3 offset:1024
    v_mfma_f32_16x16x32_bf16 v[84:87], v[36:39], v[48:51], v[84:87]
    ds_read_b128 v[24:27], v3 offset:5120
    v_mfma_f32_16x16x32_bf16 v[88:91], v[40:43], v[48:51], v[88:91]
    v_add_u32 v5, 16384, v5
    ds_read_b64_tr_b16 v[48:49], v5 offset:0
    s_waitcnt lgkmcnt(7)
    v_mfma_f32_16x16x32_bf16 v[92:95], v[28:31], v[52:55], v[92:95]
    ds_read_b64_tr_b16 v[50:51], v5 offset:512
    v_mfma_f32_16x16x32_bf16 v[96:99], v[32:35], v[52:55], v[96:99]
    v_mfma_f32_16x16x32_bf16 v[100:103], v[36:39], v[52:55], v[100:103]
    v_mfma_f32_16x16x32_bf16 v[104:107], v[40:43], v[52:55], v[104:107]
    v_add_u32 v6, 16384, v6
    ds_read_b64_tr_b16 v[52:53], v6 offset:0
    v_mfma_f32_16x16x32_bf16 v[108:111], v[28:31], v[56:59], v[108:111]
    ds_read_b64_tr_b16 v[54:55], v6 offset:512
    v_mfma_f32_16x16x32_bf16 v[112:115], v[32:35], v[56:59], v[112:115]
    v_mfma_f32_16x16x32_bf16 v[116:119], v[36:39], v[56:59], v[116:119]
    v_mfma_f32_16x16x32_bf16 v[120:123], v[40:43], v[56:59], v[120:123]
    v_add_u32 v7, 16384, v7
    ds_read_b64_tr_b16 v[56:57], v7 offset:0
    ds_read_b64_tr_b16 v[58:59], v7 offset:512
    s_waitcnt lgkmcnt(4)
    v_mfma_f32_16x16x32_bf16 v[60:63], v[12:15], v[44:47], v[60:63]
    ds_read_b128 v[28:31], v3 offset:0
    v_mfma_f32_16x16x32_bf16 v[64:67], v[16:19], v[44:47], v[64:67]
    ds_read_b128 v[32:35], v3 offset:4096
    v_mfma_f32_16x16x32_bf16 v[68:71], v[20:23], v[44:47], v[68:71]
    ds_read_b128 v[36:39], v2 offset:1024
    v_mfma_f32_16x16x32_bf16 v[72:75], v[24:27], v[44:47], v[72:75]
    ds_read_b64_tr_b16 v[44:45], v4 offset:4096
    v_mfma_f32_16x16x32_bf16 v[76:79], v[12:15], v[48:51], v[76:79]
    ds_read_b64_tr_b16 v[46:47], v4 offset:4608
    v_mfma_f32_16x16x32_bf16 v[80:83], v[16:19], v[48:51], v[80:83]
    ds_read_b128 v[40:43], v2 offset:5120
    v_mfma_f32_16x16x32_bf16 v[84:87], v[20:23], v[48:51], v[84:87]
    v_mfma_f32_16x16x32_bf16 v[88:91], v[24:27], v[48:51], v[88:91]
    ds_read_b64_tr_b16 v[48:49], v5 offset:4096
    s_waitcnt lgkmcnt(7)
    v_mfma_f32_16x16x32_bf16 v[92:95], v[12:15], v[52:55], v[92:95]
    ds_read_b64_tr_b16 v[50:51], v5 offset:4608
    v_mfma_f32_16x16x32_bf16 v[96:99], v[16:19], v[52:55], v[96:99]
    v_mfma_f32_16x16x32_bf16 v[100:103], v[20:23], v[52:55], v[100:103]
    v_mfma_f32_16x16x32_bf16 v[104:107], v[24:27], v[52:55], v[104:107]
    ds_read_b64_tr_b16 v[52:53], v6 offset:4096
    v_mfma_f32_16x16x32_bf16 v[108:111], v[12:15], v[56:59], v[108:111]
    ds_read_b64_tr_b16 v[54:55], v6 offset:4608
    v_mfma_f32_16x16x32_bf16 v[112:115], v[16:19], v[56:59], v[112:115]
    v_mfma_f32_16x16x32_bf16 v[116:119], v[20:23], v[56:59], v[116:119]
    v_mfma_f32_16x16x32_bf16 v[120:123], v[24:27], v[56:59], v[120:123]
    ds_read_b64_tr_b16 v[56:57], v7 offset:4096
    ds_read_b64_tr_b16 v[58:59], v7 offset:4608
    s_waitcnt lgkmcnt(4)
    v_mfma_f32_16x16x32_bf16 v[60:63], v[28:31], v[44:47], v[60:63]
    s_barrier
    v_mfma_f32_16x16x32_bf16 v[64:67], v[32:35], v[44:47], v[64:67]
    v_add_u32 v2, 8192, v2
    ds_read_b128 v[12:15], v2 offset:0
    v_mfma_f32_16x16x32_bf16 v[68:71], v[36:39], v[44:47], v[68:71]
    ds_read_b128 v[16:19], v2 offset:4096
    v_mfma_f32_16x16x32_bf16 v[72:75], v[40:43], v[44:47], v[72:75]
    v_add_u32 v4, 4294918144, v4
    ds_read_b64_tr_b16 v[44:45], v4 offset:0
    v_mfma_f32_16x16x32_bf16 v[76:79], v[28:31], v[48:51], v[76:79]
    ds_read_b64_tr_b16 v[46:47], v4 offset:512
    v_mfma_f32_16x16x32_bf16 v[80:83], v[32:35], v[48:51], v[80:83]
    v_add_u32 v3, 8192, v3
    ds_read_b128 v[20:23], v3 offset:1024
    v_mfma_f32_16x16x32_bf16 v[84:87], v[36:39], v[48:51], v[84:87]
    ds_read_b128 v[24:27], v3 offset:5120
    v_mfma_f32_16x16x32_bf16 v[88:91], v[40:43], v[48:51], v[88:91]
    v_add_u32 v5, 4294918144, v5
    ds_read_b64_tr_b16 v[48:49], v5 offset:0
    s_waitcnt lgkmcnt(7)
    v_mfma_f32_16x16x32_bf16 v[92:95], v[28:31], v[52:55], v[92:95]
    ds_read_b64_tr_b16 v[50:51], v5 offset:512
    v_mfma_f32_16x16x32_bf16 v[96:99], v[32:35], v[52:55], v[96:99]
    v_mfma_f32_16x16x32_bf16 v[100:103], v[36:39], v[52:55], v[100:103]
    v_mfma_f32_16x16x32_bf16 v[104:107], v[40:43], v[52:55], v[104:107]
    v_add_u32 v6, 4294918144, v6
    ds_read_b64_tr_b16 v[52:53], v6 offset:0
    v_mfma_f32_16x16x32_bf16 v[108:111], v[28:31], v[56:59], v[108:111]
    ds_read_b64_tr_b16 v[54:55], v6 offset:512
    v_mfma_f32_16x16x32_bf16 v[112:115], v[32:35], v[56:59], v[112:115]
    v_mfma_f32_16x16x32_bf16 v[116:119], v[36:39], v[56:59], v[116:119]
    v_mfma_f32_16x16x32_bf16 v[120:123], v[40:43], v[56:59], v[120:123]
    v_add_u32 v7, 4294918144, v7
    ds_read_b64_tr_b16 v[56:57], v7 offset:0
    ds_read_b64_tr_b16 v[58:59], v7 offset:512
    s_waitcnt lgkmcnt(4)
    v_mfma_f32_16x16x32_bf16 v[60:63], v[12:15], v[44:47], v[60:63]
    ds_read_b128 v[28:31], v3 offset:0
    v_mfma_f32_16x16x32_bf16 v[64:67], v[16:19], v[44:47], v[64:67]
    ds_read_b128 v[32:35], v3 offset:4096
    v_mfma_f32_16x16x32_bf16 v[68:71], v[20:23], v[44:47], v[68:71]
    ds_read_b128 v[36:39], v2 offset:1024
    v_mfma_f32_16x16x32_bf16 v[72:75], v[24:27], v[44:47], v[72:75]
    ds_read_b64_tr_b16 v[44:45], v4 offset:4096
    v_mfma_f32_16x16x32_bf16 v[76:79], v[12:15], v[48:51], v[76:79]
    ds_read_b64_tr_b16 v[46:47], v4 offset:4608
    v_mfma_f32_16x16x32_bf16 v[80:83], v[16:19], v[48:51], v[80:83]
    ds_read_b128 v[40:43], v2 offset:5120
    v_mfma_f32_16x16x32_bf16 v[84:87], v[20:23], v[48:51], v[84:87]
    v_mfma_f32_16x16x32_bf16 v[88:91], v[24:27], v[48:51], v[88:91]
    ds_read_b64_tr_b16 v[48:49], v5 offset:4096
    s_waitcnt lgkmcnt(7)
    v_mfma_f32_16x16x32_bf16 v[92:95], v[12:15], v[52:55], v[92:95]
    ds_read_b64_tr_b16 v[50:51], v5 offset:4608
    v_mfma_f32_16x16x32_bf16 v[96:99], v[16:19], v[52:55], v[96:99]
    v_mfma_f32_16x16x32_bf16 v[100:103], v[20:23], v[52:55], v[100:103]
    v_mfma_f32_16x16x32_bf16 v[104:107], v[24:27], v[52:55], v[104:107]
    ds_read_b64_tr_b16 v[52:53], v6 offset:4096
    v_mfma_f32_16x16x32_bf16 v[108:111], v[12:15], v[56:59], v[108:111]
    ds_read_b64_tr_b16 v[54:55], v6 offset:4608
    v_mfma_f32_16x16x32_bf16 v[112:115], v[16:19], v[56:59], v[112:115]
    v_mfma_f32_16x16x32_bf16 v[116:119], v[20:23], v[56:59], v[116:119]
    v_mfma_f32_16x16x32_bf16 v[120:123], v[24:27], v[56:59], v[120:123]
    ds_read_b64_tr_b16 v[56:57], v7 offset:4096
    ds_read_b64_tr_b16 v[58:59], v7 offset:4608
    s_waitcnt lgkmcnt(4)
    v_mfma_f32_16x16x32_bf16 v[60:63], v[28:31], v[44:47], v[60:63]
    s_barrier
    v_mfma_f32_16x16x32_bf16 v[64:67], v[32:35], v[44:47], v[64:67]
    v_add_u32 v2, 8192, v2
    ds_read_b128 v[12:15], v2 offset:0
    v_mfma_f32_16x16x32_bf16 v[68:71], v[36:39], v[44:47], v[68:71]
    ds_read_b128 v[16:19], v2 offset:4096
    v_mfma_f32_16x16x32_bf16 v[72:75], v[40:43], v[44:47], v[72:75]
    v_add_u32 v4, 16384, v4
    ds_read_b64_tr_b16 v[44:45], v4 offset:0
    v_mfma_f32_16x16x32_bf16 v[76:79], v[28:31], v[48:51], v[76:79]
    ds_read_b64_tr_b16 v[46:47], v4 offset:512
    v_mfma_f32_16x16x32_bf16 v[80:83], v[32:35], v[48:51], v[80:83]
    v_add_u32 v3, 8192, v3
    ds_read_b128 v[20:23], v3 offset:1024
    v_mfma_f32_16x16x32_bf16 v[84:87], v[36:39], v[48:51], v[84:87]
    ds_read_b128 v[24:27], v3 offset:5120
    v_mfma_f32_16x16x32_bf16 v[88:91], v[40:43], v[48:51], v[88:91]
    v_add_u32 v5, 16384, v5
    ds_read_b64_tr_b16 v[48:49], v5 offset:0
    s_waitcnt lgkmcnt(7)
    v_mfma_f32_16x16x32_bf16 v[92:95], v[28:31], v[52:55], v[92:95]
    ds_read_b64_tr_b16 v[50:51], v5 offset:512
    v_mfma_f32_16x16x32_bf16 v[96:99], v[32:35], v[52:55], v[96:99]
    v_mfma_f32_16x16x32_bf16 v[100:103], v[36:39], v[52:55], v[100:103]
    v_mfma_f32_16x16x32_bf16 v[104:107], v[40:43], v[52:55], v[104:107]
    v_add_u32 v6, 16384, v6
    ds_read_b64_tr_b16 v[52:53], v6 offset:0
    v_mfma_f32_16x16x32_bf16 v[108:111], v[28:31], v[56:59], v[108:111]
    ds_read_b64_tr_b16 v[54:55], v6 offset:512
    v_mfma_f32_16x16x32_bf16 v[112:115], v[32:35], v[56:59], v[112:115]
    v_mfma_f32_16x16x32_bf16 v[116:119], v[36:39], v[56:59], v[116:119]
    v_mfma_f32_16x16x32_bf16 v[120:123], v[40:43], v[56:59], v[120:123]
    v_add_u32 v7, 16384, v7
    ds_read_b64_tr_b16 v[56:57], v7 offset:0
    ds_read_b64_tr_b16 v[58:59], v7 offset:512
    s_waitcnt lgkmcnt(4)
    v_mfma_f32_16x16x32_bf16 v[60:63], v[12:15], v[44:47], v[60:63]
    ds_read_b128 v[28:31], v3 offset:0
    v_mfma_f32_16x16x32_bf16 v[64:67], v[16:19], v[44:47], v[64:67]
    ds_read_b128 v[32:35], v3 offset:4096
    v_mfma_f32_16x16x32_bf16 v[68:71], v[20:23], v[44:47], v[68:71]
    ds_read_b128 v[36:39], v2 offset:1024
    v_mfma_f32_16x16x32_bf16 v[72:75], v[24:27], v[44:47], v[72:75]
    ds_read_b64_tr_b16 v[44:45], v4 offset:4096
    v_mfma_f32_16x16x32_bf16 v[76:79], v[12:15], v[48:51], v[76:79]
    ds_read_b64_tr_b16 v[46:47], v4 offset:4608
    v_mfma_f32_16x16x32_bf16 v[80:83], v[16:19], v[48:51], v[80:83]
    ds_read_b128 v[40:43], v2 offset:5120
    v_mfma_f32_16x16x32_bf16 v[84:87], v[20:23], v[48:51], v[84:87]
    v_mfma_f32_16x16x32_bf16 v[88:91], v[24:27], v[48:51], v[88:91]
    ds_read_b64_tr_b16 v[48:49], v5 offset:4096
    s_waitcnt lgkmcnt(7)
    v_mfma_f32_16x16x32_bf16 v[92:95], v[12:15], v[52:55], v[92:95]
    ds_read_b64_tr_b16 v[50:51], v5 offset:4608
    v_mfma_f32_16x16x32_bf16 v[96:99], v[16:19], v[52:55], v[96:99]
    v_mfma_f32_16x16x32_bf16 v[100:103], v[20:23], v[52:55], v[100:103]
    v_mfma_f32_16x16x32_bf16 v[104:107], v[24:27], v[52:55], v[104:107]
    ds_read_b64_tr_b16 v[52:53], v6 offset:4096
    v_mfma_f32_16x16x32_bf16 v[108:111], v[12:15], v[56:59], v[108:111]
    ds_read_b64_tr_b16 v[54:55], v6 offset:4608
    v_mfma_f32_16x16x32_bf16 v[112:115], v[16:19], v[56:59], v[112:115]
    v_mfma_f32_16x16x32_bf16 v[116:119], v[20:23], v[56:59], v[116:119]
    v_mfma_f32_16x16x32_bf16 v[120:123], v[24:27], v[56:59], v[120:123]
    ds_read_b64_tr_b16 v[56:57], v7 offset:4096
    ds_read_b64_tr_b16 v[58:59], v7 offset:4608
    s_waitcnt lgkmcnt(4)
    v_mfma_f32_16x16x32_bf16 v[60:63], v[28:31], v[44:47], v[60:63]
    s_barrier
    v_mfma_f32_16x16x32_bf16 v[64:67], v[32:35], v[44:47], v[64:67]
    v_add_u32 v2, s54, v2
    ds_read_b128 v[12:15], v2 offset:0
    v_mfma_f32_16x16x32_bf16 v[68:71], v[36:39], v[44:47], v[68:71]
    ds_read_b128 v[16:19], v2 offset:4096
    v_mfma_f32_16x16x32_bf16 v[72:75], v[40:43], v[44:47], v[72:75]
    v_add_u32 v4, 16384, v4
    ds_read_b64_tr_b16 v[44:45], v4 offset:0
    v_mfma_f32_16x16x32_bf16 v[76:79], v[28:31], v[48:51], v[76:79]
    ds_read_b64_tr_b16 v[46:47], v4 offset:512
    v_mfma_f32_16x16x32_bf16 v[80:83], v[32:35], v[48:51], v[80:83]
    v_add_u32 v3, s54, v3
    ds_read_b128 v[20:23], v3 offset:1024
    v_mfma_f32_16x16x32_bf16 v[84:87], v[36:39], v[48:51], v[84:87]
    ds_read_b128 v[24:27], v3 offset:5120
    v_mfma_f32_16x16x32_bf16 v[88:91], v[40:43], v[48:51], v[88:91]
    v_add_u32 v5, 16384, v5
    ds_read_b64_tr_b16 v[48:49], v5 offset:0
    s_waitcnt lgkmcnt(7)
    v_mfma_f32_16x16x32_bf16 v[92:95], v[28:31], v[52:55], v[92:95]
    ds_read_b64_tr_b16 v[50:51], v5 offset:512
    v_mfma_f32_16x16x32_bf16 v[96:99], v[32:35], v[52:55], v[96:99]
    v_mfma_f32_16x16x32_bf16 v[100:103], v[36:39], v[52:55], v[100:103]
    v_mfma_f32_16x16x32_bf16 v[104:107], v[40:43], v[52:55], v[104:107]
    v_add_u32 v6, 16384, v6
    ds_read_b64_tr_b16 v[52:53], v6 offset:0
    v_mfma_f32_16x16x32_bf16 v[108:111], v[28:31], v[56:59], v[108:111]
    ds_read_b64_tr_b16 v[54:55], v6 offset:512
    v_mfma_f32_16x16x32_bf16 v[112:115], v[32:35], v[56:59], v[112:115]
    v_mfma_f32_16x16x32_bf16 v[116:119], v[36:39], v[56:59], v[116:119]
    v_mfma_f32_16x16x32_bf16 v[120:123], v[40:43], v[56:59], v[120:123]
    v_add_u32 v7, 16384, v7
    ds_read_b64_tr_b16 v[56:57], v7 offset:0
    ds_read_b64_tr_b16 v[58:59], v7 offset:512
    s_waitcnt lgkmcnt(4)
    v_mfma_f32_16x16x32_bf16 v[60:63], v[12:15], v[44:47], v[60:63]
    ds_read_b128 v[28:31], v3 offset:0
    v_mfma_f32_16x16x32_bf16 v[64:67], v[16:19], v[44:47], v[64:67]
    ds_read_b128 v[32:35], v3 offset:4096
    v_mfma_f32_16x16x32_bf16 v[68:71], v[20:23], v[44:47], v[68:71]
    ds_read_b128 v[36:39], v2 offset:1024
    v_mfma_f32_16x16x32_bf16 v[72:75], v[24:27], v[44:47], v[72:75]
    ds_read_b64_tr_b16 v[44:45], v4 offset:4096
    v_mfma_f32_16x16x32_bf16 v[76:79], v[12:15], v[48:51], v[76:79]
    ds_read_b64_tr_b16 v[46:47], v4 offset:4608
    v_mfma_f32_16x16x32_bf16 v[80:83], v[16:19], v[48:51], v[80:83]
    ds_read_b128 v[40:43], v2 offset:5120
    v_mfma_f32_16x16x32_bf16 v[84:87], v[20:23], v[48:51], v[84:87]
    v_mfma_f32_16x16x32_bf16 v[88:91], v[24:27], v[48:51], v[88:91]
    ds_read_b64_tr_b16 v[48:49], v5 offset:4096
    s_waitcnt lgkmcnt(7)
    v_mfma_f32_16x16x32_bf16 v[92:95], v[12:15], v[52:55], v[92:95]
    ds_read_b64_tr_b16 v[50:51], v5 offset:4608
    v_mfma_f32_16x16x32_bf16 v[96:99], v[16:19], v[52:55], v[96:99]
    v_mfma_f32_16x16x32_bf16 v[100:103], v[20:23], v[52:55], v[100:103]
    v_mfma_f32_16x16x32_bf16 v[104:107], v[24:27], v[52:55], v[104:107]
    ds_read_b64_tr_b16 v[52:53], v6 offset:4096
    v_mfma_f32_16x16x32_bf16 v[108:111], v[12:15], v[56:59], v[108:111]
    ds_read_b64_tr_b16 v[54:55], v6 offset:4608
    v_mfma_f32_16x16x32_bf16 v[112:115], v[16:19], v[56:59], v[112:115]
    v_mfma_f32_16x16x32_bf16 v[116:119], v[20:23], v[56:59], v[116:119]
    v_mfma_f32_16x16x32_bf16 v[120:123], v[24:27], v[56:59], v[120:123]
    ds_read_b64_tr_b16 v[56:57], v7 offset:4096
    ds_read_b64_tr_b16 v[58:59], v7 offset:4608
    s_waitcnt lgkmcnt(4)
    v_mfma_f32_16x16x32_bf16 v[60:63], v[28:31], v[44:47], v[60:63]
    s_barrier
    v_mfma_f32_16x16x32_bf16 v[64:67], v[32:35], v[44:47], v[64:67]
    v_add_u32 v2, 8192, v2
    ds_read_b128 v[12:15], v2 offset:0
    v_mfma_f32_16x16x32_bf16 v[68:71], v[36:39], v[44:47], v[68:71]
    ds_read_b128 v[16:19], v2 offset:4096
    v_mfma_f32_16x16x32_bf16 v[72:75], v[40:43], v[44:47], v[72:75]
    v_add_u32 v4, 16384, v4
    ds_read_b64_tr_b16 v[44:45], v4 offset:0
    v_mfma_f32_16x16x32_bf16 v[76:79], v[28:31], v[48:51], v[76:79]
    ds_read_b64_tr_b16 v[46:47], v4 offset:512
    v_mfma_f32_16x16x32_bf16 v[80:83], v[32:35], v[48:51], v[80:83]
    v_add_u32 v3, 8192, v3
    ds_read_b128 v[20:23], v3 offset:1024
    v_mfma_f32_16x16x32_bf16 v[84:87], v[36:39], v[48:51], v[84:87]
    ds_read_b128 v[24:27], v3 offset:5120
    v_mfma_f32_16x16x32_bf16 v[88:91], v[40:43], v[48:51], v[88:91]
    v_add_u32 v5, 16384, v5
    ds_read_b64_tr_b16 v[48:49], v5 offset:0
    s_waitcnt lgkmcnt(7)
    v_mfma_f32_16x16x32_bf16 v[92:95], v[28:31], v[52:55], v[92:95]
    ds_read_b64_tr_b16 v[50:51], v5 offset:512
    v_mfma_f32_16x16x32_bf16 v[96:99], v[32:35], v[52:55], v[96:99]
    v_mfma_f32_16x16x32_bf16 v[100:103], v[36:39], v[52:55], v[100:103]
    v_mfma_f32_16x16x32_bf16 v[104:107], v[40:43], v[52:55], v[104:107]
    v_add_u32 v6, 16384, v6
    ds_read_b64_tr_b16 v[52:53], v6 offset:0
    v_mfma_f32_16x16x32_bf16 v[108:111], v[28:31], v[56:59], v[108:111]
    ds_read_b64_tr_b16 v[54:55], v6 offset:512
    v_mfma_f32_16x16x32_bf16 v[112:115], v[32:35], v[56:59], v[112:115]
    v_mfma_f32_16x16x32_bf16 v[116:119], v[36:39], v[56:59], v[116:119]
    v_mfma_f32_16x16x32_bf16 v[120:123], v[40:43], v[56:59], v[120:123]
    v_add_u32 v7, 16384, v7
    ds_read_b64_tr_b16 v[56:57], v7 offset:0
    ds_read_b64_tr_b16 v[58:59], v7 offset:512
    s_waitcnt lgkmcnt(4)
    v_mfma_f32_16x16x32_bf16 v[60:63], v[12:15], v[44:47], v[60:63]
    ds_read_b128 v[28:31], v3 offset:0
    v_mfma_f32_16x16x32_bf16 v[64:67], v[16:19], v[44:47], v[64:67]
    ds_read_b128 v[32:35], v3 offset:4096
    v_mfma_f32_16x16x32_bf16 v[68:71], v[20:23], v[44:47], v[68:71]
    ds_read_b128 v[36:39], v2 offset:1024
    v_mfma_f32_16x16x32_bf16 v[72:75], v[24:27], v[44:47], v[72:75]
    ds_read_b64_tr_b16 v[44:45], v4 offset:4096
    v_mfma_f32_16x16x32_bf16 v[76:79], v[12:15], v[48:51], v[76:79]
    ds_read_b64_tr_b16 v[46:47], v4 offset:4608
    v_mfma_f32_16x16x32_bf16 v[80:83], v[16:19], v[48:51], v[80:83]
    ds_read_b128 v[40:43], v2 offset:5120
    v_mfma_f32_16x16x32_bf16 v[84:87], v[20:23], v[48:51], v[84:87]
    v_mfma_f32_16x16x32_bf16 v[88:91], v[24:27], v[48:51], v[88:91]
    ds_read_b64_tr_b16 v[48:49], v5 offset:4096
    s_waitcnt lgkmcnt(7)
    v_mfma_f32_16x16x32_bf16 v[92:95], v[12:15], v[52:55], v[92:95]
    ds_read_b64_tr_b16 v[50:51], v5 offset:4608
    v_mfma_f32_16x16x32_bf16 v[96:99], v[16:19], v[52:55], v[96:99]
    v_mfma_f32_16x16x32_bf16 v[100:103], v[20:23], v[52:55], v[100:103]
    v_mfma_f32_16x16x32_bf16 v[104:107], v[24:27], v[52:55], v[104:107]
    ds_read_b64_tr_b16 v[52:53], v6 offset:4096
    v_mfma_f32_16x16x32_bf16 v[108:111], v[12:15], v[56:59], v[108:111]
    ds_read_b64_tr_b16 v[54:55], v6 offset:4608
    v_mfma_f32_16x16x32_bf16 v[112:115], v[16:19], v[56:59], v[112:115]
    v_mfma_f32_16x16x32_bf16 v[116:119], v[20:23], v[56:59], v[116:119]
    v_mfma_f32_16x16x32_bf16 v[120:123], v[24:27], v[56:59], v[120:123]
    ds_read_b64_tr_b16 v[56:57], v7 offset:4096
    ds_read_b64_tr_b16 v[58:59], v7 offset:4608
    s_waitcnt lgkmcnt(4)
    v_mfma_f32_16x16x32_bf16 v[60:63], v[28:31], v[44:47], v[60:63]
    s_barrier
    v_mfma_f32_16x16x32_bf16 v[64:67], v[32:35], v[44:47], v[64:67]
    v_add_u32 v2, 8192, v2
    ds_read_b128 v[12:15], v2 offset:0
    v_mfma_f32_16x16x32_bf16 v[68:71], v[36:39], v[44:47], v[68:71]
    ds_read_b128 v[16:19], v2 offset:4096
    v_mfma_f32_16x16x32_bf16 v[72:75], v[40:43], v[44:47], v[72:75]
    v_add_u32 v4, 4294918144, v4
    ds_read_b64_tr_b16 v[44:45], v4 offset:0
    v_mfma_f32_16x16x32_bf16 v[76:79], v[28:31], v[48:51], v[76:79]
    ds_read_b64_tr_b16 v[46:47], v4 offset:512
    v_mfma_f32_16x16x32_bf16 v[80:83], v[32:35], v[48:51], v[80:83]
    v_add_u32 v3, 8192, v3
    ds_read_b128 v[20:23], v3 offset:1024
    v_mfma_f32_16x16x32_bf16 v[84:87], v[36:39], v[48:51], v[84:87]
    ds_read_b128 v[24:27], v3 offset:5120
    v_mfma_f32_16x16x32_bf16 v[88:91], v[40:43], v[48:51], v[88:91]
    v_add_u32 v5, 4294918144, v5
    ds_read_b64_tr_b16 v[48:49], v5 offset:0
    s_waitcnt lgkmcnt(7)
    v_mfma_f32_16x16x32_bf16 v[92:95], v[28:31], v[52:55], v[92:95]
    ds_read_b64_tr_b16 v[50:51], v5 offset:512
    v_mfma_f32_16x16x32_bf16 v[96:99], v[32:35], v[52:55], v[96:99]
    v_mfma_f32_16x16x32_bf16 v[100:103], v[36:39], v[52:55], v[100:103]
    v_mfma_f32_16x16x32_bf16 v[104:107], v[40:43], v[52:55], v[104:107]
    v_add_u32 v6, 4294918144, v6
    ds_read_b64_tr_b16 v[52:53], v6 offset:0
    v_mfma_f32_16x16x32_bf16 v[108:111], v[28:31], v[56:59], v[108:111]
    ds_read_b64_tr_b16 v[54:55], v6 offset:512
    v_mfma_f32_16x16x32_bf16 v[112:115], v[32:35], v[56:59], v[112:115]
    v_mfma_f32_16x16x32_bf16 v[116:119], v[36:39], v[56:59], v[116:119]
    v_mfma_f32_16x16x32_bf16 v[120:123], v[40:43], v[56:59], v[120:123]
    v_add_u32 v7, 4294918144, v7
    ds_read_b64_tr_b16 v[56:57], v7 offset:0
    ds_read_b64_tr_b16 v[58:59], v7 offset:512
    s_waitcnt lgkmcnt(4)
    v_mfma_f32_16x16x32_bf16 v[60:63], v[12:15], v[44:47], v[60:63]
    ds_read_b128 v[28:31], v3 offset:0
    v_mfma_f32_16x16x32_bf16 v[64:67], v[16:19], v[44:47], v[64:67]
    ds_read_b128 v[32:35], v3 offset:4096
    v_mfma_f32_16x16x32_bf16 v[68:71], v[20:23], v[44:47], v[68:71]
    ds_read_b128 v[36:39], v2 offset:1024
    v_mfma_f32_16x16x32_bf16 v[72:75], v[24:27], v[44:47], v[72:75]
    ds_read_b64_tr_b16 v[44:45], v4 offset:4096
    v_mfma_f32_16x16x32_bf16 v[76:79], v[12:15], v[48:51], v[76:79]
    ds_read_b64_tr_b16 v[46:47], v4 offset:4608
    v_mfma_f32_16x16x32_bf16 v[80:83], v[16:19], v[48:51], v[80:83]
    ds_read_b128 v[40:43], v2 offset:5120
    v_mfma_f32_16x16x32_bf16 v[84:87], v[20:23], v[48:51], v[84:87]
    v_mfma_f32_16x16x32_bf16 v[88:91], v[24:27], v[48:51], v[88:91]
    ds_read_b64_tr_b16 v[48:49], v5 offset:4096
    s_waitcnt lgkmcnt(7)
    v_mfma_f32_16x16x32_bf16 v[92:95], v[12:15], v[52:55], v[92:95]
    ds_read_b64_tr_b16 v[50:51], v5 offset:4608
    v_mfma_f32_16x16x32_bf16 v[96:99], v[16:19], v[52:55], v[96:99]
    v_mfma_f32_16x16x32_bf16 v[100:103], v[20:23], v[52:55], v[100:103]
    v_mfma_f32_16x16x32_bf16 v[104:107], v[24:27], v[52:55], v[104:107]
    ds_read_b64_tr_b16 v[52:53], v6 offset:4096
    v_mfma_f32_16x16x32_bf16 v[108:111], v[12:15], v[56:59], v[108:111]
    ds_read_b64_tr_b16 v[54:55], v6 offset:4608
    v_mfma_f32_16x16x32_bf16 v[112:115], v[16:19], v[56:59], v[112:115]
    v_mfma_f32_16x16x32_bf16 v[116:119], v[20:23], v[56:59], v[116:119]
    v_mfma_f32_16x16x32_bf16 v[120:123], v[24:27], v[56:59], v[120:123]
    ds_read_b64_tr_b16 v[56:57], v7 offset:4096
    ds_read_b64_tr_b16 v[58:59], v7 offset:4608
    s_waitcnt lgkmcnt(4)
    v_mfma_f32_16x16x32_bf16 v[60:63], v[28:31], v[44:47], v[60:63]
    v_mfma_f32_16x16x32_bf16 v[64:67], v[32:35], v[44:47], v[64:67]
    v_mfma_f32_16x16x32_bf16 v[68:71], v[36:39], v[44:47], v[68:71]
    v_mfma_f32_16x16x32_bf16 v[72:75], v[40:43], v[44:47], v[72:75]
    v_mfma_f32_16x16x32_bf16 v[76:79], v[28:31], v[48:51], v[76:79]
    v_mfma_f32_16x16x32_bf16 v[80:83], v[32:35], v[48:51], v[80:83]
    v_mfma_f32_16x16x32_bf16 v[84:87], v[36:39], v[48:51], v[84:87]
    v_mfma_f32_16x16x32_bf16 v[88:91], v[40:43], v[48:51], v[88:91]
    s_waitcnt lgkmcnt(0)
    v_mfma_f32_16x16x32_bf16 v[92:95], v[28:31], v[52:55], v[92:95]
    v_mfma_f32_16x16x32_bf16 v[96:99], v[32:35], v[52:55], v[96:99]
    v_mfma_f32_16x16x32_bf16 v[100:103], v[36:39], v[52:55], v[100:103]
    v_mfma_f32_16x16x32_bf16 v[104:107], v[40:43], v[52:55], v[104:107]
    v_mfma_f32_16x16x32_bf16 v[108:111], v[28:31], v[56:59], v[108:111]
    v_mfma_f32_16x16x32_bf16 v[112:115], v[32:35], v[56:59], v[112:115]
    v_mfma_f32_16x16x32_bf16 v[116:119], v[36:39], v[56:59], v[116:119]
    v_mfma_f32_16x16x32_bf16 v[120:123], v[40:43], v[56:59], v[120:123]
    v_pk_mul_f32 v[60:61], v[60:61], s[52:53]
    v_pk_mul_f32 v[62:63], v[62:63], s[52:53]
    v_pk_mul_f32 v[64:65], v[64:65], s[52:53]
    v_pk_mul_f32 v[66:67], v[66:67], s[52:53]
    v_pk_mul_f32 v[68:69], v[68:69], s[52:53]
    v_pk_mul_f32 v[70:71], v[70:71], s[52:53]
    v_pk_mul_f32 v[72:73], v[72:73], s[52:53]
    v_pk_mul_f32 v[74:75], v[74:75], s[52:53]
    v_cvt_pk_bf16_f32 v12, v60, v61
    v_cvt_pk_bf16_f32 v13, v62, v63
    v_cvt_pk_bf16_f32 v14, v64, v65
    v_cvt_pk_bf16_f32 v15, v66, v67
    buffer_store_dwordx4 v[12:15], v8, s[4:7], s49 offen offset:0 sc1
    v_cvt_pk_bf16_f32 v16, v68, v69
    v_cvt_pk_bf16_f32 v17, v70, v71
    v_cvt_pk_bf16_f32 v18, v72, v73
    v_cvt_pk_bf16_f32 v19, v74, v75
    buffer_store_dwordx4 v[16:19], v8, s[4:7], s50 offen offset:0 sc1
    v_pk_mul_f32 v[76:77], v[76:77], s[52:53]
    v_pk_mul_f32 v[78:79], v[78:79], s[52:53]
    v_pk_mul_f32 v[80:81], v[80:81], s[52:53]
    v_pk_mul_f32 v[82:83], v[82:83], s[52:53]
    v_pk_mul_f32 v[84:85], v[84:85], s[52:53]
    v_pk_mul_f32 v[86:87], v[86:87], s[52:53]
    v_pk_mul_f32 v[88:89], v[88:89], s[52:53]
    v_pk_mul_f32 v[90:91], v[90:91], s[52:53]
    v_cvt_pk_bf16_f32 v20, v76, v77
    v_cvt_pk_bf16_f32 v21, v78, v79
    v_cvt_pk_bf16_f32 v22, v80, v81
    v_cvt_pk_bf16_f32 v23, v82, v83
    buffer_store_dwordx4 v[20:23], v8, s[4:7], s49 offen offset:256 sc1
    v_cvt_pk_bf16_f32 v24, v84, v85
    v_cvt_pk_bf16_f32 v25, v86, v87
    v_cvt_pk_bf16_f32 v26, v88, v89
    v_cvt_pk_bf16_f32 v27, v90, v91
    buffer_store_dwordx4 v[24:27], v8, s[4:7], s50 offen offset:256 sc1
    s_barrier
    v_mov_b32 v4, 160896
    v_mov_b32 v5, 0
    ds_write_b32 v4, v5
    v_pk_mul_f32 v[92:93], v[92:93], s[52:53]
    v_pk_mul_f32 v[94:95], v[94:95], s[52:53]
    v_pk_mul_f32 v[96:97], v[96:97], s[52:53]
    v_pk_mul_f32 v[98:99], v[98:99], s[52:53]
    v_pk_mul_f32 v[100:101], v[100:101], s[52:53]
    v_pk_mul_f32 v[102:103], v[102:103], s[52:53]
    v_pk_mul_f32 v[104:105], v[104:105], s[52:53]
    v_pk_mul_f32 v[106:107], v[106:107], s[52:53]
    v_cvt_pk_bf16_f32 v28, v92, v93
    v_cvt_pk_bf16_f32 v29, v94, v95
    v_cvt_pk_bf16_f32 v30, v96, v97
    v_cvt_pk_bf16_f32 v31, v98, v99
    buffer_store_dwordx4 v[28:31], v8, s[4:7], s49 offen offset:512 sc1
    v_cvt_pk_bf16_f32 v32, v100, v101
    v_cvt_pk_bf16_f32 v33, v102, v103
    v_cvt_pk_bf16_f32 v34, v104, v105
    v_cvt_pk_bf16_f32 v35, v106, v107
    buffer_store_dwordx4 v[32:35], v8, s[4:7], s50 offen offset:512 sc1
    v_pk_mul_f32 v[108:109], v[108:109], s[52:53]
    v_pk_mul_f32 v[110:111], v[110:111], s[52:53]
    v_pk_mul_f32 v[112:113], v[112:113], s[52:53]
    v_pk_mul_f32 v[114:115], v[114:115], s[52:53]
    v_pk_mul_f32 v[116:117], v[116:117], s[52:53]
    v_pk_mul_f32 v[118:119], v[118:119], s[52:53]
    v_pk_mul_f32 v[120:121], v[120:121], s[52:53]
    v_pk_mul_f32 v[122:123], v[122:123], s[52:53]
    v_cvt_pk_bf16_f32 v36, v108, v109
    v_cvt_pk_bf16_f32 v37, v110, v111
    v_cvt_pk_bf16_f32 v38, v112, v113
    v_cvt_pk_bf16_f32 v39, v114, v115
    buffer_store_dwordx4 v[36:39], v8, s[4:7], s49 offen offset:768 sc1
    v_cvt_pk_bf16_f32 v40, v116, v117
    v_cvt_pk_bf16_f32 v41, v118, v119
    v_cvt_pk_bf16_f32 v42, v120, v121
    v_cvt_pk_bf16_f32 v43, v122, v123
    buffer_store_dwordx4 v[40:43], v8, s[4:7], s50 offen offset:768 sc1
    s_waitcnt lgkmcnt(0)
    s_barrier
    s_cmp_lg_u32 s47, 18
    s_cbranch_scc1 p1_w_b2
    v_lshrrev_b32 v2, 3, v1
    v_mul_u32_u24 v2, 9344, v2
    v_and_b32 v3, 7, v1
    v_lshl_add_u32 v2, v3, 4, v2
    v_add_u32 v2, 9216, v2
    v_mov_b32 v4, 0x3f803f80
    v_mov_b32 v5, 0x3f803f80
    v_mov_b32 v6, 0x3f803f80
    v_mov_b32 v7, 0x3f803f80
    buffer_store_dwordx4 v[4:7], v2, s[4:7], s49 offen sc1
    s_branch p1_w_b2
p1_w_idle:
    s_barrier
    s_barrier
    s_barrier
    s_barrier
    s_barrier
    s_barrier
    s_barrier
    s_barrier
    s_barrier
p1_w_b0:
    s_barrier
    v_mov_b32 v4, 160896
    v_mov_b32 v5, 0
    ds_write_b32 v4, v5
    s_waitcnt lgkmcnt(0)
    s_barrier
p1_w_b2:
    s_barrier
    s_barrier
    s_barrier
    s_mov_b64 exec, 1
    v_mov_b32 v2, 160896
    v_mov_b32 v3, 1
    s_lshl_b32 s24, s17, 8
    s_add_u32 s24, s24, 17465344
    s_waitcnt vmcnt(0)
    ds_add_rtn_u32 v4, v2, v3
    s_waitcnt lgkmcnt(0)
    v_readfirstlane_b32 s25, v4
    s_nop 0
    s_cmp_lg_u32 s25, 3
    s_cbranch_scc1 p1_w_nosig
    v_mov_b32 v2, 0
    v_mov_b32 v3, 1
    s_mov_b64 exec, 1
    buffer_atomic_add v3, v2, s[4:7], s24 offen sc1
    s_mov_b64 exec, -1
p1_w_nosig:
    s_mov_b64 exec, -1
    s_barrier
    s_barrier
    s_barrier
    s_barrier
    s_branch p1_done
p1_aux:
    s_lshl_b32 s24, s24, 4
    s_add_u32 s16, s16, s24
    s_mov_b32 s17, 14
    s_cmp_ge_u32 s3, 8
    s_cbranch_scc1 p1_h
    s_cmp_ge_u32 s16, 21
    s_cbranch_scc1 p1_aux_wo
    s_lshl_b32 s56, s16, 3
    s_add_u32 s56, s56, s3
    s_cmp_ge_u32 s56, 162
    s_cbranch_scc1 p1_aux_b0
    s_load_dwordx2 s[48:49], s[0:1], 64
    s_mov_b32 s50, 663552
    s_mov_b32 s51, 0x20000
    s_load_dwordx2 s[52:53], s[0:1], 72
    s_mov_b32 s54, 663552
    s_mov_b32 s55, 0x20000
    s_load_dwordx2 s[32:33], s[0:1], 32
    s_mov_b32 s34, 1152
    s_mov_b32 s35, 0x20000
    s_load_dwordx2 s[36:37], s[0:1], 40
    s_mov_b32 s38, 1152
    s_mov_b32 s39, 0x20000
    s_load_dwordx2 s[40:41], s[0:1], 80
    s_mov_b32 s42, 1152
    s_mov_b32 s43, 0x20000
    s_mul_i32 s59, s56, 7282
    s_lshr_b32 s59, s59, 16
    s_mul_i32 s25, s59, 9
    s_sub_u32 s58, s56, s25
    s_mul_i32 s57, s3, 8704
    v_lshrrev_b32 v5, 3, v1
    v_mul_u32_u24 v3, 1152, v5
    v_and_b32 v6, 7, v1
    v_lshrrev_b32 v7, 4, v1
    v_xor_b32 v7, v7, v6
    v_lshl_add_u32 v4, v7, 4, v3
    v_xor_b32 v8, 64, v4
    v_lshlrev_b32 v2, 1, v1
    s_lshl_b32 s27, s58, 7
    s_mul_i32 s26, s59, 36864
    s_add_u32 s26, s26, s27
    s_waitcnt lgkmcnt(0)
    buffer_load_ushort v10, v2, s[32:35], s27 offen
    buffer_load_ushort v11, v2, s[36:39], s27 offen
    buffer_load_ushort v12, v2, s[40:43], s27 offen
    s_add_u32 m0, s57, 0
    s_nop 0
    buffer_load_dwordx4 v4, s[48:51], s26 offen lds
    s_add_u32 m0, s57, 4096
    s_nop 0
    buffer_load_dwordx4 v4, s[52:55], s26 offen lds
    s_add_u32 s26, s26, 9216
    s_add_u32 m0, s57, 1024
    s_nop 0
    buffer_load_dwordx4 v8, s[48:51], s26 offen lds
    s_add_u32 m0, s57, 5120
    s_nop 0
    buffer_load_dwordx4 v8, s[52:55], s26 offen lds
    s_add_u32 s26, s26, 9216
    s_add_u32 m0, s57, 2048
    s_nop 0
    buffer_load_dwordx4 v4, s[48:51], s26 offen lds
    s_add_u32 m0, s57, 6144
    s_nop 0
    buffer_load_dwordx4 v4, s[52:55], s26 offen lds
    s_add_u32 s26, s26, 9216
    s_add_u32 m0, s57, 3072
    s_nop 0
    buffer_load_dwordx4 v8, s[48:51], s26 offen lds
    s_add_u32 m0, s57, 7168
    s_nop 0
    buffer_load_dwordx4 v8, s[52:55], s26 offen lds
    v_and_b32 v5, 31, v1
    v_bfe_u32 v6, v1, 1, 3
    v_lshrrev_b32 v7, 5, v1
    v_lshlrev_b32 v9, 2, v7
    v_xor_b32 v6, v6, v9
    v_lshl_add_u32 v5, v5, 7, s57
    v_xor_b32 v9, 0, v6
    v_lshl_add_u32 v56, v9, 4, v5
    v_xor_b32 v9, 1, v6
    v_lshl_add_u32 v57, v9, 4, v5
    v_xor_b32 v9, 2, v6
    v_lshl_add_u32 v58, v9, 4, v5
    v_xor_b32 v9, 3, v6
    v_lshl_add_u32 v59, v9, 4, v5
    s_add_u32 s24, s57, 8192
    v_lshl_add_u32 v54, v1, 3, s24
    v_lshl_add_u32 v9, v7, 8, s24
    s_waitcnt vmcnt(8)
    v_lshlrev_b32 v16, 16, v10
    v_lshlrev_b32 v17, 16, v11
    v_lshlrev_b32 v10, 16, v10
    v_lshlrev_b32 v11, 16, v11
    v_lshlrev_b32 v12, 16, v12
    v_mul_f32 v12, 0x3fb8aa3b, v12
    v_exp_f32 v12, v12
    s_nop 0
    v_cvt_pk_bf16_f32 v12, v12, v12
    v_and_b32 v12, 0xffff0000, v12
    v_mul_f32 v10, v12, v10
    v_mul_f32 v11, v12, v11
    v_mul_f32 v10, 0x3fb8aa3b, v10
    v_mul_f32 v11, 0x3e22f983, v11
    v_mul_f32 v12, 0x3f800000, v10
    v_mul_f32 v19, 0x3f800000, v11
    v_exp_f32 v12, v12
    v_fract_f32 v19, v19
    v_cos_f32 v18, v19
    v_sin_f32 v19, v19
    v_mul_f32 v18, v12, v18
    v_mul_f32 v19, v12, v19
    v_add_f32 v18, -1.0, v18
    v_mul_f32 v2, v16, v16
    v_fmac_f32 v2, v17, v17
    v_rcp_f32 v2, v2
    v_mul_f32 v52, v18, v16
    v_fmac_f32 v52, v19, v17
    v_mul_f32 v53, v19, v16
    v_fma_f32 v53, -v18, v17, v53
    v_add_f32 v2, v2, v2
    v_mul_f32 v52, v52, v2
    v_mul_f32 v53, v53, v2
    ds_write_b64 v54, v[52:53]
    s_waitcnt vmcnt(0) lgkmcnt(0)
    ds_read_b128 v[20:23], v56
    ds_read_b128 v[36:39], v56 offset:4096
    ds_read_b128 v[60:63], v9 offset:0
    ds_read_b128 v[64:67], v9 offset:16
    ds_read_b128 v[68:71], v9 offset:32
    ds_read_b128 v[72:75], v9 offset:48
    ds_read_b128 v[24:27], v57
    ds_read_b128 v[40:43], v57 offset:4096
    ds_read_b128 v[76:79], v9 offset:64
    ds_read_b128 v[80:83], v9 offset:80
    ds_read_b128 v[84:87], v9 offset:96
    ds_read_b128 v[88:91], v9 offset:112
    ds_read_b128 v[28:31], v58
    ds_read_b128 v[44:47], v58 offset:4096
    ds_read_b128 v[92:95], v9 offset:128
    ds_read_b128 v[96:99], v9 offset:144
    ds_read_b128 v[100:103], v9 offset:160
    ds_read_b128 v[104:107], v9 offset:176
    ds_read_b128 v[32:35], v59
    ds_read_b128 v[48:51], v59 offset:4096
    ds_read_b128 v[108:111], v9 offset:192
    ds_read_b128 v[112:115], v9 offset:208
    ds_read_b128 v[116:119], v9 offset:224
    ds_read_b128 v[120:123], v9 offset:240
    s_waitcnt lgkmcnt(15)
    v_lshlrev_b32 v160, 16, v20
    v_and_b32 v161, 0xffff0000, v20
    v_lshlrev_b32 v162, 16, v36
    v_and_b32 v163, 0xffff0000, v36
    v_mul_f32 v164, v60, v160
    v_mul_f32 v166, v61, v160
    v_fma_f32 v164, -v61, v162, v164
    v_fma_f32 v166, -v60, v162, -v166
    v_mul_f32 v165, v62, v161
    v_mul_f32 v167, v63, v161
    v_fma_f32 v165, -v63, v163, v165
    v_fma_f32 v167, -v62, v163, -v167
    v_cvt_pk_bf16_f32 v128, v164, v165
    v_cvt_pk_bf16_f32 v136, v166, v167
    v_lshlrev_b32 v160, 16, v21
    v_and_b32 v161, 0xffff0000, v21
    v_lshlrev_b32 v162, 16, v37
    v_and_b32 v163, 0xffff0000, v37
    v_mul_f32 v164, v64, v160
    v_mul_f32 v166, v65, v160
    v_fma_f32 v164, -v65, v162, v164
    v_fma_f32 v166, -v64, v162, -v166
    v_mul_f32 v165, v66, v161
    v_mul_f32 v167, v67, v161
    v_fma_f32 v165, -v67, v163, v165
    v_fma_f32 v167, -v66, v163, -v167
    v_cvt_pk_bf16_f32 v129, v164, v165
    v_cvt_pk_bf16_f32 v137, v166, v167
    v_lshlrev_b32 v160, 16, v22
    v_and_b32 v161, 0xffff0000, v22
    v_lshlrev_b32 v162, 16, v38
    v_and_b32 v163, 0xffff0000, v38
    v_mul_f32 v164, v68, v160
    v_mul_f32 v166, v69, v160
    v_fma_f32 v164, -v69, v162, v164
    v_fma_f32 v166, -v68, v162, -v166
    v_mul_f32 v165, v70, v161
    v_mul_f32 v167, v71, v161
    v_fma_f32 v165, -v71, v163, v165
    v_fma_f32 v167, -v70, v163, -v167
    v_cvt_pk_bf16_f32 v144, v164, v165
    v_cvt_pk_bf16_f32 v152, v166, v167
    v_lshlrev_b32 v160, 16, v23
    v_and_b32 v161, 0xffff0000, v23
    v_lshlrev_b32 v162, 16, v39
    v_and_b32 v163, 0xffff0000, v39
    v_mul_f32 v164, v72, v160
    v_mul_f32 v166, v73, v160
    v_fma_f32 v164, -v73, v162, v164
    v_fma_f32 v166, -v72, v162, -v166
    v_mul_f32 v165, v74, v161
    v_mul_f32 v167, v75, v161
    v_fma_f32 v165, -v75, v163, v165
    v_fma_f32 v167, -v74, v163, -v167
    v_cvt_pk_bf16_f32 v145, v164, v165
    v_cvt_pk_bf16_f32 v153, v166, v167
    s_waitcnt lgkmcnt(12)
    v_lshlrev_b32 v160, 16, v24
    v_and_b32 v161, 0xffff0000, v24
    v_lshlrev_b32 v162, 16, v40
    v_and_b32 v163, 0xffff0000, v40
    v_mul_f32 v164, v76, v160
    v_mul_f32 v166, v77, v160
    v_fma_f32 v164, -v77, v162, v164
    v_fma_f32 v166, -v76, v162, -v166
    v_mul_f32 v165, v78, v161
    v_mul_f32 v167, v79, v161
    v_fma_f32 v165, -v79, v163, v165
    v_fma_f32 v167, -v78, v163, -v167
    v_cvt_pk_bf16_f32 v130, v164, v165
    v_cvt_pk_bf16_f32 v138, v166, v167
    v_lshlrev_b32 v160, 16, v25
    v_and_b32 v161, 0xffff0000, v25
    v_lshlrev_b32 v162, 16, v41
    v_and_b32 v163, 0xffff0000, v41
    v_mul_f32 v164, v80, v160
    v_mul_f32 v166, v81, v160
    v_fma_f32 v164, -v81, v162, v164
    v_fma_f32 v166, -v80, v162, -v166
    v_mul_f32 v165, v82, v161
    v_mul_f32 v167, v83, v161
    v_fma_f32 v165, -v83, v163, v165
    v_fma_f32 v167, -v82, v163, -v167
    v_cvt_pk_bf16_f32 v131, v164, v165
    v_cvt_pk_bf16_f32 v139, v166, v167
    v_lshlrev_b32 v160, 16, v26
    v_and_b32 v161, 0xffff0000, v26
    v_lshlrev_b32 v162, 16, v42
    v_and_b32 v163, 0xffff0000, v42
    v_mul_f32 v164, v84, v160
    v_mul_f32 v166, v85, v160
    v_fma_f32 v164, -v85, v162, v164
    v_fma_f32 v166, -v84, v162, -v166
    v_mul_f32 v165, v86, v161
    v_mul_f32 v167, v87, v161
    v_fma_f32 v165, -v87, v163, v165
    v_fma_f32 v167, -v86, v163, -v167
    v_cvt_pk_bf16_f32 v146, v164, v165
    v_cvt_pk_bf16_f32 v154, v166, v167
    v_lshlrev_b32 v160, 16, v27
    v_and_b32 v161, 0xffff0000, v27
    v_lshlrev_b32 v162, 16, v43
    v_and_b32 v163, 0xffff0000, v43
    v_mul_f32 v164, v88, v160
    v_mul_f32 v166, v89, v160
    v_fma_f32 v164, -v89, v162, v164
    v_fma_f32 v166, -v88, v162, -v166
    v_mul_f32 v165, v90, v161
    v_mul_f32 v167, v91, v161
    v_fma_f32 v165, -v91, v163, v165
    v_fma_f32 v167, -v90, v163, -v167
    v_cvt_pk_bf16_f32 v147, v164, v165
    v_cvt_pk_bf16_f32 v155, v166, v167
    s_waitcnt lgkmcnt(6)
    v_lshlrev_b32 v160, 16, v28
    v_and_b32 v161, 0xffff0000, v28
    v_lshlrev_b32 v162, 16, v44
    v_and_b32 v163, 0xffff0000, v44
    v_mul_f32 v164, v92, v160
    v_mul_f32 v166, v93, v160
    v_fma_f32 v164, -v93, v162, v164
    v_fma_f32 v166, -v92, v162, -v166
    v_mul_f32 v165, v94, v161
    v_mul_f32 v167, v95, v161
    v_fma_f32 v165, -v95, v163, v165
    v_fma_f32 v167, -v94, v163, -v167
    v_cvt_pk_bf16_f32 v132, v164, v165
    v_cvt_pk_bf16_f32 v140, v166, v167
    v_lshlrev_b32 v160, 16, v29
    v_and_b32 v161, 0xffff0000, v29
    v_lshlrev_b32 v162, 16, v45
    v_and_b32 v163, 0xffff0000, v45
    v_mul_f32 v164, v96, v160
    v_mul_f32 v166, v97, v160
    v_fma_f32 v164, -v97, v162, v164
    v_fma_f32 v166, -v96, v162, -v166
    v_mul_f32 v165, v98, v161
    v_mul_f32 v167, v99, v161
    v_fma_f32 v165, -v99, v163, v165
    v_fma_f32 v167, -v98, v163, -v167
    v_cvt_pk_bf16_f32 v133, v164, v165
    v_cvt_pk_bf16_f32 v141, v166, v167
    v_lshlrev_b32 v160, 16, v30
    v_and_b32 v161, 0xffff0000, v30
    v_lshlrev_b32 v162, 16, v46
    v_and_b32 v163, 0xffff0000, v46
    v_mul_f32 v164, v100, v160
    v_mul_f32 v166, v101, v160
    v_fma_f32 v164, -v101, v162, v164
    v_fma_f32 v166, -v100, v162, -v166
    v_mul_f32 v165, v102, v161
    v_mul_f32 v167, v103, v161
    v_fma_f32 v165, -v103, v163, v165
    v_fma_f32 v167, -v102, v163, -v167
    v_cvt_pk_bf16_f32 v148, v164, v165
    v_cvt_pk_bf16_f32 v156, v166, v167
    v_lshlrev_b32 v160, 16, v31
    v_and_b32 v161, 0xffff0000, v31
    v_lshlrev_b32 v162, 16, v47
    v_and_b32 v163, 0xffff0000, v47
    v_mul_f32 v164, v104, v160
    v_mul_f32 v166, v105, v160
    v_fma_f32 v164, -v105, v162, v164
    v_fma_f32 v166, -v104, v162, -v166
    v_mul_f32 v165, v106, v161
    v_mul_f32 v167, v107, v161
    v_fma_f32 v165, -v107, v163, v165
    v_fma_f32 v167, -v106, v163, -v167
    v_cvt_pk_bf16_f32 v149, v164, v165
    v_cvt_pk_bf16_f32 v157, v166, v167
    s_waitcnt lgkmcnt(0)
    v_lshlrev_b32 v160, 16, v32
    v_and_b32 v161, 0xffff0000, v32
    v_lshlrev_b32 v162, 16, v48
    v_and_b32 v163, 0xffff0000, v48
    v_mul_f32 v164, v108, v160
    v_mul_f32 v166, v109, v160
    v_fma_f32 v164, -v109, v162, v164
    v_fma_f32 v166, -v108, v162, -v166
    v_mul_f32 v165, v110, v161
    v_mul_f32 v167, v111, v161
    v_fma_f32 v165, -v111, v163, v165
    v_fma_f32 v167, -v110, v163, -v167
    v_cvt_pk_bf16_f32 v134, v164, v165
    v_cvt_pk_bf16_f32 v142, v166, v167
    v_lshlrev_b32 v160, 16, v33
    v_and_b32 v161, 0xffff0000, v33
    v_lshlrev_b32 v162, 16, v49
    v_and_b32 v163, 0xffff0000, v49
    v_mul_f32 v164, v112, v160
    v_mul_f32 v166, v113, v160
    v_fma_f32 v164, -v113, v162, v164
    v_fma_f32 v166, -v112, v162, -v166
    v_mul_f32 v165, v114, v161
    v_mul_f32 v167, v115, v161
    v_fma_f32 v165, -v115, v163, v165
    v_fma_f32 v167, -v114, v163, -v167
    v_cvt_pk_bf16_f32 v135, v164, v165
    v_cvt_pk_bf16_f32 v143, v166, v167
    v_lshlrev_b32 v160, 16, v34
    v_and_b32 v161, 0xffff0000, v34
    v_lshlrev_b32 v162, 16, v50
    v_and_b32 v163, 0xffff0000, v50
    v_mul_f32 v164, v116, v160
    v_mul_f32 v166, v117, v160
    v_fma_f32 v164, -v117, v162, v164
    v_fma_f32 v166, -v116, v162, -v166
    v_mul_f32 v165, v118, v161
    v_mul_f32 v167, v119, v161
    v_fma_f32 v165, -v119, v163, v165
    v_fma_f32 v167, -v118, v163, -v167
    v_cvt_pk_bf16_f32 v150, v164, v165
    v_cvt_pk_bf16_f32 v158, v166, v167
    v_lshlrev_b32 v160, 16, v35
    v_and_b32 v161, 0xffff0000, v35
    v_lshlrev_b32 v162, 16, v51
    v_and_b32 v163, 0xffff0000, v51
    v_mul_f32 v164, v120, v160
    v_mul_f32 v166, v121, v160
    v_fma_f32 v164, -v121, v162, v164
    v_fma_f32 v166, -v120, v162, -v166
    v_mul_f32 v165, v122, v161
    v_mul_f32 v167, v123, v161
    v_fma_f32 v165, -v123, v163, v165
    v_fma_f32 v167, -v122, v163, -v167
    v_cvt_pk_bf16_f32 v151, v164, v165
    v_cvt_pk_bf16_f32 v159, v166, v167
    s_mul_i32 s26, s59, 72
    s_lshl_b32 s27, s58, 3
    s_add_u32 s26, s26, s27
    s_lshl_b32 s26, s26, 10
    s_add_u32 s28, s26, 14852096
    s_add_u32 s29, s28, 4096
    v_permlane32_swap_b32 v128, v144
    v_permlane32_swap_b32 v129, v145
    v_permlane32_swap_b32 v130, v146
    v_permlane32_swap_b32 v131, v147
    v_permlane32_swap_b32 v132, v148
    v_permlane32_swap_b32 v133, v149
    v_permlane32_swap_b32 v134, v150
    v_permlane32_swap_b32 v135, v151
    v_permlane32_swap_b32 v136, v152
    v_permlane32_swap_b32 v137, v153
    v_permlane32_swap_b32 v138, v154
    v_permlane32_swap_b32 v139, v155
    v_permlane32_swap_b32 v140, v156
    v_permlane32_swap_b32 v141, v157
    v_permlane32_swap_b32 v142, v158
    v_permlane32_swap_b32 v143, v159
    v_lshlrev_b32 v6, 4, v1
    buffer_store_dwordx4 v[128:131], v6, s[4:7], s28 offen offset:0 sc1
    buffer_store_dwordx4 v[144:147], v6, s[4:7], s29 offen offset:0 sc1
    buffer_store_dwordx4 v[132:135], v6, s[4:7], s28 offen offset:2048 sc1
    buffer_store_dwordx4 v[148:151], v6, s[4:7], s29 offen offset:2048 sc1
    buffer_store_dwordx4 v[136:139], v6, s[4:7], s28 offen offset:1024 sc1
    buffer_store_dwordx4 v[152:155], v6, s[4:7], s29 offen offset:1024 sc1
    buffer_store_dwordx4 v[140:143], v6, s[4:7], s28 offen offset:3072 sc1
    buffer_store_dwordx4 v[156:159], v6, s[4:7], s29 offen offset:3072 sc1
p1_aux_b0:
    s_barrier
    s_branch p1_aux_b1
p1_aux_wo:
    s_cmp_ge_u32 s16, 30
    s_cbranch_scc1 p1_aux_b0
    s_load_dwordx2 s[48:49], s[0:1], 16
    s_mov_b32 s50, 663552
    s_mov_b32 s51, 0x20000
    s_sub_u32 s56, s16, 21
    v_lshrrev_b32 v5, 3, v1
    v_mul_u32_u24 v3, 1152, v5
    v_and_b32 v6, 7, v1
    v_lshl_add_u32 v3, v6, 4, v3
    s_lshl_b32 s25, s56, 7
    s_mul_i32 s26, s3, 9216
    s_add_u32 s25, s25, s26
    s_lshl_b32 s26, s3, 10
    s_waitcnt lgkmcnt(0)
    s_add_u32 m0, s26, 0
    s_nop 0
    buffer_load_dwordx4 v3, s[48:51], s25 offen lds
    s_add_u32 s25, s25, 73728
    s_add_u32 m0, s26, 8192
    s_nop 0
    buffer_load_dwordx4 v3, s[48:51], s25 offen lds
    s_add_u32 s25, s25, 73728
    s_add_u32 m0, s26, 16384
    s_nop 0
    buffer_load_dwordx4 v3, s[48:51], s25 offen lds
    s_add_u32 s25, s25, 73728
    s_add_u32 m0, s26, 24576
    s_nop 0
    buffer_load_dwordx4 v3, s[48:51], s25 offen lds
    s_add_u32 s25, s25, 73728
    s_add_u32 m0, s26, 32768
    s_nop 0
    buffer_load_dwordx4 v3, s[48:51], s25 offen lds
    s_add_u32 s25, s25, 73728
    s_add_u32 m0, s26, 40960
    s_nop 0
    buffer_load_dwordx4 v3, s[48:51], s25 offen lds
    s_add_u32 s25, s25, 73728
    s_add_u32 m0, s26, 49152
    s_nop 0
    buffer_load_dwordx4 v3, s[48:51], s25 offen lds
    s_add_u32 s25, s25, 73728
    s_add_u32 m0, s26, 57344
    s_nop 0
    buffer_load_dwordx4 v3, s[48:51], s25 offen lds
    s_add_u32 s25, s25, 73728
    s_add_u32 m0, s26, 65536
    s_nop 0
    buffer_load_dwordx4 v3, s[48:51], s25 offen lds
    v_bfe_u32 v2, v1, 2, 2
    v_lshrrev_b32 v3, 5, v1
    v_bfe_u32 v4, v1, 4, 1
    v_lshlrev_b32 v4, 5, v4
    v_and_b32 v5, 3, v1
    v_lshl_add_u32 v4, v5, 3, v4
    v_lshl_add_u32 v5, v3, 2, v2
    v_lshl_add_u32 v5, v5, 7, v4
    s_mul_i32 s24, s3, 9216
    v_add_u32 v5, s24, v5
    v_lshrrev_b32 v8, 1, v2
    v_lshl_add_u32 v8, v3, 2, v8
    v_mul_u32_u24 v8, 18, v8
    v_and_b32 v7, 1, v2
    v_add3_u32 v8, v8, v7, 16
    v_lshl_add_u32 v8, v8, 7, v4
    s_and_b32 s25, s3, 3
    s_lshr_b32 s26, s3, 2
    s_mul_i32 s24, s25, 18432
    s_lshl_b32 s27, s26, 6
    s_add_u32 s24, s24, s27
    v_add_u32 v8, s24, v8
    v_lshlrev_b32 v6, 4, v1
    s_waitcnt vmcnt(0)
    s_barrier
    ds_read_b64_tr_b16 v[20:21], v5 offset:0
    ds_read_b64_tr_b16 v[22:23], v5 offset:1024
    ds_read_b64_tr_b16 v[24:25], v5 offset:2304
    ds_read_b64_tr_b16 v[26:27], v5 offset:3328
    ds_read_b64_tr_b16 v[28:29], v5 offset:4608
    ds_read_b64_tr_b16 v[30:31], v5 offset:5632
    ds_read_b64_tr_b16 v[32:33], v5 offset:6912
    ds_read_b64_tr_b16 v[34:35], v5 offset:7936
    ds_read_b64_tr_b16 v[36:37], v5 offset:64
    ds_read_b64_tr_b16 v[38:39], v5 offset:1088
    ds_read_b64_tr_b16 v[40:41], v5 offset:2368
    ds_read_b64_tr_b16 v[42:43], v5 offset:3392
    ds_read_b64_tr_b16 v[44:45], v5 offset:4672
    ds_read_b64_tr_b16 v[46:47], v5 offset:5696
    ds_read_b64_tr_b16 v[48:49], v5 offset:6976
    ds_read_b64_tr_b16 v[50:51], v5 offset:8000
    ds_read_b64_tr_b16 v[52:53], v8
    ds_read_b64_tr_b16 v[54:55], v8 offset:4608
    s_mul_i32 s24, s56, 73728
    s_add_u32 s24, s24, 14188544
    s_lshl_b32 s27, s3, 12
    s_add_u32 s27, s27, s24
    s_add_u32 s28, s27, 36864
    s_mul_i32 s26, s26, 36864
    s_add_u32 s24, s24, s26
    s_lshl_b32 s25, s25, 10
    s_add_u32 s24, s24, s25
    s_add_u32 s24, s24, 32768
    s_waitcnt lgkmcnt(0)
    buffer_store_dwordx4 v[20:23], v6, s[4:7], s27 offen offset:0 sc1
    buffer_store_dwordx4 v[24:27], v6, s[4:7], s27 offen offset:1024 sc1
    buffer_store_dwordx4 v[28:31], v6, s[4:7], s27 offen offset:2048 sc1
    buffer_store_dwordx4 v[32:35], v6, s[4:7], s27 offen offset:3072 sc1
    buffer_store_dwordx4 v[36:39], v6, s[4:7], s28 offen offset:0 sc1
    buffer_store_dwordx4 v[40:43], v6, s[4:7], s28 offen offset:1024 sc1
    buffer_store_dwordx4 v[44:47], v6, s[4:7], s28 offen offset:2048 sc1
    buffer_store_dwordx4 v[48:51], v6, s[4:7], s28 offen offset:3072 sc1
    buffer_store_dwordx4 v[52:55], v6, s[4:7], s24 offen sc1
p1_aux_b1:
    s_barrier
    s_cmp_ge_u32 s3, 4
    s_cbranch_scc1 p1_w_b0
    s_and_b32 s24, s3, 1
    s_lshr_b32 s25, s3, 1
    s_lshl_b32 s26, s25, 3
    s_add_u32 s26, s26, 48
    s_load_dwordx2 s[48:49], s[0:1], s26
    s_mov_b32 s50, 663552
    s_mov_b32 s51, 0x20000
    v_lshrrev_b32 v3, 3, v1
    v_and_b32 v4, 7, v1
    v_lshrrev_b32 v2, 4, v1
    s_lshl_b32 s26, s24, 2
    v_xor_b32 v2, s26, v2
    v_xor_b32 v2, v2, v4
    v_lshlrev_b32 v2, 4, v2
    s_lshl_b32 s26, s24, 5
    s_lshl_b32 s27, s25, 2
    s_add_u32 s26, s26, s27
    v_lshrrev_b32 v5, 5, v1
    v_and_b32 v6, 3, v3
    v_lshl_add_u32 v5, v5, 4, v6
    v_add_u32 v5, s26, v5
    v_mul_u32_u24 v5, 1152, v5
    s_lshl_b32 s26, s25, 6
    v_xor_b32 v6, s26, v2
    v_add_u32 v8, v5, v6
    s_mul_i32 s52, s18, 73728
    s_xor_b32 s53, s18, 1
    s_mul_i32 s53, s53, 73728
    s_lshl_b32 s44, s3, 10
    v_mov_b32 v12, 0
    s_setprio 3
    s_lshl_b32 s27, s19, 4
    s_lshl_b32 s26, s24, 3
    s_add_u32 s27, s27, s26
    s_mul_i32 s27, s27, 1152
    v_mul_u32_u24 v5, 1152, v3
    v_add3_u32 v11, v5, v2, s27
    s_waitcnt lgkmcnt(0)
    s_add_u32 m0, s44, 0
    s_add_u32 s29, s52, 0
    buffer_load_dwordx4 v8, s[8:11], s29 offen lds
    s_add_u32 m0, s44, 4096
    s_add_u32 s29, s52, 9216
    buffer_load_dwordx4 v8, s[8:11], s29 offen lds
    s_add_u32 m0, s44, 8192
    s_add_u32 s29, s52, 128
    buffer_load_dwordx4 v8, s[8:11], s29 offen lds
    s_add_u32 m0, s44, 12288
    s_add_u32 s29, s52, 9344
    buffer_load_dwordx4 v8, s[8:11], s29 offen lds
    s_cmp_eq_u32 s20, 0
    s_cbranch_scc1 p1_no5_9x
    s_add_u32 m0, s44, 110592
    s_mov_b32 s29, 73728
    buffer_load_dwordx4 v11, s[48:51], s29 offen lds
    s_branch p1_has5_9x
p1_no5_9x:
    buffer_load_dword v13, v12, s[8:11], 0 offen
p1_has5_9x:
    s_add_u32 m0, s44, 94208
    s_mov_b32 s29, 0
    buffer_load_dwordx4 v11, s[48:51], s29 offen lds
    s_add_u32 m0, s44, 98304
    s_mov_b32 s29, 18432
    buffer_load_dwordx4 v11, s[48:51], s29 offen lds
    s_add_u32 m0, s44, 102400
    s_mov_b32 s29, 36864
    buffer_load_dwordx4 v11, s[48:51], s29 offen lds
    s_add_u32 m0, s44, 106496
    s_mov_b32 s29, 55296
    buffer_load_dwordx4 v11, s[48:51], s29 offen lds
    s_add_u32 m0, s44, 16384
    s_add_u32 s29, s52, 256
    buffer_load_dwordx4 v8, s[8:11], s29 offen lds
    s_add_u32 m0, s44, 20480
    s_add_u32 s29, s52, 9472
    buffer_load_dwordx4 v8, s[8:11], s29 offen lds
    s_add_u32 m0, s44, 24576
    s_add_u32 s29, s52, 384
    buffer_load_dwordx4 v8, s[8:11], s29 offen lds
    s_add_u32 m0, s44, 28672
    s_add_u32 s29, s52, 9600
    buffer_load_dwordx4 v8, s[8:11], s29 offen lds
    s_add_u32 m0, s44, 32768
    s_add_u32 s29, s52, 512
    buffer_load_dwordx4 v8, s[8:11], s29 offen lds
    s_add_u32 m0, s44, 36864
    s_add_u32 s29, s52, 9728
    buffer_load_dwordx4 v8, s[8:11], s29 offen lds
    s_add_u32 m0, s44, 40960
    s_add_u32 s29, s52, 640
    buffer_load_dwordx4 v8, s[8:11], s29 offen lds
    s_add_u32 m0, s44, 45056
    s_add_u32 s29, s52, 9856
    buffer_load_dwordx4 v8, s[8:11], s29 offen lds
    s_add_u32 m0, s44, 49152
    s_add_u32 s29, s52, 768
    buffer_load_dwordx4 v8, s[8:11], s29 offen lds
    s_add_u32 m0, s44, 53248
    s_add_u32 s29, s52, 9984
    buffer_load_dwordx4 v8, s[8:11], s29 offen lds
    s_add_u32 m0, s44, 57344
    s_add_u32 s29, s52, 896
    buffer_load_dwordx4 v8, s[8:11], s29 offen lds
    s_add_u32 m0, s44, 61440
    s_add_u32 s29, s52, 10112
    buffer_load_dwordx4 v8, s[8:11], s29 offen lds
    s_add_u32 m0, s44, 65536
    s_add_u32 s29, s52, 1024
    buffer_load_dwordx4 v8, s[8:11], s29 offen lds
    s_add_u32 m0, s44, 69632
    s_add_u32 s29, s52, 10240
    buffer_load_dwordx4 v8, s[8:11], s29 offen lds
    s_branch p1_ld_b
p1_h:
    s_load_dwordx2 s[32:33], s[0:1], 32
    s_mov_b32 s34, 1152
    s_mov_b32 s35, 0x20000
    s_load_dwordx2 s[36:37], s[0:1], 40
    s_mov_b32 s38, 1152
    s_mov_b32 s39, 0x20000
    s_load_dwordx2 s[40:41], s[0:1], 80
    s_mov_b32 s42, 1152
    s_mov_b32 s43, 0x20000
    s_load_dwordx2 s[48:49], s[0:1], 112
    s_mov_b32 s50, 256
    s_mov_b32 s51, 0x20000
    s_load_dwordx2 s[52:53], s[0:1], 96
    s_mov_b32 s54, 1152
    s_mov_b32 s55, 0x20000
    s_sub_u32 s24, s3, 8
    s_lshl_b32 s25, s24, 12
    v_and_b32 v12, 15, v1
    v_lshrrev_b32 v13, 4, v1
    v_lshrrev_b32 v14, 1, v12
    v_xor_b32 v14, v14, v13
    v_lshlrev_b32 v14, 4, v14
    v_lshl_add_u32 v14, v12, 7, v14
    v_add_u32 v2, 0, v14
    v_xor_b32 v3, 64, v2
    s_add_u32 s25, s25, 94208
    v_add_u32 v4, s25, v14
    v_xor_b32 v5, 64, v4
    s_add_u32 s24, s24, s19
    s_lshl_b32 s24, s24, 5
    v_lshl_add_u32 v15, v12, 1, s24
    s_cmp_eq_u32 s20, 1
    s_mov_b32 s25, 4294967168
    s_cselect_b32 s24, 32, s25
    v_add_u32 v25, s24, v15
    v_lshlrev_b32 v22, 4, v13
    v_cvt_f32_u32 v22, v22
    v_mov_b32 v23, 0
    s_cmp_eq_u32 s17, 14
    s_cbranch_scc1 p1_h_aux
    s_setprio 2
    s_barrier
    v_and_b32 v36, 1, v1
    v_lshlrev_b32 v36, 4, v36
    v_lshlrev_b32 v37, v36, 1
    v_and_b32 v36, 31, v1
    v_lshrrev_b32 v64, 5, v1
    v_lshlrev_b32 v64, 4, v64
    v_sub_u32 v36, v36, v64
    v_lshrrev_b32 v36, 1, v36
    v_cmp_eq_u32 vcc, 0, v36
    s_nop 1
    v_cndmask_b32 v64, 0, v37, vcc
    v_cmp_eq_u32 vcc, 1, v36
    s_nop 1
    v_cndmask_b32 v65, 0, v37, vcc
    v_cmp_eq_u32 vcc, 2, v36
    s_nop 1
    v_cndmask_b32 v66, 0, v37, vcc
    v_cmp_eq_u32 vcc, 3, v36
    s_nop 1
    v_cndmask_b32 v67, 0, v37, vcc
    v_cmp_eq_u32 vcc, 4, v36
    s_nop 1
    v_cndmask_b32 v68, 0, v37, vcc
    v_cmp_eq_u32 vcc, 5, v36
    s_nop 1
    v_cndmask_b32 v69, 0, v37, vcc
    v_cmp_eq_u32 vcc, 6, v36
    s_nop 1
    v_cndmask_b32 v70, 0, v37, vcc
    v_cmp_eq_u32 vcc, 7, v36
    s_nop 1
    v_cndmask_b32 v71, 0, v37, vcc
    s_barrier
    s_sub_u32 s31, s3, 8
    s_lshl_b32 s31, s31, 11
    s_add_u32 s31, s31, 151552
    v_lshrrev_b32 v36, 3, v1
    v_and_b32 v36, 6, v36
    v_and_b32 v37, 7, v1
    v_xor_b32 v36, v36, v37
    v_lshlrev_b32 v36, 4, v36
    v_and_b32 v37, 15, v1
    v_lshl_add_u32 v36, v37, 7, v36
    v_add_u32 v60, s31, v36
    v_xor_b32 v61, 16, v60
    v_bfe_u32 v36, v1, 2, 2
    v_lshrrev_b32 v37, 5, v1
    v_lshl_add_u32 v36, v37, 2, v36
    v_bfe_u32 v37, v1, 4, 1
    v_lshlrev_b32 v37, 1, v37
    v_bfe_u32 v62, v1, 1, 1
    v_add_u32 v37, v37, v62
    v_xor_b32 v37, v37, v36
    v_lshlrev_b32 v37, 4, v37
    v_lshl_add_u32 v37, v36, 7, v37
    v_and_b32 v36, 1, v1
    v_lshl_add_u32 v37, v36, 3, v37
    v_add_u32 v62, s31, v37
    v_xor_b32 v63, 64, v62
    s_barrier
    s_waitcnt lgkmcnt(0)
    buffer_load_ushort v16, v15, s[32:35], 0 offen
    buffer_load_ushort v17, v15, s[36:39], 0 offen
    buffer_load_ushort v18, v15, s[40:43], 0 offen
    buffer_load_ushort v88, v25, s[32:35], 0 offen
    buffer_load_ushort v89, v25, s[36:39], 0 offen
    buffer_load_ushort v90, v25, s[40:43], 0 offen
    s_barrier
    s_barrier
    s_waitcnt vmcnt(0)
    s_cmp_lg_u32 s3, 8
    s_cbranch_scc1 p1_h_nr
    buffer_load_dword v24, v23, s[48:51], 0 offen sc1
p1_h_nr:
    v_lshlrev_b32 v16, 16, v16
    v_lshlrev_b32 v17, 16, v17
    v_lshlrev_b32 v18, 16, v18
    v_mul_f32 v18, 0x3fb8aa3b, v18
    v_exp_f32 v18, v18
    s_nop 0
    v_cvt_pk_bf16_f32 v18, v18, v18
    v_and_b32 v18, 0xffff0000, v18
    v_mul_f32 v16, v18, v16
    v_mul_f32 v17, v18, v17
    v_mul_f32 v16, 0x3fb8aa3b, v16
    v_mul_f32 v17, 0x3e22f983, v17
    v_mul_f32 v18, 0x3f800000, v16
    v_mul_f32 v77, 0x3f800000, v17
    v_exp_f32 v18, v18
    v_fract_f32 v77, v77
    s_barrier
    v_cos_f32 v76, v77
    v_sin_f32 v77, v77
    v_mul_f32 v76, v18, v76
    v_mul_f32 v77, v18, v77
    v_mul_f32 v18, 0x40000000, v16
    v_mul_f32 v79, 0x40000000, v17
    v_exp_f32 v18, v18
    v_fract_f32 v79, v79
    v_cos_f32 v78, v79
    v_sin_f32 v79, v79
    v_mul_f32 v78, v18, v78
    v_mul_f32 v79, v18, v79
    v_mul_f32 v18, 0x41800000, v16
    v_mul_f32 v81, 0x41800000, v17
    v_exp_f32 v18, v18
    s_barrier
    v_fract_f32 v81, v81
    v_cos_f32 v80, v81
    v_sin_f32 v81, v81
    v_mul_f32 v80, v18, v80
    v_mul_f32 v81, v18, v81
    v_mul_f32 v18, 0x42800000, v16
    v_mul_f32 v83, 0x42800000, v17
    v_exp_f32 v18, v18
    v_fract_f32 v83, v83
    v_cos_f32 v82, v83
    v_sin_f32 v83, v83
    v_mul_f32 v82, v18, v82
    v_mul_f32 v83, v18, v83
    v_mul_f32 v18, 0x44000000, v16
    v_mul_f32 v85, 0x44000000, v17
    s_barrier
    v_exp_f32 v18, v18
    v_fract_f32 v85, v85
    v_cos_f32 v84, v85
    v_sin_f32 v85, v85
    v_mul_f32 v84, v18, v84
    v_mul_f32 v85, v18, v85
    v_mul_f32 v18, v22, v16
    v_mul_f32 v87, v22, v17
    v_exp_f32 v18, v18
    v_fract_f32 v87, v87
    v_cos_f32 v86, v87
    v_sin_f32 v87, v87
    v_mul_f32 v86, v18, v86
    v_mul_f32 v87, v18, v87
    s_barrier
    s_waitcnt lgkmcnt(0)
    s_cmp_lg_u32 s3, 8
    s_cbranch_scc1 p1_h_rdya
    s_waitcnt vmcnt(0)
    v_readfirstlane_b32 s30, v24
    s_nop 0
    s_cmp_lg_u32 s30, 0
    s_cbranch_scc1 p1_h_rdya
    s_mov_b64 exec, 1
    s_mov_b32 s24, 0
poll_readya:
    buffer_load_dword v24, v23, s[48:51], 0 offen sc1
    s_add_u32 s24, s24, 1
    s_waitcnt vmcnt(0)
    v_cmp_gt_u32 vcc, 1, v24
    s_cbranch_vccz polled_readya
    s_sleep 4
    s_cmp_lt_u32 s24, 524288
    s_cbranch_scc1 poll_readya
polled_readya:
    s_mov_b64 exec, -1
p1_h_rdya:
    s_branch p1_h_go
p1_h_aux:
    s_and_b32 s24, s3, 1
    s_lshl_b32 s24, s24, 3
    s_add_u32 s24, s24, 48
    s_load_dwordx2 s[60:61], s[0:1], s24
    s_mov_b32 s62, 663552
    s_mov_b32 s63, 0x20000
    s_lshl_b32 s24, s16, 1
    s_bfe_u32 s25, s3, 0x10001
    s_add_u32 s24, s24, s25
    s_mul_i32 s24, s24, 10368
    v_lshlrev_b32 v8, 7, v1
    s_waitcnt lgkmcnt(0)
    buffer_load_dword v40, v8, s[60:63], s24 offen
    s_add_u32 s24, s24, 8192
    s_mov_b64 exec, 0x1ffff
    buffer_load_dword v41, v8, s[60:63], s24 offen
    s_mov_b64 exec, -1
    s_waitcnt lgkmcnt(0)
    buffer_load_ushort v16, v15, s[32:35], 0 offen
    buffer_load_ushort v17, v15, s[36:39], 0 offen
    buffer_load_ushort v18, v15, s[40:43], 0 offen
    buffer_load_ushort v88, v25, s[32:35], 0 offen
    buffer_load_ushort v89, v25, s[36:39], 0 offen
    buffer_load_ushort v90, v25, s[40:43], 0 offen
    buffer_load_dword v24, v23, s[48:51], 0 offen sc1
    s_waitcnt vmcnt(0)
    v_and_b32 v36, 1, v1
    v_lshlrev_b32 v36, 4, v36
    v_lshlrev_b32 v37, v36, 1
    v_and_b32 v36, 31, v1
    v_lshrrev_b32 v64, 5, v1
    v_lshlrev_b32 v64, 4, v64
    v_sub_u32 v36, v36, v64
    v_lshrrev_b32 v36, 1, v36
    v_cmp_eq_u32 vcc, 0, v36
    s_nop 1
    v_cndmask_b32 v64, 0, v37, vcc
    v_cmp_eq_u32 vcc, 1, v36
    s_nop 1
    v_cndmask_b32 v65, 0, v37, vcc
    v_cmp_eq_u32 vcc, 2, v36
    s_nop 1
    v_cndmask_b32 v66, 0, v37, vcc
    v_cmp_eq_u32 vcc, 3, v36
    s_nop 1
    v_cndmask_b32 v67, 0, v37, vcc
    v_cmp_eq_u32 vcc, 4, v36
    s_nop 1
    v_cndmask_b32 v68, 0, v37, vcc
    v_cmp_eq_u32 vcc, 5, v36
    s_nop 1
    v_cndmask_b32 v69, 0, v37, vcc
    v_cmp_eq_u32 vcc, 6, v36
    s_nop 1
    v_cndmask_b32 v70, 0, v37, vcc
    v_cmp_eq_u32 vcc, 7, v36
    s_nop 1
    v_cndmask_b32 v71, 0, v37, vcc
    s_sub_u32 s31, s3, 8
    s_lshl_b32 s31, s31, 11
    s_add_u32 s31, s31, 151552
    v_lshrrev_b32 v36, 3, v1
    v_and_b32 v36, 6, v36
    v_and_b32 v37, 7, v1
    v_xor_b32 v36, v36, v37
    v_lshlrev_b32 v36, 4, v36
    v_and_b32 v37, 15, v1
    v_lshl_add_u32 v36, v37, 7, v36
    v_add_u32 v60, s31, v36
    v_xor_b32 v61, 16, v60
    v_bfe_u32 v36, v1, 2, 2
    v_lshrrev_b32 v37, 5, v1
    v_lshl_add_u32 v36, v37, 2, v36
    v_bfe_u32 v37, v1, 4, 1
    v_lshlrev_b32 v37, 1, v37
    v_bfe_u32 v62, v1, 1, 1
    v_add_u32 v37, v37, v62
    v_xor_b32 v37, v37, v36
    v_lshlrev_b32 v37, 4, v37
    v_lshl_add_u32 v37, v36, 7, v37
    v_and_b32 v36, 1, v1
    v_lshl_add_u32 v37, v36, 3, v37
    v_add_u32 v62, s31, v37
    v_xor_b32 v63, 64, v62
    v_lshlrev_b32 v16, 16, v16
    v_lshlrev_b32 v17, 16, v17
    v_lshlrev_b32 v18, 16, v18
    v_mul_f32 v18, 0x3fb8aa3b, v18
    v_exp_f32 v18, v18
    s_nop 0
    v_cvt_pk_bf16_f32 v18, v18, v18
    v_and_b32 v18, 0xffff0000, v18
    v_mul_f32 v16, v18, v16
    v_mul_f32 v17, v18, v17
    v_mul_f32 v16, 0x3fb8aa3b, v16
    v_mul_f32 v17, 0x3e22f983, v17
    v_mul_f32 v18, 0x3f800000, v16
    v_mul_f32 v77, 0x3f800000, v17
    v_exp_f32 v18, v18
    v_fract_f32 v77, v77
    v_cos_f32 v76, v77
    v_sin_f32 v77, v77
    v_mul_f32 v76, v18, v76
    v_mul_f32 v77, v18, v77
    v_mul_f32 v18, 0x40000000, v16
    v_mul_f32 v79, 0x40000000, v17
    v_exp_f32 v18, v18
    v_fract_f32 v79, v79
    v_cos_f32 v78, v79
    v_sin_f32 v79, v79
    v_mul_f32 v78, v18, v78
    v_mul_f32 v79, v18, v79
    v_mul_f32 v18, 0x41800000, v16
    v_mul_f32 v81, 0x41800000, v17
    v_exp_f32 v18, v18
    v_fract_f32 v81, v81
    v_cos_f32 v80, v81
    v_sin_f32 v81, v81
    v_mul_f32 v80, v18, v80
    v_mul_f32 v81, v18, v81
    v_mul_f32 v18, 0x42800000, v16
    v_mul_f32 v83, 0x42800000, v17
    v_exp_f32 v18, v18
    v_fract_f32 v83, v83
    v_cos_f32 v82, v83
    v_sin_f32 v83, v83
    v_mul_f32 v82, v18, v82
    v_mul_f32 v83, v18, v83
    v_mul_f32 v18, 0x44000000, v16
    v_mul_f32 v85, 0x44000000, v17
    v_exp_f32 v18, v18
    v_fract_f32 v85, v85
    v_cos_f32 v84, v85
    v_sin_f32 v85, v85
    v_mul_f32 v84, v18, v84
    v_mul_f32 v85, v18, v85
    v_mul_f32 v18, v22, v16
    v_mul_f32 v87, v22, v17
    v_exp_f32 v18, v18
    v_fract_f32 v87, v87
    v_cos_f32 v86, v87
    v_sin_f32 v87, v87
    v_mul_f32 v86, v18, v86
    v_mul_f32 v87, v18, v87
    s_cmp_lg_u32 s3, 8
    s_cbranch_scc1 p1_h_rdyb
    s_waitcnt vmcnt(0)
    v_readfirstlane_b32 s30, v24
    s_nop 0
    s_cmp_lg_u32 s30, 0
    s_cbranch_scc1 p1_h_rdyb
    s_mov_b64 exec, 1
    s_mov_b32 s24, 0
poll_readyb:
    buffer_load_dword v24, v23, s[48:51], 0 offen sc1
    s_add_u32 s24, s24, 1
    s_waitcnt vmcnt(0)
    v_cmp_gt_u32 vcc, 1, v24
    s_cbranch_vccz polled_readyb
    s_sleep 4
    s_cmp_lt_u32 s24, 524288
    s_cbranch_scc1 poll_readyb
polled_readyb:
    s_mov_b64 exec, -1
p1_h_rdyb:
    s_barrier
    s_barrier
p1_h_go:
    s_cmp_eq_u32 s20, 1
    s_cbranch_scc1 p1_h_five
    s_barrier
    ds_read_b128 v[44:47], v4 offset:0
    ds_read_b128 v[12:15], v2 offset:0
    ds_read_b128 v[16:19], v3 offset:2048
    ds_read_b128 v[20:23], v2 offset:4096
    ds_read_b128 v[24:27], v3 offset:6144
    ds_read_b128 v[48:51], v4 offset:2048
    s_waitcnt lgkmcnt(4)
    v_mfma_f32_16x16x32_bf16 v[100:103], v[12:15], v[44:47], 0
    ds_read_b128 v[28:31], v3 offset:0
    s_waitcnt lgkmcnt(4)
    v_mfma_f32_16x16x32_bf16 v[104:107], v[16:19], v[44:47], 0
    ds_read_b128 v[32:35], v2 offset:2048
    s_waitcnt lgkmcnt(4)
    v_mfma_f32_16x16x32_bf16 v[108:111], v[20:23], v[44:47], 0
    ds_read_b128 v[36:39], v3 offset:4096
    s_waitcnt lgkmcnt(4)
    v_mfma_f32_16x16x32_bf16 v[112:115], v[24:27], v[44:47], 0
    ds_read_b128 v[44:47], v5 offset:0
    s_waitcnt lgkmcnt(4)
    v_mfma_f32_16x16x32_bf16 v[116:119], v[12:15], v[48:51], 0
    ds_read_b128 v[40:43], v2 offset:6144
    v_mfma_f32_16x16x32_bf16 v[120:123], v[16:19], v[48:51], 0
    v_mfma_f32_16x16x32_bf16 v[124:127], v[20:23], v[48:51], 0
    v_mfma_f32_16x16x32_bf16 v[128:131], v[24:27], v[48:51], 0
    ds_read_b128 v[48:51], v5 offset:2048
    s_waitcnt lgkmcnt(1)
    v_mfma_f32_16x16x32_bf16 v[100:103], v[28:31], v[44:47], v[100:103]
    s_barrier
    v_mfma_f32_16x16x32_bf16 v[104:107], v[32:35], v[44:47], v[104:107]
    v_add_u32 v2, 8192, v2
    ds_read_b128 v[12:15], v2 offset:0
    v_mfma_f32_16x16x32_bf16 v[108:111], v[36:39], v[44:47], v[108:111]
    v_add_u32 v3, 8192, v3
    ds_read_b128 v[16:19], v3 offset:2048
    v_mfma_f32_16x16x32_bf16 v[112:115], v[40:43], v[44:47], v[112:115]
    v_add_u32 v4, 20480, v4
    ds_read_b128 v[44:47], v4 offset:0
    s_waitcnt lgkmcnt(3)
    v_mfma_f32_16x16x32_bf16 v[116:119], v[28:31], v[48:51], v[116:119]
    ds_read_b128 v[20:23], v2 offset:4096
    v_mfma_f32_16x16x32_bf16 v[120:123], v[32:35], v[48:51], v[120:123]
    ds_read_b128 v[24:27], v3 offset:6144
    v_mfma_f32_16x16x32_bf16 v[124:127], v[36:39], v[48:51], v[124:127]
    v_mfma_f32_16x16x32_bf16 v[128:131], v[40:43], v[48:51], v[128:131]
    ds_read_b128 v[48:51], v4 offset:2048
    s_waitcnt lgkmcnt(1)
    v_mfma_f32_16x16x32_bf16 v[100:103], v[12:15], v[44:47], v[100:103]
    ds_read_b128 v[28:31], v3 offset:0
    v_mfma_f32_16x16x32_bf16 v[104:107], v[16:19], v[44:47], v[104:107]
    ds_read_b128 v[32:35], v2 offset:2048
    v_mfma_f32_16x16x32_bf16 v[108:111], v[20:23], v[44:47], v[108:111]
    ds_read_b128 v[36:39], v3 offset:4096
    v_mfma_f32_16x16x32_bf16 v[112:115], v[24:27], v[44:47], v[112:115]
    v_add_u32 v5, 20480, v5
    ds_read_b128 v[44:47], v5 offset:0
    s_waitcnt lgkmcnt(4)
    v_mfma_f32_16x16x32_bf16 v[116:119], v[12:15], v[48:51], v[116:119]
    ds_read_b128 v[40:43], v2 offset:6144
    v_mfma_f32_16x16x32_bf16 v[120:123], v[16:19], v[48:51], v[120:123]
    v_mfma_f32_16x16x32_bf16 v[124:127], v[20:23], v[48:51], v[124:127]
    v_mfma_f32_16x16x32_bf16 v[128:131], v[24:27], v[48:51], v[128:131]
    ds_read_b128 v[48:51], v5 offset:2048
    s_waitcnt lgkmcnt(1)
    v_mfma_f32_16x16x32_bf16 v[100:103], v[28:31], v[44:47], v[100:103]
    s_barrier
    v_mfma_f32_16x16x32_bf16 v[104:107], v[32:35], v[44:47], v[104:107]
    v_add_u32 v2, 8192, v2
    ds_read_b128 v[12:15], v2 offset:0
    v_mfma_f32_16x16x32_bf16 v[108:111], v[36:39], v[44:47], v[108:111]
    v_add_u32 v3, 8192, v3
    ds_read_b128 v[16:19], v3 offset:2048
    v_mfma_f32_16x16x32_bf16 v[112:115], v[40:43], v[44:47], v[112:115]
    v_add_u32 v4, 20480, v4
    ds_read_b128 v[44:47], v4 offset:0
    s_waitcnt lgkmcnt(3)
    v_mfma_f32_16x16x32_bf16 v[116:119], v[28:31], v[48:51], v[116:119]
    ds_read_b128 v[20:23], v2 offset:4096
    v_mfma_f32_16x16x32_bf16 v[120:123], v[32:35], v[48:51], v[120:123]
    ds_read_b128 v[24:27], v3 offset:6144
    v_mfma_f32_16x16x32_bf16 v[124:127], v[36:39], v[48:51], v[124:127]
    v_mfma_f32_16x16x32_bf16 v[128:131], v[40:43], v[48:51], v[128:131]
    ds_read_b128 v[48:51], v4 offset:2048
    s_waitcnt lgkmcnt(1)
    v_mfma_f32_16x16x32_bf16 v[100:103], v[12:15], v[44:47], v[100:103]
    ds_read_b128 v[28:31], v3 offset:0
    v_mfma_f32_16x16x32_bf16 v[104:107], v[16:19], v[44:47], v[104:107]
    ds_read_b128 v[32:35], v2 offset:2048
    v_mfma_f32_16x16x32_bf16 v[108:111], v[20:23], v[44:47], v[108:111]
    ds_read_b128 v[36:39], v3 offset:4096
    v_mfma_f32_16x16x32_bf16 v[112:115], v[24:27], v[44:47], v[112:115]
    v_add_u32 v5, 20480, v5
    ds_read_b128 v[44:47], v5 offset:0
    s_waitcnt lgkmcnt(4)
    v_mfma_f32_16x16x32_bf16 v[116:119], v[12:15], v[48:51], v[116:119]
    ds_read_b128 v[40:43], v2 offset:6144
    v_mfma_f32_16x16x32_bf16 v[120:123], v[16:19], v[48:51], v[120:123]
    v_mfma_f32_16x16x32_bf16 v[124:127], v[20:23], v[48:51], v[124:127]
    v_mfma_f32_16x16x32_bf16 v[128:131], v[24:27], v[48:51], v[128:131]
    ds_read_b128 v[48:51], v5 offset:2048
    s_waitcnt lgkmcnt(1)
    v_mfma_f32_16x16x32_bf16 v[100:103], v[28:31], v[44:47], v[100:103]
    s_barrier
    v_mfma_f32_16x16x32_bf16 v[104:107], v[32:35], v[44:47], v[104:107]
    v_add_u32 v2, 8192, v2
    ds_read_b128 v[12:15], v2 offset:0
    v_mfma_f32_16x16x32_bf16 v[108:111], v[36:39], v[44:47], v[108:111]
    v_add_u32 v3, 8192, v3
    ds_read_b128 v[16:19], v3 offset:2048
    v_mfma_f32_16x16x32_bf16 v[112:115], v[40:43], v[44:47], v[112:115]
    v_add_u32 v4, 4294905856, v4
    ds_read_b128 v[44:47], v4 offset:0
    s_waitcnt lgkmcnt(3)
    v_mfma_f32_16x16x32_bf16 v[116:119], v[28:31], v[48:51], v[116:119]
    ds_read_b128 v[20:23], v2 offset:4096
    v_mfma_f32_16x16x32_bf16 v[120:123], v[32:35], v[48:51], v[120:123]
    ds_read_b128 v[24:27], v3 offset:6144
    v_mfma_f32_16x16x32_bf16 v[124:127], v[36:39], v[48:51], v[124:127]
    v_mfma_f32_16x16x32_bf16 v[128:131], v[40:43], v[48:51], v[128:131]
    ds_read_b128 v[48:51], v4 offset:2048
    s_waitcnt lgkmcnt(1)
    v_mfma_f32_16x16x32_bf16 v[100:103], v[12:15], v[44:47], v[100:103]
    ds_read_b128 v[28:31], v3 offset:0
    v_mfma_f32_16x16x32_bf16 v[104:107], v[16:19], v[44:47], v[104:107]
    ds_read_b128 v[32:35], v2 offset:2048
    v_mfma_f32_16x16x32_bf16 v[108:111], v[20:23], v[44:47], v[108:111]
    ds_read_b128 v[36:39], v3 offset:4096
    v_mfma_f32_16x16x32_bf16 v[112:115], v[24:27], v[44:47], v[112:115]
    v_add_u32 v5, 4294905856, v5
    ds_read_b128 v[44:47], v5 offset:0
    s_waitcnt lgkmcnt(4)
    v_mfma_f32_16x16x32_bf16 v[116:119], v[12:15], v[48:51], v[116:119]
    ds_read_b128 v[40:43], v2 offset:6144
    v_mfma_f32_16x16x32_bf16 v[120:123], v[16:19], v[48:51], v[120:123]
    v_mfma_f32_16x16x32_bf16 v[124:127], v[20:23], v[48:51], v[124:127]
    v_mfma_f32_16x16x32_bf16 v[128:131], v[24:27], v[48:51], v[128:131]
    ds_read_b128 v[48:51], v5 offset:2048
    s_waitcnt lgkmcnt(1)
    v_mfma_f32_16x16x32_bf16 v[100:103], v[28:31], v[44:47], v[100:103]
    s_barrier
    v_mfma_f32_16x16x32_bf16 v[104:107], v[32:35], v[44:47], v[104:107]
    v_add_u32 v2, 8192, v2
    ds_read_b128 v[12:15], v2 offset:0
    v_mfma_f32_16x16x32_bf16 v[108:111], v[36:39], v[44:47], v[108:111]
    v_add_u32 v3, 8192, v3
    ds_read_b128 v[16:19], v3 offset:2048
    v_mfma_f32_16x16x32_bf16 v[112:115], v[40:43], v[44:47], v[112:115]
    v_add_u32 v4, 20480, v4
    ds_read_b128 v[44:47], v4 offset:0
    s_waitcnt lgkmcnt(3)
    v_mfma_f32_16x16x32_bf16 v[116:119], v[28:31], v[48:51], v[116:119]
    ds_read_b128 v[20:23], v2 offset:4096
    v_mfma_f32_16x16x32_bf16 v[120:123], v[32:35], v[48:51], v[120:123]
    ds_read_b128 v[24:27], v3 offset:6144
    v_mfma_f32_16x16x32_bf16 v[124:127], v[36:39], v[48:51], v[124:127]
    v_mfma_f32_16x16x32_bf16 v[128:131], v[40:43], v[48:51], v[128:131]
    ds_read_b128 v[48:51], v4 offset:2048
    s_waitcnt lgkmcnt(1)
    v_mfma_f32_16x16x32_bf16 v[100:103], v[12:15], v[44:47], v[100:103]
    ds_read_b128 v[28:31], v3 offset:0
    v_mfma_f32_16x16x32_bf16 v[104:107], v[16:19], v[44:47], v[104:107]
    ds_read_b128 v[32:35], v2 offset:2048
    v_mfma_f32_16x16x32_bf16 v[108:111], v[20:23], v[44:47], v[108:111]
    ds_read_b128 v[36:39], v3 offset:4096
    v_mfma_f32_16x16x32_bf16 v[112:115], v[24:27], v[44:47], v[112:115]
    v_add_u32 v5, 20480, v5
    ds_read_b128 v[44:47], v5 offset:0
    s_waitcnt lgkmcnt(4)
    v_mfma_f32_16x16x32_bf16 v[116:119], v[12:15], v[48:51], v[116:119]
    ds_read_b128 v[40:43], v2 offset:6144
    v_mfma_f32_16x16x32_bf16 v[120:123], v[16:19], v[48:51], v[120:123]
    v_mfma_f32_16x16x32_bf16 v[124:127], v[20:23], v[48:51], v[124:127]
    v_mfma_f32_16x16x32_bf16 v[128:131], v[24:27], v[48:51], v[128:131]
    ds_read_b128 v[48:51], v5 offset:2048
    s_waitcnt lgkmcnt(1)
    v_mfma_f32_16x16x32_bf16 v[100:103], v[28:31], v[44:47], v[100:103]
    s_barrier
    v_mfma_f32_16x16x32_bf16 v[104:107], v[32:35], v[44:47], v[104:107]
    v_add_u32 v2, 8192, v2
    ds_read_b128 v[12:15], v2 offset:0
    v_mfma_f32_16x16x32_bf16 v[108:111], v[36:39], v[44:47], v[108:111]
    v_add_u32 v3, 8192, v3
    ds_read_b128 v[16:19], v3 offset:2048
    v_mfma_f32_16x16x32_bf16 v[112:115], v[40:43], v[44:47], v[112:115]
    v_add_u32 v4, 20480, v4
    ds_read_b128 v[44:47], v4 offset:0
    s_waitcnt lgkmcnt(3)
    v_mfma_f32_16x16x32_bf16 v[116:119], v[28:31], v[48:51], v[116:119]
    ds_read_b128 v[20:23], v2 offset:4096
    v_mfma_f32_16x16x32_bf16 v[120:123], v[32:35], v[48:51], v[120:123]
    ds_read_b128 v[24:27], v3 offset:6144
    v_mfma_f32_16x16x32_bf16 v[124:127], v[36:39], v[48:51], v[124:127]
    v_mfma_f32_16x16x32_bf16 v[128:131], v[40:43], v[48:51], v[128:131]
    ds_read_b128 v[48:51], v4 offset:2048
    s_waitcnt lgkmcnt(1)
    v_mfma_f32_16x16x32_bf16 v[100:103], v[12:15], v[44:47], v[100:103]
    ds_read_b128 v[28:31], v3 offset:0
    v_mfma_f32_16x16x32_bf16 v[104:107], v[16:19], v[44:47], v[104:107]
    ds_read_b128 v[32:35], v2 offset:2048
    v_mfma_f32_16x16x32_bf16 v[108:111], v[20:23], v[44:47], v[108:111]
    ds_read_b128 v[36:39], v3 offset:4096
    v_mfma_f32_16x16x32_bf16 v[112:115], v[24:27], v[44:47], v[112:115]
    v_add_u32 v5, 20480, v5
    ds_read_b128 v[44:47], v5 offset:0
    s_waitcnt lgkmcnt(4)
    v_mfma_f32_16x16x32_bf16 v[116:119], v[12:15], v[48:51], v[116:119]
    ds_read_b128 v[40:43], v2 offset:6144
    v_mfma_f32_16x16x32_bf16 v[120:123], v[16:19], v[48:51], v[120:123]
    v_mfma_f32_16x16x32_bf16 v[124:127], v[20:23], v[48:51], v[124:127]
    v_mfma_f32_16x16x32_bf16 v[128:131], v[24:27], v[48:51], v[128:131]
    ds_read_b128 v[48:51], v5 offset:2048
    s_waitcnt lgkmcnt(1)
    v_mfma_f32_16x16x32_bf16 v[100:103], v[28:31], v[44:47], v[100:103]
    s_barrier
    v_mfma_f32_16x16x32_bf16 v[104:107], v[32:35], v[44:47], v[104:107]
    v_add_u32 v2, 8192, v2
    ds_read_b128 v[12:15], v2 offset:0
    v_mfma_f32_16x16x32_bf16 v[108:111], v[36:39], v[44:47], v[108:111]
    v_add_u32 v3, 8192, v3
    ds_read_b128 v[16:19], v3 offset:2048
    v_mfma_f32_16x16x32_bf16 v[112:115], v[40:43], v[44:47], v[112:115]
    v_add_u32 v4, 20480, v4
    ds_read_b128 v[44:47], v4 offset:0
    s_waitcnt lgkmcnt(3)
    v_mfma_f32_16x16x32_bf16 v[116:119], v[28:31], v[48:51], v[116:119]
    ds_read_b128 v[20:23], v2 offset:4096
    v_mfma_f32_16x16x32_bf16 v[120:123], v[32:35], v[48:51], v[120:123]
    ds_read_b128 v[24:27], v3 offset:6144
    v_mfma_f32_16x16x32_bf16 v[124:127], v[36:39], v[48:51], v[124:127]
    v_mfma_f32_16x16x32_bf16 v[128:131], v[40:43], v[48:51], v[128:131]
    ds_read_b128 v[48:51], v4 offset:2048
    s_waitcnt lgkmcnt(1)
    v_mfma_f32_16x16x32_bf16 v[100:103], v[12:15], v[44:47], v[100:103]
    ds_read_b128 v[28:31], v3 offset:0
    v_mfma_f32_16x16x32_bf16 v[104:107], v[16:19], v[44:47], v[104:107]
    ds_read_b128 v[32:35], v2 offset:2048
    v_mfma_f32_16x16x32_bf16 v[108:111], v[20:23], v[44:47], v[108:111]
    ds_read_b128 v[36:39], v3 offset:4096
    v_mfma_f32_16x16x32_bf16 v[112:115], v[24:27], v[44:47], v[112:115]
    v_add_u32 v5, 20480, v5
    ds_read_b128 v[44:47], v5 offset:0
    s_waitcnt lgkmcnt(4)
    v_mfma_f32_16x16x32_bf16 v[116:119], v[12:15], v[48:51], v[116:119]
    ds_read_b128 v[40:43], v2 offset:6144
    v_mfma_f32_16x16x32_bf16 v[120:123], v[16:19], v[48:51], v[120:123]
    v_mfma_f32_16x16x32_bf16 v[124:127], v[20:23], v[48:51], v[124:127]
    v_mfma_f32_16x16x32_bf16 v[128:131], v[24:27], v[48:51], v[128:131]
    ds_read_b128 v[48:51], v5 offset:2048
    s_waitcnt lgkmcnt(1)
    v_mfma_f32_16x16x32_bf16 v[100:103], v[28:31], v[44:47], v[100:103]
    s_barrier
    v_mfma_f32_16x16x32_bf16 v[104:107], v[32:35], v[44:47], v[104:107]
    v_add_u32 v2, 8192, v2
    ds_read_b128 v[12:15], v2 offset:0
    v_mfma_f32_16x16x32_bf16 v[108:111], v[36:39], v[44:47], v[108:111]
    v_add_u32 v3, 8192, v3
    ds_read_b128 v[16:19], v3 offset:2048
    v_mfma_f32_16x16x32_bf16 v[112:115], v[40:43], v[44:47], v[112:115]
    v_add_u32 v4, 4294905856, v4
    ds_read_b128 v[44:47], v4 offset:0
    s_waitcnt lgkmcnt(3)
    v_mfma_f32_16x16x32_bf16 v[116:119], v[28:31], v[48:51], v[116:119]
    ds_read_b128 v[20:23], v2 offset:4096
    v_mfma_f32_16x16x32_bf16 v[120:123], v[32:35], v[48:51], v[120:123]
    ds_read_b128 v[24:27], v3 offset:6144
    v_mfma_f32_16x16x32_bf16 v[124:127], v[36:39], v[48:51], v[124:127]
    v_mfma_f32_16x16x32_bf16 v[128:131], v[40:43], v[48:51], v[128:131]
    ds_read_b128 v[48:51], v4 offset:2048
    s_waitcnt lgkmcnt(1)
    v_mfma_f32_16x16x32_bf16 v[100:103], v[12:15], v[44:47], v[100:103]
    ds_read_b128 v[28:31], v3 offset:0
    v_mfma_f32_16x16x32_bf16 v[104:107], v[16:19], v[44:47], v[104:107]
    ds_read_b128 v[32:35], v2 offset:2048
    v_mfma_f32_16x16x32_bf16 v[108:111], v[20:23], v[44:47], v[108:111]
    ds_read_b128 v[36:39], v3 offset:4096
    v_mfma_f32_16x16x32_bf16 v[112:115], v[24:27], v[44:47], v[112:115]
    v_add_u32 v5, 4294905856, v5
    ds_read_b128 v[44:47], v5 offset:0
    s_waitcnt lgkmcnt(4)
    v_mfma_f32_16x16x32_bf16 v[116:119], v[12:15], v[48:51], v[116:119]
    ds_read_b128 v[40:43], v2 offset:6144
    v_mfma_f32_16x16x32_bf16 v[120:123], v[16:19], v[48:51], v[120:123]
    v_mfma_f32_16x16x32_bf16 v[124:127], v[20:23], v[48:51], v[124:127]
    v_mfma_f32_16x16x32_bf16 v[128:131], v[24:27], v[48:51], v[128:131]
    ds_read_b128 v[48:51], v5 offset:2048
    s_waitcnt lgkmcnt(1)
    v_mfma_f32_16x16x32_bf16 v[100:103], v[28:31], v[44:47], v[100:103]
    s_barrier
    v_mfma_f32_16x16x32_bf16 v[104:107], v[32:35], v[44:47], v[104:107]
    v_add_u32 v2, 8192, v2
    ds_read_b128 v[12:15], v2 offset:0
    v_mfma_f32_16x16x32_bf16 v[108:111], v[36:39], v[44:47], v[108:111]
    v_add_u32 v3, 8192, v3
    ds_read_b128 v[16:19], v3 offset:2048
    v_mfma_f32_16x16x32_bf16 v[112:115], v[40:43], v[44:47], v[112:115]
    v_add_u32 v4, 20480, v4
    ds_read_b128 v[44:47], v4 offset:0
    s_waitcnt lgkmcnt(3)
    v_mfma_f32_16x16x32_bf16 v[116:119], v[28:31], v[48:51], v[116:119]
    ds_read_b128 v[20:23], v2 offset:4096
    v_mfma_f32_16x16x32_bf16 v[120:123], v[32:35], v[48:51], v[120:123]
    ds_read_b128 v[24:27], v3 offset:6144
    v_mfma_f32_16x16x32_bf16 v[124:127], v[36:39], v[48:51], v[124:127]
    v_mfma_f32_16x16x32_bf16 v[128:131], v[40:43], v[48:51], v[128:131]
    ds_read_b128 v[48:51], v4 offset:2048
    s_waitcnt lgkmcnt(1)
    v_mfma_f32_16x16x32_bf16 v[100:103], v[12:15], v[44:47], v[100:103]
    ds_read_b128 v[28:31], v3 offset:0
    v_mfma_f32_16x16x32_bf16 v[104:107], v[16:19], v[44:47], v[104:107]
    ds_read_b128 v[32:35], v2 offset:2048
    v_mfma_f32_16x16x32_bf16 v[108:111], v[20:23], v[44:47], v[108:111]
    ds_read_b128 v[36:39], v3 offset:4096
    v_mfma_f32_16x16x32_bf16 v[112:115], v[24:27], v[44:47], v[112:115]
    v_add_u32 v5, 20480, v5
    ds_read_b128 v[44:47], v5 offset:0
    s_waitcnt lgkmcnt(4)
    v_mfma_f32_16x16x32_bf16 v[116:119], v[12:15], v[48:51], v[116:119]
    ds_read_b128 v[40:43], v2 offset:6144
    v_mfma_f32_16x16x32_bf16 v[120:123], v[16:19], v[48:51], v[120:123]
    v_mfma_f32_16x16x32_bf16 v[124:127], v[20:23], v[48:51], v[124:127]
    v_mfma_f32_16x16x32_bf16 v[128:131], v[24:27], v[48:51], v[128:131]
    ds_read_b128 v[48:51], v5 offset:2048
    s_waitcnt lgkmcnt(1)
    v_mfma_f32_16x16x32_bf16 v[100:103], v[28:31], v[44:47], v[100:103]
    v_mfma_f32_16x16x32_bf16 v[104:107], v[32:35], v[44:47], v[104:107]
    v_mfma_f32_16x16x32_bf16 v[108:111], v[36:39], v[44:47], v[108:111]
    v_mfma_f32_16x16x32_bf16 v[112:115], v[40:43], v[44:47], v[112:115]
    s_waitcnt lgkmcnt(0)
    v_mfma_f32_16x16x32_bf16 v[116:119], v[28:31], v[48:51], v[116:119]
    v_mfma_f32_16x16x32_bf16 v[120:123], v[32:35], v[48:51], v[120:123]
    v_mfma_f32_16x16x32_bf16 v[124:127], v[36:39], v[48:51], v[124:127]
    v_mfma_f32_16x16x32_bf16 v[128:131], v[40:43], v[48:51], v[128:131]
    s_branch p1_done
p1_h_five:
    s_sub_u32 s24, s3, 8
    s_lshl_b32 s25, s24, 11
    s_and_b32 s26, s24, 1
    s_lshl_b32 s26, s26, 6
    v_xor_b32 v6, s26, v2
    v_add_u32 v6, s25, v6
    v_xor_b32 v7, 64, v6
    v_add_u32 v8, 110592, v2
    v_xor_b32 v9, 64, v8
    s_lshl_b32 s24, s24, 10
    s_add_u32 s24, s24, 24576
    v_lshl_add_u32 v10, v1, 4, s24
    s_barrier
    ds_read_b128 v[44:47], v4 offset:0
    ds_read_b128 v[12:15], v2 offset:0
    ds_read_b128 v[16:19], v3 offset:2048
    ds_read_b128 v[20:23], v2 offset:4096
    ds_read_b128 v[24:27], v3 offset:6144
    ds_read_b128 v[48:51], v4 offset:2048
    ds_read_b128 v[52:55], v8
    ds_read_b128 v[140:143], v6
    ds_read_b128 v[56:59], v8 offset:2048
    s_waitcnt lgkmcnt(7)
    v_mfma_f32_16x16x32_bf16 v[100:103], v[12:15], v[44:47], 0
    ds_read_b128 v[28:31], v3 offset:0
    s_waitcnt lgkmcnt(7)
    v_mfma_f32_16x16x32_bf16 v[104:107], v[16:19], v[44:47], 0
    ds_read_b128 v[32:35], v2 offset:2048
    s_waitcnt lgkmcnt(7)
    v_mfma_f32_16x16x32_bf16 v[108:111], v[20:23], v[44:47], 0
    ds_read_b128 v[36:39], v3 offset:4096
    s_waitcnt lgkmcnt(7)
    v_mfma_f32_16x16x32_bf16 v[112:115], v[24:27], v[44:47], 0
    ds_read_b128 v[44:47], v5 offset:0
    s_waitcnt lgkmcnt(7)
    v_mfma_f32_16x16x32_bf16 v[116:119], v[12:15], v[48:51], 0
    ds_read_b128 v[40:43], v2 offset:6144
    v_mfma_f32_16x16x32_bf16 v[120:123], v[16:19], v[48:51], 0
    v_mfma_f32_16x16x32_bf16 v[124:127], v[20:23], v[48:51], 0
    v_mfma_f32_16x16x32_bf16 v[128:131], v[24:27], v[48:51], 0
    ds_read_b128 v[48:51], v5 offset:2048
    s_waitcnt lgkmcnt(6)
    v_mfma_f32_16x16x32_bf16 v[132:135], v[140:143], v[52:55], 0
    ds_read_b128 v[52:55], v9
    v_mfma_f32_16x16x32_bf16 v[136:139], v[140:143], v[56:59], 0
    ds_read_b128 v[140:143], v7
    ds_read_b128 v[56:59], v9 offset:2048
    s_waitcnt lgkmcnt(4)
    v_mfma_f32_16x16x32_bf16 v[100:103], v[28:31], v[44:47], v[100:103]
    s_barrier
    v_mfma_f32_16x16x32_bf16 v[104:107], v[32:35], v[44:47], v[104:107]
    v_add_u32 v2, 8192, v2
    ds_read_b128 v[12:15], v2 offset:0
    v_mfma_f32_16x16x32_bf16 v[108:111], v[36:39], v[44:47], v[108:111]
    v_add_u32 v3, 8192, v3
    ds_read_b128 v[16:19], v3 offset:2048
    v_mfma_f32_16x16x32_bf16 v[112:115], v[40:43], v[44:47], v[112:115]
    v_add_u32 v4, 20480, v4
    ds_read_b128 v[44:47], v4 offset:0
    s_waitcnt lgkmcnt(6)
    v_mfma_f32_16x16x32_bf16 v[116:119], v[28:31], v[48:51], v[116:119]
    ds_read_b128 v[20:23], v2 offset:4096
    v_mfma_f32_16x16x32_bf16 v[120:123], v[32:35], v[48:51], v[120:123]
    ds_read_b128 v[24:27], v3 offset:6144
    v_mfma_f32_16x16x32_bf16 v[124:127], v[36:39], v[48:51], v[124:127]
    v_mfma_f32_16x16x32_bf16 v[128:131], v[40:43], v[48:51], v[128:131]
    ds_read_b128 v[48:51], v4 offset:2048
    s_waitcnt lgkmcnt(6)
    v_mfma_f32_16x16x32_bf16 v[132:135], v[140:143], v[52:55], v[132:135]
    v_add_u32 v8, 20480, v8
    ds_read_b128 v[52:55], v8
    v_mfma_f32_16x16x32_bf16 v[136:139], v[140:143], v[56:59], v[136:139]
    v_add_u32 v6, 8192, v6
    ds_read_b128 v[140:143], v6
    ds_read_b128 v[56:59], v8 offset:2048
    s_waitcnt lgkmcnt(4)
    v_mfma_f32_16x16x32_bf16 v[100:103], v[12:15], v[44:47], v[100:103]
    ds_read_b128 v[28:31], v3 offset:0
    v_mfma_f32_16x16x32_bf16 v[104:107], v[16:19], v[44:47], v[104:107]
    ds_read_b128 v[32:35], v2 offset:2048
    v_mfma_f32_16x16x32_bf16 v[108:111], v[20:23], v[44:47], v[108:111]
    ds_read_b128 v[36:39], v3 offset:4096
    v_mfma_f32_16x16x32_bf16 v[112:115], v[24:27], v[44:47], v[112:115]
    v_add_u32 v5, 20480, v5
    ds_read_b128 v[44:47], v5 offset:0
    s_waitcnt lgkmcnt(7)
    v_mfma_f32_16x16x32_bf16 v[116:119], v[12:15], v[48:51], v[116:119]
    ds_read_b128 v[40:43], v2 offset:6144
    v_mfma_f32_16x16x32_bf16 v[120:123], v[16:19], v[48:51], v[120:123]
    v_mfma_f32_16x16x32_bf16 v[124:127], v[20:23], v[48:51], v[124:127]
    v_mfma_f32_16x16x32_bf16 v[128:131], v[24:27], v[48:51], v[128:131]
    ds_read_b128 v[48:51], v5 offset:2048
    s_waitcnt lgkmcnt(6)
    v_mfma_f32_16x16x32_bf16 v[132:135], v[140:143], v[52:55], v[132:135]
    v_add_u32 v9, 20480, v9
    ds_read_b128 v[52:55], v9
    v_mfma_f32_16x16x32_bf16 v[136:139], v[140:143], v[56:59], v[136:139]
    v_add_u32 v7, 8192, v7
    ds_read_b128 v[140:143], v7
    ds_read_b128 v[56:59], v9 offset:2048
    s_waitcnt lgkmcnt(4)
    v_mfma_f32_16x16x32_bf16 v[100:103], v[28:31], v[44:47], v[100:103]
    s_barrier
    v_mfma_f32_16x16x32_bf16 v[104:107], v[32:35], v[44:47], v[104:107]
    v_add_u32 v2, 8192, v2
    ds_read_b128 v[12:15], v2 offset:0
    v_mfma_f32_16x16x32_bf16 v[108:111], v[36:39], v[44:47], v[108:111]
    v_add_u32 v3, 8192, v3
    ds_read_b128 v[16:19], v3 offset:2048
    v_mfma_f32_16x16x32_bf16 v[112:115], v[40:43], v[44:47], v[112:115]
    v_add_u32 v4, 20480, v4
    ds_read_b128 v[44:47], v4 offset:0
    s_waitcnt lgkmcnt(6)
    v_mfma_f32_16x16x32_bf16 v[116:119], v[28:31], v[48:51], v[116:119]
    ds_read_b128 v[20:23], v2 offset:4096
    v_mfma_f32_16x16x32_bf16 v[120:123], v[32:35], v[48:51], v[120:123]
    ds_read_b128 v[24:27], v3 offset:6144
    v_mfma_f32_16x16x32_bf16 v[124:127], v[36:39], v[48:51], v[124:127]
    v_mfma_f32_16x16x32_bf16 v[128:131], v[40:43], v[48:51], v[128:131]
    ds_read_b128 v[48:51], v4 offset:2048
    s_waitcnt lgkmcnt(6)
    v_mfma_f32_16x16x32_bf16 v[132:135], v[140:143], v[52:55], v[132:135]
    v_add_u32 v8, 20480, v8
    ds_read_b128 v[52:55], v8
    v_mfma_f32_16x16x32_bf16 v[136:139], v[140:143], v[56:59], v[136:139]
    v_add_u32 v6, 8192, v6
    ds_read_b128 v[140:143], v6
    ds_read_b128 v[56:59], v8 offset:2048
    s_waitcnt lgkmcnt(4)
    v_mfma_f32_16x16x32_bf16 v[100:103], v[12:15], v[44:47], v[100:103]
    ds_read_b128 v[28:31], v3 offset:0
    v_mfma_f32_16x16x32_bf16 v[104:107], v[16:19], v[44:47], v[104:107]
    ds_read_b128 v[32:35], v2 offset:2048
    v_mfma_f32_16x16x32_bf16 v[108:111], v[20:23], v[44:47], v[108:111]
    ds_read_b128 v[36:39], v3 offset:4096
    v_mfma_f32_16x16x32_bf16 v[112:115], v[24:27], v[44:47], v[112:115]
    v_add_u32 v5, 20480, v5
    ds_read_b128 v[44:47], v5 offset:0
    s_waitcnt lgkmcnt(7)
    v_mfma_f32_16x16x32_bf16 v[116:119], v[12:15], v[48:51], v[116:119]
    ds_read_b128 v[40:43], v2 offset:6144
    v_mfma_f32_16x16x32_bf16 v[120:123], v[16:19], v[48:51], v[120:123]
    v_mfma_f32_16x16x32_bf16 v[124:127], v[20:23], v[48:51], v[124:127]
    v_mfma_f32_16x16x32_bf16 v[128:131], v[24:27], v[48:51], v[128:131]
    ds_read_b128 v[48:51], v5 offset:2048
    s_waitcnt lgkmcnt(6)
    v_mfma_f32_16x16x32_bf16 v[132:135], v[140:143], v[52:55], v[132:135]
    v_add_u32 v9, 20480, v9
    ds_read_b128 v[52:55], v9
    v_mfma_f32_16x16x32_bf16 v[136:139], v[140:143], v[56:59], v[136:139]
    v_add_u32 v7, 8192, v7
    ds_read_b128 v[140:143], v7
    ds_read_b128 v[56:59], v9 offset:2048
    s_waitcnt lgkmcnt(4)
    v_mfma_f32_16x16x32_bf16 v[100:103], v[28:31], v[44:47], v[100:103]
    s_barrier
    v_mfma_f32_16x16x32_bf16 v[104:107], v[32:35], v[44:47], v[104:107]
    v_add_u32 v2, 8192, v2
    ds_read_b128 v[12:15], v2 offset:0
    v_mfma_f32_16x16x32_bf16 v[108:111], v[36:39], v[44:47], v[108:111]
    v_add_u32 v3, 8192, v3
    ds_read_b128 v[16:19], v3 offset:2048
    v_mfma_f32_16x16x32_bf16 v[112:115], v[40:43], v[44:47], v[112:115]
    v_add_u32 v4, 4294905856, v4
    ds_read_b128 v[44:47], v4 offset:0
    s_waitcnt lgkmcnt(6)
    v_mfma_f32_16x16x32_bf16 v[116:119], v[28:31], v[48:51], v[116:119]
    ds_read_b128 v[20:23], v2 offset:4096
    v_mfma_f32_16x16x32_bf16 v[120:123], v[32:35], v[48:51], v[120:123]
    ds_read_b128 v[24:27], v3 offset:6144
    v_mfma_f32_16x16x32_bf16 v[124:127], v[36:39], v[48:51], v[124:127]
    v_mfma_f32_16x16x32_bf16 v[128:131], v[40:43], v[48:51], v[128:131]
    ds_read_b128 v[48:51], v4 offset:2048
    s_waitcnt lgkmcnt(6)
    v_mfma_f32_16x16x32_bf16 v[132:135], v[140:143], v[52:55], v[132:135]
    v_add_u32 v8, 4294905856, v8
    ds_read_b128 v[52:55], v8
    v_mfma_f32_16x16x32_bf16 v[136:139], v[140:143], v[56:59], v[136:139]
    v_add_u32 v6, 8192, v6
    ds_read_b128 v[140:143], v6
    ds_read_b128 v[56:59], v8 offset:2048
    s_waitcnt lgkmcnt(4)
    v_mfma_f32_16x16x32_bf16 v[100:103], v[12:15], v[44:47], v[100:103]
    ds_read_b128 v[28:31], v3 offset:0
    v_mfma_f32_16x16x32_bf16 v[104:107], v[16:19], v[44:47], v[104:107]
    ds_read_b128 v[32:35], v2 offset:2048
    v_mfma_f32_16x16x32_bf16 v[108:111], v[20:23], v[44:47], v[108:111]
    ds_read_b128 v[36:39], v3 offset:4096
    v_mfma_f32_16x16x32_bf16 v[112:115], v[24:27], v[44:47], v[112:115]
    v_add_u32 v5, 4294905856, v5
    ds_read_b128 v[44:47], v5 offset:0
    s_waitcnt lgkmcnt(7)
    v_mfma_f32_16x16x32_bf16 v[116:119], v[12:15], v[48:51], v[116:119]
    ds_read_b128 v[40:43], v2 offset:6144
    v_mfma_f32_16x16x32_bf16 v[120:123], v[16:19], v[48:51], v[120:123]
    v_mfma_f32_16x16x32_bf16 v[124:127], v[20:23], v[48:51], v[124:127]
    v_mfma_f32_16x16x32_bf16 v[128:131], v[24:27], v[48:51], v[128:131]
    ds_read_b128 v[48:51], v5 offset:2048
    s_waitcnt lgkmcnt(6)
    v_mfma_f32_16x16x32_bf16 v[132:135], v[140:143], v[52:55], v[132:135]
    v_add_u32 v9, 4294905856, v9
    ds_read_b128 v[52:55], v9
    v_mfma_f32_16x16x32_bf16 v[136:139], v[140:143], v[56:59], v[136:139]
    v_add_u32 v7, 8192, v7
    ds_read_b128 v[140:143], v7
    ds_read_b128 v[56:59], v9 offset:2048
    s_waitcnt lgkmcnt(4)
    v_mfma_f32_16x16x32_bf16 v[100:103], v[28:31], v[44:47], v[100:103]
    s_barrier
    v_mfma_f32_16x16x32_bf16 v[104:107], v[32:35], v[44:47], v[104:107]
    v_add_u32 v2, 8192, v2
    ds_read_b128 v[12:15], v2 offset:0
    v_mfma_f32_16x16x32_bf16 v[108:111], v[36:39], v[44:47], v[108:111]
    v_add_u32 v3, 8192, v3
    ds_read_b128 v[16:19], v3 offset:2048
    v_mfma_f32_16x16x32_bf16 v[112:115], v[40:43], v[44:47], v[112:115]
    v_add_u32 v4, 20480, v4
    ds_read_b128 v[44:47], v4 offset:0
    s_waitcnt lgkmcnt(6)
    v_mfma_f32_16x16x32_bf16 v[116:119], v[28:31], v[48:51], v[116:119]
    ds_read_b128 v[20:23], v2 offset:4096
    v_mfma_f32_16x16x32_bf16 v[120:123], v[32:35], v[48:51], v[120:123]
    ds_read_b128 v[24:27], v3 offset:6144
    v_mfma_f32_16x16x32_bf16 v[124:127], v[36:39], v[48:51], v[124:127]
    v_mfma_f32_16x16x32_bf16 v[128:131], v[40:43], v[48:51], v[128:131]
    ds_read_b128 v[48:51], v4 offset:2048
    s_waitcnt lgkmcnt(6)
    v_mfma_f32_16x16x32_bf16 v[132:135], v[140:143], v[52:55], v[132:135]
    v_add_u32 v8, 20480, v8
    ds_read_b128 v[52:55], v8
    v_mfma_f32_16x16x32_bf16 v[136:139], v[140:143], v[56:59], v[136:139]
    v_add_u32 v6, 8192, v6
    ds_read_b128 v[140:143], v6
    ds_read_b128 v[56:59], v8 offset:2048
    s_waitcnt lgkmcnt(4)
    v_mfma_f32_16x16x32_bf16 v[100:103], v[12:15], v[44:47], v[100:103]
    ds_read_b128 v[28:31], v3 offset:0
    v_mfma_f32_16x16x32_bf16 v[104:107], v[16:19], v[44:47], v[104:107]
    ds_read_b128 v[32:35], v2 offset:2048
    v_mfma_f32_16x16x32_bf16 v[108:111], v[20:23], v[44:47], v[108:111]
    ds_read_b128 v[36:39], v3 offset:4096
    v_mfma_f32_16x16x32_bf16 v[112:115], v[24:27], v[44:47], v[112:115]
    v_add_u32 v5, 20480, v5
    ds_read_b128 v[44:47], v5 offset:0
    s_waitcnt lgkmcnt(7)
    v_mfma_f32_16x16x32_bf16 v[116:119], v[12:15], v[48:51], v[116:119]
    ds_read_b128 v[40:43], v2 offset:6144
    v_mfma_f32_16x16x32_bf16 v[120:123], v[16:19], v[48:51], v[120:123]
    v_mfma_f32_16x16x32_bf16 v[124:127], v[20:23], v[48:51], v[124:127]
    v_mfma_f32_16x16x32_bf16 v[128:131], v[24:27], v[48:51], v[128:131]
    ds_read_b128 v[48:51], v5 offset:2048
    s_waitcnt lgkmcnt(6)
    v_mfma_f32_16x16x32_bf16 v[132:135], v[140:143], v[52:55], v[132:135]
    v_add_u32 v9, 20480, v9
    ds_read_b128 v[52:55], v9
    v_mfma_f32_16x16x32_bf16 v[136:139], v[140:143], v[56:59], v[136:139]
    v_add_u32 v7, 8192, v7
    ds_read_b128 v[140:143], v7
    ds_read_b128 v[56:59], v9 offset:2048
    s_waitcnt lgkmcnt(4)
    v_mfma_f32_16x16x32_bf16 v[100:103], v[28:31], v[44:47], v[100:103]
    s_barrier
    v_mfma_f32_16x16x32_bf16 v[104:107], v[32:35], v[44:47], v[104:107]
    v_add_u32 v2, 8192, v2
    ds_read_b128 v[12:15], v2 offset:0
    v_mfma_f32_16x16x32_bf16 v[108:111], v[36:39], v[44:47], v[108:111]
    v_add_u32 v3, 8192, v3
    ds_read_b128 v[16:19], v3 offset:2048
    v_mfma_f32_16x16x32_bf16 v[112:115], v[40:43], v[44:47], v[112:115]
    v_add_u32 v4, 20480, v4
    ds_read_b128 v[44:47], v4 offset:0
    s_waitcnt lgkmcnt(6)
    v_mfma_f32_16x16x32_bf16 v[116:119], v[28:31], v[48:51], v[116:119]
    ds_read_b128 v[20:23], v2 offset:4096
    v_mfma_f32_16x16x32_bf16 v[120:123], v[32:35], v[48:51], v[120:123]
    ds_read_b128 v[24:27], v3 offset:6144
    v_mfma_f32_16x16x32_bf16 v[124:127], v[36:39], v[48:51], v[124:127]
    v_mfma_f32_16x16x32_bf16 v[128:131], v[40:43], v[48:51], v[128:131]
    ds_read_b128 v[48:51], v4 offset:2048
    s_waitcnt lgkmcnt(6)
    v_mfma_f32_16x16x32_bf16 v[132:135], v[140:143], v[52:55], v[132:135]
    v_add_u32 v8, 20480, v8
    ds_read_b128 v[52:55], v8
    v_mfma_f32_16x16x32_bf16 v[136:139], v[140:143], v[56:59], v[136:139]
    v_add_u32 v6, 8192, v6
    ds_read_b128 v[140:143], v6
    ds_read_b128 v[56:59], v8 offset:2048
    s_waitcnt lgkmcnt(4)
    v_mfma_f32_16x16x32_bf16 v[100:103], v[12:15], v[44:47], v[100:103]
    ds_read_b128 v[28:31], v3 offset:0
    v_mfma_f32_16x16x32_bf16 v[104:107], v[16:19], v[44:47], v[104:107]
    ds_read_b128 v[32:35], v2 offset:2048
    v_mfma_f32_16x16x32_bf16 v[108:111], v[20:23], v[44:47], v[108:111]
    ds_read_b128 v[36:39], v3 offset:4096
    v_mfma_f32_16x16x32_bf16 v[112:115], v[24:27], v[44:47], v[112:115]
    v_add_u32 v5, 20480, v5
    ds_read_b128 v[44:47], v5 offset:0
    s_waitcnt lgkmcnt(7)
    v_mfma_f32_16x16x32_bf16 v[116:119], v[12:15], v[48:51], v[116:119]
    ds_read_b128 v[40:43], v2 offset:6144
    v_mfma_f32_16x16x32_bf16 v[120:123], v[16:19], v[48:51], v[120:123]
    v_mfma_f32_16x16x32_bf16 v[124:127], v[20:23], v[48:51], v[124:127]
    v_mfma_f32_16x16x32_bf16 v[128:131], v[24:27], v[48:51], v[128:131]
    ds_read_b128 v[48:51], v5 offset:2048
    s_waitcnt lgkmcnt(6)
    v_mfma_f32_16x16x32_bf16 v[132:135], v[140:143], v[52:55], v[132:135]
    v_add_u32 v9, 20480, v9
    ds_read_b128 v[52:55], v9
    v_mfma_f32_16x16x32_bf16 v[136:139], v[140:143], v[56:59], v[136:139]
    v_add_u32 v7, 8192, v7
    ds_read_b128 v[140:143], v7
    ds_read_b128 v[56:59], v9 offset:2048
    s_waitcnt lgkmcnt(4)
    v_mfma_f32_16x16x32_bf16 v[100:103], v[28:31], v[44:47], v[100:103]
    s_barrier
    v_mfma_f32_16x16x32_bf16 v[104:107], v[32:35], v[44:47], v[104:107]
    v_add_u32 v2, 8192, v2
    ds_read_b128 v[12:15], v2 offset:0
    v_mfma_f32_16x16x32_bf16 v[108:111], v[36:39], v[44:47], v[108:111]
    v_add_u32 v3, 8192, v3
    ds_read_b128 v[16:19], v3 offset:2048
    v_mfma_f32_16x16x32_bf16 v[112:115], v[40:43], v[44:47], v[112:115]
    v_add_u32 v4, 20480, v4
    ds_read_b128 v[44:47], v4 offset:0
    s_waitcnt lgkmcnt(6)
    v_mfma_f32_16x16x32_bf16 v[116:119], v[28:31], v[48:51], v[116:119]
    ds_read_b128 v[20:23], v2 offset:4096
    v_mfma_f32_16x16x32_bf16 v[120:123], v[32:35], v[48:51], v[120:123]
    ds_read_b128 v[24:27], v3 offset:6144
    v_mfma_f32_16x16x32_bf16 v[124:127], v[36:39], v[48:51], v[124:127]
    v_mfma_f32_16x16x32_bf16 v[128:131], v[40:43], v[48:51], v[128:131]
    ds_read_b128 v[48:51], v4 offset:2048
    s_waitcnt lgkmcnt(6)
    v_mfma_f32_16x16x32_bf16 v[132:135], v[140:143], v[52:55], v[132:135]
    v_add_u32 v8, 20480, v8
    ds_read_b128 v[52:55], v8
    v_mfma_f32_16x16x32_bf16 v[136:139], v[140:143], v[56:59], v[136:139]
    v_add_u32 v6, 8192, v6
    ds_read_b128 v[140:143], v6
    ds_read_b128 v[56:59], v8 offset:2048
    s_waitcnt lgkmcnt(4)
    v_mfma_f32_16x16x32_bf16 v[100:103], v[12:15], v[44:47], v[100:103]
    ds_read_b128 v[28:31], v3 offset:0
    v_mfma_f32_16x16x32_bf16 v[104:107], v[16:19], v[44:47], v[104:107]
    ds_read_b128 v[32:35], v2 offset:2048
    v_mfma_f32_16x16x32_bf16 v[108:111], v[20:23], v[44:47], v[108:111]
    ds_read_b128 v[36:39], v3 offset:4096
    v_mfma_f32_16x16x32_bf16 v[112:115], v[24:27], v[44:47], v[112:115]
    v_add_u32 v5, 20480, v5
    ds_read_b128 v[44:47], v5 offset:0
    s_waitcnt lgkmcnt(7)
    v_mfma_f32_16x16x32_bf16 v[116:119], v[12:15], v[48:51], v[116:119]
    ds_read_b128 v[40:43], v2 offset:6144
    v_mfma_f32_16x16x32_bf16 v[120:123], v[16:19], v[48:51], v[120:123]
    v_mfma_f32_16x16x32_bf16 v[124:127], v[20:23], v[48:51], v[124:127]
    v_mfma_f32_16x16x32_bf16 v[128:131], v[24:27], v[48:51], v[128:131]
    ds_read_b128 v[48:51], v5 offset:2048
    s_waitcnt lgkmcnt(6)
    v_mfma_f32_16x16x32_bf16 v[132:135], v[140:143], v[52:55], v[132:135]
    v_add_u32 v9, 20480, v9
    ds_read_b128 v[52:55], v9
    v_mfma_f32_16x16x32_bf16 v[136:139], v[140:143], v[56:59], v[136:139]
    v_add_u32 v7, 8192, v7
    ds_read_b128 v[140:143], v7
    ds_read_b128 v[56:59], v9 offset:2048
    s_waitcnt lgkmcnt(4)
    v_mfma_f32_16x16x32_bf16 v[100:103], v[28:31], v[44:47], v[100:103]
    s_barrier
    v_mfma_f32_16x16x32_bf16 v[104:107], v[32:35], v[44:47], v[104:107]
    v_add_u32 v2, 8192, v2
    ds_read_b128 v[12:15], v2 offset:0
    v_mfma_f32_16x16x32_bf16 v[108:111], v[36:39], v[44:47], v[108:111]
    v_add_u32 v3, 8192, v3
    ds_read_b128 v[16:19], v3 offset:2048
    v_mfma_f32_16x16x32_bf16 v[112:115], v[40:43], v[44:47], v[112:115]
    v_add_u32 v4, 4294905856, v4
    ds_read_b128 v[44:47], v4 offset:0
    s_waitcnt lgkmcnt(6)
    v_mfma_f32_16x16x32_bf16 v[116:119], v[28:31], v[48:51], v[116:119]
    ds_read_b128 v[20:23], v2 offset:4096
    v_mfma_f32_16x16x32_bf16 v[120:123], v[32:35], v[48:51], v[120:123]
    ds_read_b128 v[24:27], v3 offset:6144
    v_mfma_f32_16x16x32_bf16 v[124:127], v[36:39], v[48:51], v[124:127]
    v_mfma_f32_16x16x32_bf16 v[128:131], v[40:43], v[48:51], v[128:131]
    ds_read_b128 v[48:51], v4 offset:2048
    s_waitcnt lgkmcnt(6)
    v_mfma_f32_16x16x32_bf16 v[132:135], v[140:143], v[52:55], v[132:135]
    v_add_u32 v8, 4294905856, v8
    ds_read_b128 v[52:55], v8
    v_mfma_f32_16x16x32_bf16 v[136:139], v[140:143], v[56:59], v[136:139]
    v_add_u32 v6, 8192, v6
    ds_read_b128 v[140:143], v6
    ds_read_b128 v[56:59], v8 offset:2048
    s_waitcnt lgkmcnt(4)
    v_mfma_f32_16x16x32_bf16 v[100:103], v[12:15], v[44:47], v[100:103]
    ds_read_b128 v[28:31], v3 offset:0
    v_mfma_f32_16x16x32_bf16 v[104:107], v[16:19], v[44:47], v[104:107]
    ds_read_b128 v[32:35], v2 offset:2048
    v_mfma_f32_16x16x32_bf16 v[108:111], v[20:23], v[44:47], v[108:111]
    ds_read_b128 v[36:39], v3 offset:4096
    v_mfma_f32_16x16x32_bf16 v[112:115], v[24:27], v[44:47], v[112:115]
    v_add_u32 v5, 4294905856, v5
    ds_read_b128 v[44:47], v5 offset:0
    s_waitcnt lgkmcnt(7)
    v_mfma_f32_16x16x32_bf16 v[116:119], v[12:15], v[48:51], v[116:119]
    ds_read_b128 v[40:43], v2 offset:6144
    v_mfma_f32_16x16x32_bf16 v[120:123], v[16:19], v[48:51], v[120:123]
    v_mfma_f32_16x16x32_bf16 v[124:127], v[20:23], v[48:51], v[124:127]
    v_mfma_f32_16x16x32_bf16 v[128:131], v[24:27], v[48:51], v[128:131]
    ds_read_b128 v[48:51], v5 offset:2048
    s_waitcnt lgkmcnt(6)
    v_mfma_f32_16x16x32_bf16 v[132:135], v[140:143], v[52:55], v[132:135]
    v_add_u32 v9, 4294905856, v9
    ds_read_b128 v[52:55], v9
    v_mfma_f32_16x16x32_bf16 v[136:139], v[140:143], v[56:59], v[136:139]
    v_add_u32 v7, 8192, v7
    ds_read_b128 v[140:143], v7
    ds_read_b128 v[56:59], v9 offset:2048
    s_waitcnt lgkmcnt(4)
    v_mfma_f32_16x16x32_bf16 v[100:103], v[28:31], v[44:47], v[100:103]
    s_barrier
    v_mfma_f32_16x16x32_bf16 v[104:107], v[32:35], v[44:47], v[104:107]
    v_add_u32 v2, 8192, v2
    ds_read_b128 v[12:15], v2 offset:0
    v_mfma_f32_16x16x32_bf16 v[108:111], v[36:39], v[44:47], v[108:111]
    v_add_u32 v3, 8192, v3
    ds_read_b128 v[16:19], v3 offset:2048
    v_mfma_f32_16x16x32_bf16 v[112:115], v[40:43], v[44:47], v[112:115]
    v_add_u32 v4, 20480, v4
    ds_read_b128 v[44:47], v4 offset:0
    s_waitcnt lgkmcnt(6)
    v_mfma_f32_16x16x32_bf16 v[116:119], v[28:31], v[48:51], v[116:119]
    ds_read_b128 v[20:23], v2 offset:4096
    v_mfma_f32_16x16x32_bf16 v[120:123], v[32:35], v[48:51], v[120:123]
    ds_read_b128 v[24:27], v3 offset:6144
    v_mfma_f32_16x16x32_bf16 v[124:127], v[36:39], v[48:51], v[124:127]
    v_mfma_f32_16x16x32_bf16 v[128:131], v[40:43], v[48:51], v[128:131]
    ds_read_b128 v[48:51], v4 offset:2048
    s_waitcnt lgkmcnt(6)
    v_mfma_f32_16x16x32_bf16 v[132:135], v[140:143], v[52:55], v[132:135]
    v_add_u32 v8, 20480, v8
    ds_read_b128 v[52:55], v8
    v_mfma_f32_16x16x32_bf16 v[136:139], v[140:143], v[56:59], v[136:139]
    v_add_u32 v6, 8192, v6
    ds_read_b128 v[140:143], v6
    ds_read_b128 v[56:59], v8 offset:2048
    s_waitcnt lgkmcnt(4)
    v_mfma_f32_16x16x32_bf16 v[100:103], v[12:15], v[44:47], v[100:103]
    ds_read_b128 v[28:31], v3 offset:0
    v_mfma_f32_16x16x32_bf16 v[104:107], v[16:19], v[44:47], v[104:107]
    ds_read_b128 v[32:35], v2 offset:2048
    v_mfma_f32_16x16x32_bf16 v[108:111], v[20:23], v[44:47], v[108:111]
    ds_read_b128 v[36:39], v3 offset:4096
    v_mfma_f32_16x16x32_bf16 v[112:115], v[24:27], v[44:47], v[112:115]
    v_add_u32 v5, 20480, v5
    ds_read_b128 v[44:47], v5 offset:0
    s_waitcnt lgkmcnt(7)
    v_mfma_f32_16x16x32_bf16 v[116:119], v[12:15], v[48:51], v[116:119]
    ds_read_b128 v[40:43], v2 offset:6144
    v_mfma_f32_16x16x32_bf16 v[120:123], v[16:19], v[48:51], v[120:123]
    v_mfma_f32_16x16x32_bf16 v[124:127], v[20:23], v[48:51], v[124:127]
    v_mfma_f32_16x16x32_bf16 v[128:131], v[24:27], v[48:51], v[128:131]
    ds_read_b128 v[48:51], v5 offset:2048
    s_waitcnt lgkmcnt(6)
    v_mfma_f32_16x16x32_bf16 v[132:135], v[140:143], v[52:55], v[132:135]
    v_add_u32 v9, 20480, v9
    ds_read_b128 v[52:55], v9
    v_mfma_f32_16x16x32_bf16 v[136:139], v[140:143], v[56:59], v[136:139]
    v_add_u32 v7, 8192, v7
    ds_read_b128 v[140:143], v7
    ds_read_b128 v[56:59], v9 offset:2048
    s_waitcnt lgkmcnt(4)
    v_mfma_f32_16x16x32_bf16 v[100:103], v[28:31], v[44:47], v[100:103]
    v_mfma_f32_16x16x32_bf16 v[104:107], v[32:35], v[44:47], v[104:107]
    v_mfma_f32_16x16x32_bf16 v[108:111], v[36:39], v[44:47], v[108:111]
    v_mfma_f32_16x16x32_bf16 v[112:115], v[40:43], v[44:47], v[112:115]
    s_waitcnt lgkmcnt(3)
    v_mfma_f32_16x16x32_bf16 v[116:119], v[28:31], v[48:51], v[116:119]
    v_mfma_f32_16x16x32_bf16 v[120:123], v[32:35], v[48:51], v[120:123]
    v_mfma_f32_16x16x32_bf16 v[124:127], v[36:39], v[48:51], v[124:127]
    v_mfma_f32_16x16x32_bf16 v[128:131], v[40:43], v[48:51], v[128:131]
    s_waitcnt lgkmcnt(0)
    v_mfma_f32_16x16x32_bf16 v[132:135], v[140:143], v[52:55], v[132:135]
    v_mfma_f32_16x16x32_bf16 v[136:139], v[140:143], v[56:59], v[136:139]
    s_nop 6
    ds_write_b128 v10, v[132:135] offset:0
    ds_write_b128 v10, v[136:139] offset:4096
    s_waitcnt lgkmcnt(0)
    s_branch p1_done
p1_done:
    s_waitcnt lgkmcnt(0)
    v_lshlrev_b32 v2, 4, v1
    s_and_b32 s26, s2, 7
    s_lshl_b32 s26, s26, 2
    s_bfe_u32 s13, s2, 0x20003
    s_add_u32 s26, s26, s13
    s_lshr_b32 s27, s2, 5
    s_cmp_lt_u32 s3, 8
    s_cbranch_scc1 k2_att
    s_sub_u32 s36, s3, 8
    s_add_u32 s28, s19, s36
    s_lshl_b32 s37, s20, 4
    s_add_u32 s37, s37, s3
    s_lshl_b32 s40, s18, 2
    s_lshr_b32 s13, s23, 1
    s_add_u32 s40, s40, s13
    s_mul_i32 s40, s40, 8704
    s_add_u32 s40, s40, 16343040
    v_lshlrev_b32 v5, 2, v1
    v_and_b32 v6, 15, v1
    v_lshlrev_b32 v6, 3, v6
    v_mul_u32_u24 v8, 3641, v1
    v_lshrrev_b32 v8, 16, v8
    v_mul_u32_u24 v8, 8928, v8
    s_mul_i32 s13, s26, 288
    v_add3_u32 v8, v8, v2, s13
    v_mul_u32_u24 v9, 3450, v1
    v_lshrrev_b32 v9, 16, v9
    v_mul_u32_u24 v10, 19, v9
    v_sub_u32 v10, v1, v10
    v_cmp_eq_u32 vcc, 18, v10
    v_lshl_add_u32 v10, v10, 4, s13
    v_mov_b32 v11, 9216
    v_cndmask_b32 v10, v10, v11, vcc
    v_mul_u32_u24 v9, 9344, v9
    v_add_u32 v9, v9, v10
    s_mov_b32 s44, -1
    s_mov_b32 s45, 4194303
    s_mov_b32 s46, -1
    s_mov_b32 s47, 33554431
    s_mul_i32 s42, s36, 3
    s_lshl_b32 s17, s23, 8
    s_add_u32 s17, s17, 17469440
    s_barrier
    s_setprio 3
    s_cmp_lg_u32 s37, 27
    s_cbranch_scc1 p2_h_no5
    ds_read_b128 v[132:135], v2 offset:24576
    ds_read_b128 v[136:139], v2 offset:25600
    ds_read_b128 v[140:143], v2 offset:26624
    ds_read_b128 v[144:147], v2 offset:27648
    ds_read_b128 v[148:151], v2 offset:28672
    ds_read_b128 v[152:155], v2 offset:29696
    ds_read_b128 v[156:159], v2 offset:30720
    ds_read_b128 v[160:163], v2 offset:31744
p2_h_no5:
    v_pk_fma_f32 v[16:17], v[78:79], v[100:101], v[102:103] op_sel:[0,0,0] op_sel_hi:[0,1,1]
    v_pk_fma_f32 v[18:19], v[78:79], v[116:117], v[118:119] op_sel:[0,0,0] op_sel_hi:[0,1,1]
    v_pk_fma_f32 v[16:17], v[78:79], v[116:117], v[16:17] op_sel:[1,0,0] op_sel_hi:[1,1,1] neg_lo:[1,0,0] neg_hi:[1,0,0]
    v_pk_fma_f32 v[18:19], v[78:79], v[100:101], v[18:19] op_sel:[1,0,0] op_sel_hi:[1,1,1]
    v_pk_fma_f32 v[12:13], v[78:79], v[16:17], v[104:105] op_sel:[0,0,0] op_sel_hi:[0,1,1]
    v_pk_fma_f32 v[14:15], v[78:79], v[18:19], v[120:121] op_sel:[0,0,0] op_sel_hi:[0,1,1]
    v_pk_fma_f32 v[12:13], v[78:79], v[18:19], v[12:13] op_sel:[1,0,0] op_sel_hi:[1,1,1] neg_lo:[1,0,0] neg_hi:[1,0,0]
    v_pk_fma_f32 v[14:15], v[78:79], v[16:17], v[14:15] op_sel:[1,0,0] op_sel_hi:[1,1,1]
    v_pk_fma_f32 v[16:17], v[78:79], v[12:13], v[106:107] op_sel:[0,0,0] op_sel_hi:[0,1,1]
    v_pk_fma_f32 v[18:19], v[78:79], v[14:15], v[122:123] op_sel:[0,0,0] op_sel_hi:[0,1,1]
    v_pk_fma_f32 v[16:17], v[78:79], v[14:15], v[16:17] op_sel:[1,0,0] op_sel_hi:[1,1,1] neg_lo:[1,0,0] neg_hi:[1,0,0]
    v_pk_fma_f32 v[18:19], v[78:79], v[12:13], v[18:19] op_sel:[1,0,0] op_sel_hi:[1,1,1]
    v_pk_fma_f32 v[12:13], v[78:79], v[16:17], v[108:109] op_sel:[0,0,0] op_sel_hi:[0,1,1]
    v_pk_fma_f32 v[14:15], v[78:79], v[18:19], v[124:125] op_sel:[0,0,0] op_sel_hi:[0,1,1]
    v_pk_fma_f32 v[12:13], v[78:79], v[18:19], v[12:13] op_sel:[1,0,0] op_sel_hi:[1,1,1] neg_lo:[1,0,0] neg_hi:[1,0,0]
    v_pk_fma_f32 v[14:15], v[78:79], v[16:17], v[14:15] op_sel:[1,0,0] op_sel_hi:[1,1,1]
    v_pk_fma_f32 v[16:17], v[78:79], v[12:13], v[110:111] op_sel:[0,0,0] op_sel_hi:[0,1,1]
    v_pk_fma_f32 v[18:19], v[78:79], v[14:15], v[126:127] op_sel:[0,0,0] op_sel_hi:[0,1,1]
    v_pk_fma_f32 v[16:17], v[78:79], v[14:15], v[16:17] op_sel:[1,0,0] op_sel_hi:[1,1,1] neg_lo:[1,0,0] neg_hi:[1,0,0]
    v_pk_fma_f32 v[18:19], v[78:79], v[12:13], v[18:19] op_sel:[1,0,0] op_sel_hi:[1,1,1]
    v_pk_fma_f32 v[12:13], v[78:79], v[16:17], v[112:113] op_sel:[0,0,0] op_sel_hi:[0,1,1]
    v_pk_fma_f32 v[14:15], v[78:79], v[18:19], v[128:129] op_sel:[0,0,0] op_sel_hi:[0,1,1]
    v_pk_fma_f32 v[12:13], v[78:79], v[18:19], v[12:13] op_sel:[1,0,0] op_sel_hi:[1,1,1] neg_lo:[1,0,0] neg_hi:[1,0,0]
    v_pk_fma_f32 v[14:15], v[78:79], v[16:17], v[14:15] op_sel:[1,0,0] op_sel_hi:[1,1,1]
    v_pk_fma_f32 v[16:17], v[78:79], v[12:13], v[114:115] op_sel:[0,0,0] op_sel_hi:[0,1,1]
    v_pk_fma_f32 v[18:19], v[78:79], v[14:15], v[130:131] op_sel:[0,0,0] op_sel_hi:[0,1,1]
    v_pk_fma_f32 v[16:17], v[78:79], v[14:15], v[16:17] op_sel:[1,0,0] op_sel_hi:[1,1,1] neg_lo:[1,0,0] neg_hi:[1,0,0]
    v_pk_fma_f32 v[18:19], v[78:79], v[12:13], v[18:19] op_sel:[1,0,0] op_sel_hi:[1,1,1]
    v_fma_f32 v20, v76, v16, v17
    v_fma_f32 v21, v76, v18, v19
    v_fma_f32 v20, -v77, v18, v20
    v_fmac_f32 v21, v77, v16
    v_add_u32 v7, 192, v5
    ds_bpermute_b32 v22, v7, v20
    ds_bpermute_b32 v23, v7, v21
    v_add_u32 v7, 128, v5
    ds_bpermute_b32 v24, v7, v20
    ds_bpermute_b32 v25, v7, v21
    v_add_u32 v7, 64, v5
    ds_bpermute_b32 v26, v7, v20
    ds_bpermute_b32 v27, v7, v21
    s_lshl_b32 s13, s28, 7
    s_mul_i32 s14, s18, 4608
    s_add_u32 s13, s13, s14
    s_add_u32 s13, s13, 16195584
    s_waitcnt lgkmcnt(0)
    s_mov_b64 exec, 0xffff
    v_mov_b32 v22, 0
    v_mov_b32 v23, 0
    s_mov_b32 exec_lo, -1
    v_mov_b32 v24, 0
    v_mov_b32 v25, 0
    s_mov_b32 exec_hi, 0xffff
    v_mov_b32 v26, 0
    v_mov_b32 v27, 0
    s_mov_b64 exec, -1
    v_pk_fma_f32 v[24:25], v[80:81], v[26:27], v[24:25] op_sel:[0,0,0] op_sel_hi:[0,1,1]
    v_pk_fma_f32 v[24:25], v[80:81], v[26:27], v[24:25] op_sel:[1,1,0] op_sel_hi:[1,0,1] neg_lo:[1,0,0]
    v_pk_fma_f32 v[72:73], v[80:81], v[24:25], v[22:23] op_sel:[0,0,0] op_sel_hi:[0,1,1]
    v_pk_fma_f32 v[72:73], v[80:81], v[24:25], v[72:73] op_sel:[1,1,0] op_sel_hi:[1,0,1] neg_lo:[1,0,0]
    v_pk_fma_f32 v[20:21], v[80:81], v[72:73], v[20:21] op_sel:[0,0,0] op_sel_hi:[0,1,1]
    v_pk_fma_f32 v[20:21], v[80:81], v[72:73], v[20:21] op_sel:[1,1,0] op_sel_hi:[1,0,1] neg_lo:[1,0,0]
    s_mov_b32 exec_lo, 0
    s_mov_b32 exec_hi, 0xffff0000
    buffer_store_dwordx2 v[20:21], v6, s[4:7], s13 offen sc1
    s_mov_b64 exec, -1
    s_cmp_lg_u32 s36, 3
    s_cbranch_scc1 p2_h_noc
    v_mov_b32 v12, v88
    v_mov_b32 v13, v89
    v_mov_b32 v14, v90
    v_and_b32 v15, 48, v1
    v_cvt_f32_u32 v15, v15
    v_lshlrev_b32 v12, 16, v12
    v_lshlrev_b32 v13, 16, v13
    v_lshlrev_b32 v14, 16, v14
    v_mul_f32 v14, 0x3fb8aa3b, v14
    v_exp_f32 v14, v14
    s_nop 0
    v_cvt_pk_bf16_f32 v14, v14, v14
    v_and_b32 v14, 0xffff0000, v14
    v_mul_f32 v12, v14, v12
    v_mul_f32 v13, v14, v13
    v_mul_f32 v12, 0x3fb8aa3b, v12
    v_mul_f32 v13, 0x3e22f983, v13
    v_mul_f32 v14, 0x3f800000, v12
    v_mul_f32 v89, 0x3f800000, v13
    v_exp_f32 v14, v14
    v_fract_f32 v89, v89
    v_cos_f32 v88, v89
    v_sin_f32 v89, v89
    v_mul_f32 v88, v14, v88
    v_mul_f32 v89, v14, v89
    v_mul_f32 v14, 0x40000000, v12
    v_mul_f32 v91, 0x40000000, v13
    v_exp_f32 v14, v14
    v_fract_f32 v91, v91
    v_cos_f32 v90, v91
    v_sin_f32 v91, v91
    v_mul_f32 v90, v14, v90
    v_mul_f32 v91, v14, v91
    v_mul_f32 v14, 0x41800000, v12
    v_mul_f32 v93, 0x41800000, v13
    v_exp_f32 v14, v14
    v_fract_f32 v93, v93
    v_cos_f32 v92, v93
    v_sin_f32 v93, v93
    v_mul_f32 v92, v14, v92
    v_mul_f32 v93, v14, v93
    v_mul_f32 v14, 0x42800000, v12
    v_mul_f32 v95, 0x42800000, v13
    v_exp_f32 v14, v14
    v_fract_f32 v95, v95
    v_cos_f32 v94, v95
    v_sin_f32 v95, v95
    v_mul_f32 v94, v14, v94
    v_mul_f32 v95, v14, v95
    v_mul_f32 v14, 0x44000000, v12
    v_mul_f32 v97, 0x44000000, v13
    v_exp_f32 v14, v14
    v_fract_f32 v97, v97
    v_cos_f32 v96, v97
    v_sin_f32 v97, v97
    v_mul_f32 v96, v14, v96
    v_mul_f32 v97, v14, v97
    v_mul_f32 v14, v15, v12
    v_mul_f32 v99, v15, v13
    v_exp_f32 v14, v14
    v_fract_f32 v99, v99
    v_cos_f32 v98, v99
    v_sin_f32 v99, v99
    v_mul_f32 v98, v14, v98
    v_mul_f32 v99, v14, v99
p2_h_noc:
    s_barrier
    s_cmp_lg_u32 s37, 27
    s_cbranch_scc1 p2_h_one
    v_pk_fma_f32 v[16:17], v[90:91], v[132:133], v[134:135] op_sel:[0,0,0] op_sel_hi:[0,1,1]
    v_pk_fma_f32 v[18:19], v[90:91], v[148:149], v[150:151] op_sel:[0,0,0] op_sel_hi:[0,1,1]
    v_pk_fma_f32 v[16:17], v[90:91], v[148:149], v[16:17] op_sel:[1,0,0] op_sel_hi:[1,1,1] neg_lo:[1,0,0] neg_hi:[1,0,0]
    v_pk_fma_f32 v[18:19], v[90:91], v[132:133], v[18:19] op_sel:[1,0,0] op_sel_hi:[1,1,1]
    v_pk_fma_f32 v[12:13], v[90:91], v[16:17], v[136:137] op_sel:[0,0,0] op_sel_hi:[0,1,1]
    v_pk_fma_f32 v[14:15], v[90:91], v[18:19], v[152:153] op_sel:[0,0,0] op_sel_hi:[0,1,1]
    v_pk_fma_f32 v[12:13], v[90:91], v[18:19], v[12:13] op_sel:[1,0,0] op_sel_hi:[1,1,1] neg_lo:[1,0,0] neg_hi:[1,0,0]
    v_pk_fma_f32 v[14:15], v[90:91], v[16:17], v[14:15] op_sel:[1,0,0] op_sel_hi:[1,1,1]
    v_pk_fma_f32 v[16:17], v[90:91], v[12:13], v[138:139] op_sel:[0,0,0] op_sel_hi:[0,1,1]
    v_pk_fma_f32 v[18:19], v[90:91], v[14:15], v[154:155] op_sel:[0,0,0] op_sel_hi:[0,1,1]
    v_pk_fma_f32 v[16:17], v[90:91], v[14:15], v[16:17] op_sel:[1,0,0] op_sel_hi:[1,1,1] neg_lo:[1,0,0] neg_hi:[1,0,0]
    v_pk_fma_f32 v[18:19], v[90:91], v[12:13], v[18:19] op_sel:[1,0,0] op_sel_hi:[1,1,1]
    v_pk_fma_f32 v[12:13], v[90:91], v[16:17], v[140:141] op_sel:[0,0,0] op_sel_hi:[0,1,1]
    v_pk_fma_f32 v[14:15], v[90:91], v[18:19], v[156:157] op_sel:[0,0,0] op_sel_hi:[0,1,1]
    v_pk_fma_f32 v[12:13], v[90:91], v[18:19], v[12:13] op_sel:[1,0,0] op_sel_hi:[1,1,1] neg_lo:[1,0,0] neg_hi:[1,0,0]
    v_pk_fma_f32 v[14:15], v[90:91], v[16:17], v[14:15] op_sel:[1,0,0] op_sel_hi:[1,1,1]
    v_pk_fma_f32 v[16:17], v[90:91], v[12:13], v[142:143] op_sel:[0,0,0] op_sel_hi:[0,1,1]
    v_pk_fma_f32 v[18:19], v[90:91], v[14:15], v[158:159] op_sel:[0,0,0] op_sel_hi:[0,1,1]
    v_pk_fma_f32 v[16:17], v[90:91], v[14:15], v[16:17] op_sel:[1,0,0] op_sel_hi:[1,1,1] neg_lo:[1,0,0] neg_hi:[1,0,0]
    v_pk_fma_f32 v[18:19], v[90:91], v[12:13], v[18:19] op_sel:[1,0,0] op_sel_hi:[1,1,1]
    v_pk_fma_f32 v[12:13], v[90:91], v[16:17], v[144:145] op_sel:[0,0,0] op_sel_hi:[0,1,1]
    v_pk_fma_f32 v[14:15], v[90:91], v[18:19], v[160:161] op_sel:[0,0,0] op_sel_hi:[0,1,1]
    v_pk_fma_f32 v[12:13], v[90:91], v[18:19], v[12:13] op_sel:[1,0,0] op_sel_hi:[1,1,1] neg_lo:[1,0,0] neg_hi:[1,0,0]
    v_pk_fma_f32 v[14:15], v[90:91], v[16:17], v[14:15] op_sel:[1,0,0] op_sel_hi:[1,1,1]
    v_pk_fma_f32 v[16:17], v[90:91], v[12:13], v[146:147] op_sel:[0,0,0] op_sel_hi:[0,1,1]
    v_pk_fma_f32 v[18:19], v[90:91], v[14:15], v[162:163] op_sel:[0,0,0] op_sel_hi:[0,1,1]
    v_pk_fma_f32 v[16:17], v[90:91], v[14:15], v[16:17] op_sel:[1,0,0] op_sel_hi:[1,1,1] neg_lo:[1,0,0] neg_hi:[1,0,0]
    v_pk_fma_f32 v[18:19], v[90:91], v[12:13], v[18:19] op_sel:[1,0,0] op_sel_hi:[1,1,1]
    v_fma_f32 v20, v88, v16, v17
    v_fma_f32 v21, v88, v18, v19
    v_fma_f32 v20, -v89, v18, v20
    v_fmac_f32 v21, v89, v16
    v_add_u32 v7, 192, v5
    ds_bpermute_b32 v22, v7, v20
    ds_bpermute_b32 v23, v7, v21
    v_add_u32 v7, 128, v5
    ds_bpermute_b32 v24, v7, v20
    ds_bpermute_b32 v25, v7, v21
    v_add_u32 v7, 64, v5
    ds_bpermute_b32 v26, v7, v20
    ds_bpermute_b32 v27, v7, v21
    s_lshl_b32 s13, s28, 7
    s_mul_i32 s14, s18, 4608
    s_add_u32 s13, s13, s14
    s_add_u32 s13, s13, 16195712
    s_waitcnt lgkmcnt(0)
    s_mov_b64 exec, 0xffff
    v_mov_b32 v22, 0
    v_mov_b32 v23, 0
    s_mov_b32 exec_lo, -1
    v_mov_b32 v24, 0
    v_mov_b32 v25, 0
    s_mov_b32 exec_hi, 0xffff
    v_mov_b32 v26, 0
    v_mov_b32 v27, 0
    s_mov_b64 exec, -1
    v_pk_fma_f32 v[24:25], v[92:93], v[26:27], v[24:25] op_sel:[0,0,0] op_sel_hi:[0,1,1]
    v_pk_fma_f32 v[24:25], v[92:93], v[26:27], v[24:25] op_sel:[1,1,0] op_sel_hi:[1,0,1] neg_lo:[1,0,0]
    v_pk_fma_f32 v[74:75], v[92:93], v[24:25], v[22:23] op_sel:[0,0,0] op_sel_hi:[0,1,1]
    v_pk_fma_f32 v[74:75], v[92:93], v[24:25], v[74:75] op_sel:[1,1,0] op_sel_hi:[1,0,1] neg_lo:[1,0,0]
    v_pk_fma_f32 v[20:21], v[92:93], v[74:75], v[20:21] op_sel:[0,0,0] op_sel_hi:[0,1,1]
    v_pk_fma_f32 v[20:21], v[92:93], v[74:75], v[20:21] op_sel:[1,1,0] op_sel_hi:[1,0,1] neg_lo:[1,0,0]
    s_mov_b32 exec_lo, 0
    s_mov_b32 exec_hi, 0xffff0000
    buffer_store_dwordx2 v[20:21], v6, s[4:7], s13 offen sc1
    s_mov_b64 exec, -1
    buffer_store_dwordx4 v[132:135], v2, s[4:7], s40 offen offset:0 sc1
    buffer_store_dwordx4 v[136:139], v2, s[4:7], s40 offen offset:1024 sc1
    buffer_store_dwordx4 v[140:143], v2, s[4:7], s40 offen offset:2048 sc1
    buffer_store_dwordx4 v[144:147], v2, s[4:7], s40 offen offset:3072 sc1
    s_add_u32 s40, s40, 4096
    buffer_store_dwordx4 v[148:151], v2, s[4:7], s40 offen offset:0 sc1
    buffer_store_dwordx4 v[152:155], v2, s[4:7], s40 offen offset:1024 sc1
    buffer_store_dwordx4 v[156:159], v2, s[4:7], s40 offen offset:2048 sc1
    buffer_store_dwordx4 v[160:163], v2, s[4:7], s40 offen offset:3072 sc1
    s_add_u32 s40, s40, 4096
    v_lshlrev_b32 v7, 3, v1
    buffer_store_dwordx2 v[74:75], v7, s[4:7], s40 offen sc1
p2_h_one:
    s_mov_b64 exec, 1
    v_mov_b32 v7, 160768
    v_mov_b32 v10, 1
    s_waitcnt vmcnt(0)
    ds_add_rtn_u32 v11, v7, v10
    s_waitcnt lgkmcnt(0)
    v_readfirstlane_b32 s14, v11
    s_mov_b64 exec, -1
    s_cmp_lg_u32 s14, 3
    s_cbranch_scc1 p2_nosig_e
    v_mov_b32 v7, 0
    v_mov_b32 v10, 1
    s_mov_b64 exec, 1
    buffer_atomic_add v10, v7, s[4:7], s17 offen sc1
    s_mov_b64 exec, -1
p2_nosig_e:
    s_mul_i32 s14, s42, 288
    s_mul_i32 s15, s42, 9216
    s_add_u32 m0, s14, 20736
    s_add_u32 s15, s15, 3022848
    s_mov_b64 exec, s[44:45]
    buffer_load_dwordx4 v8, s[4:7], s15 offen sc1 lds
    s_mul_i32 s14, s42, 304
    s_mul_i32 s15, s42, 9344
    s_add_u32 m0, s14, 95616
    s_add_u32 s15, s15, 5391360
    s_mov_b64 exec, s[46:47]
    buffer_load_dwordx4 v9, s[4:7], s15 offen sc1 lds
    s_mul_i32 s14, s42, 288
    s_mul_i32 s15, s42, 9216
    s_add_u32 m0, s14, 24192
    s_add_u32 s15, s15, 3133440
    s_mov_b64 exec, s[44:45]
    buffer_load_dwordx4 v8, s[4:7], s15 offen sc1 lds
    s_mul_i32 s14, s42, 304
    s_mul_i32 s15, s42, 9344
    s_add_u32 m0, s14, 99264
    s_add_u32 s15, s15, 5503488
    s_mov_b64 exec, s[46:47]
    buffer_load_dwordx4 v9, s[4:7], s15 offen sc1 lds
    s_mul_i32 s14, s42, 288
    s_mul_i32 s15, s42, 9216
    s_add_u32 m0, s14, 27648
    s_add_u32 s15, s15, 3244032
    s_mov_b64 exec, s[44:45]
    buffer_load_dwordx4 v8, s[4:7], s15 offen sc1 lds
    s_mul_i32 s14, s42, 304
    s_mul_i32 s15, s42, 9344
    s_add_u32 m0, s14, 102912
    s_add_u32 s15, s15, 5615616
    s_mov_b64 exec, s[46:47]
    buffer_load_dwordx4 v9, s[4:7], s15 offen sc1 lds
    s_mul_i32 s14, s42, 288
    s_mul_i32 s15, s42, 9216
    s_add_u32 m0, s14, 31104
    s_add_u32 s15, s15, 3354624
    s_mov_b64 exec, s[44:45]
    buffer_load_dwordx4 v8, s[4:7], s15 offen sc1 lds
    s_mul_i32 s14, s42, 304
    s_mul_i32 s15, s42, 9344
    s_add_u32 m0, s14, 106560
    s_add_u32 s15, s15, 5727744
    s_mov_b64 exec, s[46:47]
    buffer_load_dwordx4 v9, s[4:7], s15 offen sc1 lds
    s_mul_i32 s14, s42, 288
    s_mul_i32 s15, s42, 9216
    s_add_u32 m0, s14, 34560
    s_add_u32 s15, s15, 3465216
    s_mov_b64 exec, s[44:45]
    buffer_load_dwordx4 v8, s[4:7], s15 offen sc1 lds
    s_mul_i32 s14, s42, 304
    s_mul_i32 s15, s42, 9344
    s_add_u32 m0, s14, 110208
    s_add_u32 s15, s15, 5839872
    s_mov_b64 exec, s[46:47]
    buffer_load_dwordx4 v9, s[4:7], s15 offen sc1 lds
    s_mul_i32 s14, s42, 288
    s_mul_i32 s15, s42, 9216
    s_add_u32 m0, s14, 38016
    s_add_u32 s15, s15, 3575808
    s_mov_b64 exec, s[44:45]
    buffer_load_dwordx4 v8, s[4:7], s15 offen sc1 lds
    s_mul_i32 s14, s42, 304
    s_mul_i32 s15, s42, 9344
    s_add_u32 m0, s14, 113856
    s_add_u32 s15, s15, 5952000
    s_mov_b64 exec, s[46:47]
    buffer_load_dwordx4 v9, s[4:7], s15 offen sc1 lds
    s_mul_i32 s14, s42, 288
    s_mul_i32 s15, s42, 9216
    s_add_u32 m0, s14, 41472
    s_add_u32 s15, s15, 3686400
    s_mov_b64 exec, s[44:45]
    buffer_load_dwordx4 v8, s[4:7], s15 offen sc1 lds
    s_mul_i32 s14, s42, 304
    s_mul_i32 s15, s42, 9344
    s_add_u32 m0, s14, 117504
    s_add_u32 s15, s15, 6064128
    s_mov_b64 exec, s[46:47]
    buffer_load_dwordx4 v9, s[4:7], s15 offen sc1 lds
    s_mul_i32 s14, s42, 288
    s_mul_i32 s15, s42, 9216
    s_add_u32 m0, s14, 44928
    s_add_u32 s15, s15, 3796992
    s_mov_b64 exec, s[44:45]
    buffer_load_dwordx4 v8, s[4:7], s15 offen sc1 lds
    s_mul_i32 s14, s42, 304
    s_mul_i32 s15, s42, 9344
    s_add_u32 m0, s14, 121152
    s_add_u32 s15, s15, 6176256
    s_mov_b64 exec, s[46:47]
    buffer_load_dwordx4 v9, s[4:7], s15 offen sc1 lds
    s_mul_i32 s14, s42, 288
    s_mul_i32 s15, s42, 9216
    s_add_u32 m0, s14, 48384
    s_add_u32 s15, s15, 3907584
    s_mov_b64 exec, s[44:45]
    buffer_load_dwordx4 v8, s[4:7], s15 offen sc1 lds
    s_mul_i32 s14, s42, 304
    s_mul_i32 s15, s42, 9344
    s_add_u32 m0, s14, 124800
    s_add_u32 s15, s15, 6288384
    s_mov_b64 exec, s[46:47]
    buffer_load_dwordx4 v9, s[4:7], s15 offen sc1 lds
    s_mul_i32 s14, s42, 288
    s_mul_i32 s15, s42, 9216
    s_add_u32 m0, s14, 51840
    s_add_u32 s15, s15, 4018176
    s_mov_b64 exec, s[44:45]
    buffer_load_dwordx4 v8, s[4:7], s15 offen sc1 lds
    s_mul_i32 s14, s42, 304
    s_mul_i32 s15, s42, 9344
    s_add_u32 m0, s14, 128448
    s_add_u32 s15, s15, 6400512
    s_mov_b64 exec, s[46:47]
    buffer_load_dwordx4 v9, s[4:7], s15 offen sc1 lds
    s_mul_i32 s14, s42, 288
    s_mul_i32 s15, s42, 9216
    s_add_u32 m0, s14, 55296
    s_add_u32 s15, s15, 4128768
    s_mov_b64 exec, s[44:45]
    buffer_load_dwordx4 v8, s[4:7], s15 offen sc1 lds
    s_mul_i32 s14, s42, 304
    s_mul_i32 s15, s42, 9344
    s_add_u32 m0, s14, 132096
    s_add_u32 s15, s15, 6512640
    s_mov_b64 exec, s[46:47]
    buffer_load_dwordx4 v9, s[4:7], s15 offen sc1 lds
    s_mul_i32 s14, s42, 288
    s_mul_i32 s15, s42, 9216
    s_add_u32 m0, s14, 58752
    s_add_u32 s15, s15, 4239360
    s_mov_b64 exec, s[44:45]
    buffer_load_dwordx4 v8, s[4:7], s15 offen sc1 lds
    s_mul_i32 s14, s42, 304
    s_mul_i32 s15, s42, 9344
    s_add_u32 m0, s14, 135744
    s_add_u32 s15, s15, 6624768
    s_mov_b64 exec, s[46:47]
    buffer_load_dwordx4 v9, s[4:7], s15 offen sc1 lds
    s_mul_i32 s14, s42, 288
    s_mul_i32 s15, s42, 9216
    s_add_u32 m0, s14, 62208
    s_add_u32 s15, s15, 4349952
    s_mov_b64 exec, s[44:45]
    buffer_load_dwordx4 v8, s[4:7], s15 offen sc1 lds
    s_mul_i32 s14, s42, 304
    s_mul_i32 s15, s42, 9344
    s_add_u32 m0, s14, 139392
    s_add_u32 s15, s15, 6736896
    s_mov_b64 exec, s[46:47]
    buffer_load_dwordx4 v9, s[4:7], s15 offen sc1 lds
    s_mul_i32 s14, s42, 288
    s_mul_i32 s15, s42, 9216
    s_add_u32 m0, s14, 65664
    s_add_u32 s15, s15, 4460544
    s_mov_b64 exec, s[44:45]
    buffer_load_dwordx4 v8, s[4:7], s15 offen sc1 lds
    s_mul_i32 s14, s42, 304
    s_mul_i32 s15, s42, 9344
    s_add_u32 m0, s14, 143040
    s_add_u32 s15, s15, 6849024
    s_mov_b64 exec, s[46:47]
    buffer_load_dwordx4 v9, s[4:7], s15 offen sc1 lds
    s_mul_i32 s14, s42, 288
    s_mul_i32 s15, s42, 9216
    s_add_u32 m0, s14, 69120
    s_add_u32 s15, s15, 4571136
    s_mov_b64 exec, s[44:45]
    buffer_load_dwordx4 v8, s[4:7], s15 offen sc1 lds
    s_mul_i32 s14, s42, 304
    s_mul_i32 s15, s42, 9344
    s_add_u32 m0, s14, 146688
    s_add_u32 s15, s15, 6961152
    s_mov_b64 exec, s[46:47]
    buffer_load_dwordx4 v9, s[4:7], s15 offen sc1 lds
    s_min_u32 s42, s42, 1
    s_mul_i32 s14, s42, 288
    s_mul_i32 s15, s42, 9216
    s_add_u32 m0, s14, 72576
    s_add_u32 s15, s15, 4681728
    s_mov_b64 exec, s[44:45]
    buffer_load_dwordx4 v8, s[4:7], s15 offen sc1 lds
    s_mul_i32 s14, s42, 304
    s_mul_i32 s15, s42, 9344
    s_add_u32 m0, s14, 150336
    s_add_u32 s15, s15, 7073280
    s_mov_b64 exec, s[46:47]
    buffer_load_dwordx4 v9, s[4:7], s15 offen sc1 lds
    s_waitcnt vmcnt(0)
    s_mov_b64 exec, 1
    v_mov_b32 v10, 160780
    v_mov_b32 v11, 1
    ds_add_u32 v10, v11
    s_mov_b64 exec, -1
    s_add_u32 s48, s4, 16195584
    s_addc_u32 s49, s5, 0
    s_mov_b32 s50, 147456
    s_mov_b32 s51, 0x20000
    s_mov_b64 exec, 1
    v_mov_b32 v7, 0
    s_mov_b32 s21, 0
poll_e:
    buffer_load_dword v10, v7, s[4:7], s17 offen sc1
    s_add_u32 s21, s21, 1
    s_waitcnt vmcnt(0)
    v_cmp_gt_u32 vcc, 32, v10
    s_cbranch_vccz polled_e
    s_sleep 4
    s_cmp_lt_u32 s21, 524288
    s_cbranch_scc1 poll_e
polled_e:
    s_mov_b64 exec, -1
    v_lshrrev_b32 v7, 4, v1
    v_mul_u32_u24 v7, 36864, v7
    s_sub_u32 s13, s18, 32
    s_mul_i32 s13, s13, 4608
    s_lshl_b32 s14, s28, 7
    s_add_u32 s13, s13, s14
    v_add3_u32 v6, v6, v7, s13
    v_add_u32 v7, 0, v6
    buffer_load_dwordx2 v[12:13], v7, s[48:51], 0 offen sc1
    v_add_u32 v7, 4608, v6
    buffer_load_dwordx2 v[14:15], v7, s[48:51], 0 offen sc1
    v_add_u32 v7, 9216, v6
    buffer_load_dwordx2 v[16:17], v7, s[48:51], 0 offen sc1
    v_add_u32 v7, 13824, v6
    buffer_load_dwordx2 v[18:19], v7, s[48:51], 0 offen sc1
    v_add_u32 v7, 18432, v6
    buffer_load_dwordx2 v[20:21], v7, s[48:51], 0 offen sc1
    v_add_u32 v7, 23040, v6
    buffer_load_dwordx2 v[22:23], v7, s[48:51], 0 offen sc1
    v_add_u32 v7, 27648, v6
    buffer_load_dwordx2 v[24:25], v7, s[48:51], 0 offen sc1
    v_add_u32 v7, 32256, v6
    buffer_load_dwordx2 v[26:27], v7, s[48:51], 0 offen sc1
    s_cmp_lg_u32 s37, 11
    s_cbranch_scc1 p2_h_one1
    s_sub_u32 s17, s17, 256
    s_mov_b64 exec, 1
    v_mov_b32 v7, 0
    s_mov_b32 s21, 0
poll_e2:
    buffer_load_dword v10, v7, s[4:7], s17 offen sc1
    s_add_u32 s21, s21, 1
    s_waitcnt vmcnt(0)
    v_cmp_gt_u32 vcc, 32, v10
    s_cbranch_vccz polled_e2
    s_sleep 4
    s_cmp_lt_u32 s21, 524288
    s_cbranch_scc1 poll_e2
polled_e2:
    s_mov_b64 exec, -1
    buffer_load_dwordx4 v[132:135], v2, s[4:7], s40 offen offset:0 sc1
    buffer_load_dwordx4 v[136:139], v2, s[4:7], s40 offen offset:1024 sc1
    buffer_load_dwordx4 v[140:143], v2, s[4:7], s40 offen offset:2048 sc1
    buffer_load_dwordx4 v[144:147], v2, s[4:7], s40 offen offset:3072 sc1
    s_add_u32 s40, s40, 4096
    buffer_load_dwordx4 v[148:151], v2, s[4:7], s40 offen offset:0 sc1
    buffer_load_dwordx4 v[152:155], v2, s[4:7], s40 offen offset:1024 sc1
    buffer_load_dwordx4 v[156:159], v2, s[4:7], s40 offen offset:2048 sc1
    buffer_load_dwordx4 v[160:163], v2, s[4:7], s40 offen offset:3072 sc1
    s_add_u32 s40, s40, 4096
    v_lshlrev_b32 v7, 3, v1
    buffer_load_dwordx2 v[74:75], v7, s[4:7], s40 offen sc1
    v_add_u32 v7, 4294966784, v6
    buffer_load_dwordx2 v[28:29], v7, s[48:51], 0 offen sc1
    v_add_u32 v7, 4096, v6
    buffer_load_dwordx2 v[30:31], v7, s[48:51], 0 offen sc1
    v_add_u32 v7, 8704, v6
    buffer_load_dwordx2 v[32:33], v7, s[48:51], 0 offen sc1
    v_add_u32 v7, 13312, v6
    buffer_load_dwordx2 v[34:35], v7, s[48:51], 0 offen sc1
    v_add_u32 v7, 17920, v6
    buffer_load_dwordx2 v[36:37], v7, s[48:51], 0 offen sc1
    v_add_u32 v7, 22528, v6
    buffer_load_dwordx2 v[38:39], v7, s[48:51], 0 offen sc1
    v_add_u32 v7, 27136, v6
    buffer_load_dwordx2 v[40:41], v7, s[48:51], 0 offen sc1
    v_add_u32 v7, 31744, v6
    buffer_load_dwordx2 v[42:43], v7, s[48:51], 0 offen sc1
p2_h_one1:
    v_mov_b32 v10, 160836
    s_mov_b32 s63, 2097152
lw_qq:
    ds_read_b32 v11, v10
    s_waitcnt lgkmcnt(0)
    v_readfirstlane_b32 s13, v11
    s_nop 0
    s_cmp_ge_u32 s13, 8
    s_cbranch_scc1 lw_qq_ok
    s_sleep 1
    s_sub_u32 s63, s63, 1
    s_cbranch_scc0 lw_qq
lw_qq_ok:
    v_and_b32 v5, 60, v5
    s_waitcnt vmcnt(0)
    v_pk_fma_f32 v[14:15], v[82:83], v[12:13], v[14:15] op_sel:[0,0,0] op_sel_hi:[0,1,1]
    v_pk_fma_f32 v[14:15], v[82:83], v[12:13], v[14:15] op_sel:[1,1,0] op_sel_hi:[1,0,1] neg_lo:[1,0,0]
    v_pk_fma_f32 v[16:17], v[82:83], v[14:15], v[16:17] op_sel:[0,0,0] op_sel_hi:[0,1,1]
    v_pk_fma_f32 v[16:17], v[82:83], v[14:15], v[16:17] op_sel:[1,1,0] op_sel_hi:[1,0,1] neg_lo:[1,0,0]
    v_pk_fma_f32 v[18:19], v[82:83], v[16:17], v[18:19] op_sel:[0,0,0] op_sel_hi:[0,1,1]
    v_pk_fma_f32 v[18:19], v[82:83], v[16:17], v[18:19] op_sel:[1,1,0] op_sel_hi:[1,0,1] neg_lo:[1,0,0]
    v_pk_fma_f32 v[20:21], v[82:83], v[18:19], v[20:21] op_sel:[0,0,0] op_sel_hi:[0,1,1]
    v_pk_fma_f32 v[20:21], v[82:83], v[18:19], v[20:21] op_sel:[1,1,0] op_sel_hi:[1,0,1] neg_lo:[1,0,0]
    v_pk_fma_f32 v[22:23], v[82:83], v[20:21], v[22:23] op_sel:[0,0,0] op_sel_hi:[0,1,1]
    v_pk_fma_f32 v[22:23], v[82:83], v[20:21], v[22:23] op_sel:[1,1,0] op_sel_hi:[1,0,1] neg_lo:[1,0,0]
    v_pk_fma_f32 v[24:25], v[82:83], v[22:23], v[24:25] op_sel:[0,0,0] op_sel_hi:[0,1,1]
    v_pk_fma_f32 v[24:25], v[82:83], v[22:23], v[24:25] op_sel:[1,1,0] op_sel_hi:[1,0,1] neg_lo:[1,0,0]
    v_pk_fma_f32 v[26:27], v[82:83], v[24:25], v[26:27] op_sel:[0,0,0] op_sel_hi:[0,1,1]
    v_pk_fma_f32 v[26:27], v[82:83], v[24:25], v[26:27] op_sel:[1,1,0] op_sel_hi:[1,0,1] neg_lo:[1,0,0]
    v_add_u32 v7, 0, v5
    ds_bpermute_b32 v44, v7, v26
    ds_bpermute_b32 v45, v7, v27
    v_add_u32 v7, 64, v5
    ds_bpermute_b32 v46, v7, v26
    ds_bpermute_b32 v47, v7, v27
    v_add_u32 v7, 128, v5
    ds_bpermute_b32 v48, v7, v26
    ds_bpermute_b32 v49, v7, v27
    v_add_u32 v7, 192, v5
    ds_bpermute_b32 v50, v7, v26
    ds_bpermute_b32 v51, v7, v27
    s_waitcnt lgkmcnt(0)
    v_pk_fma_f32 v[46:47], v[84:85], v[44:45], v[46:47] op_sel:[0,0,0] op_sel_hi:[0,1,1]
    v_pk_fma_f32 v[46:47], v[84:85], v[44:45], v[46:47] op_sel:[1,1,0] op_sel_hi:[1,0,1] neg_lo:[1,0,0]
    v_pk_fma_f32 v[48:49], v[84:85], v[46:47], v[48:49] op_sel:[0,0,0] op_sel_hi:[0,1,1]
    v_pk_fma_f32 v[48:49], v[84:85], v[46:47], v[48:49] op_sel:[1,1,0] op_sel_hi:[1,0,1] neg_lo:[1,0,0]
    v_pk_fma_f32 v[50:51], v[84:85], v[48:49], v[50:51] op_sel:[0,0,0] op_sel_hi:[0,1,1]
    v_pk_fma_f32 v[50:51], v[84:85], v[48:49], v[50:51] op_sel:[1,1,0] op_sel_hi:[1,0,1] neg_lo:[1,0,0]
    v_pk_fma_f32 v[72:73], v[86:87], v[50:51], v[72:73] op_sel:[0,0,0] op_sel_hi:[0,1,1]
    v_pk_fma_f32 v[72:73], v[86:87], v[50:51], v[72:73] op_sel:[1,1,0] op_sel_hi:[1,0,1] neg_lo:[1,0,0]
    s_cmp_lg_u32 s37, 11
    s_cbranch_scc1 p2_h_one2
    v_pk_fma_f32 v[30:31], v[94:95], v[28:29], v[30:31] op_sel:[0,0,0] op_sel_hi:[0,1,1]
    v_pk_fma_f32 v[30:31], v[94:95], v[28:29], v[30:31] op_sel:[1,1,0] op_sel_hi:[1,0,1] neg_lo:[1,0,0]
    v_pk_fma_f32 v[32:33], v[94:95], v[30:31], v[32:33] op_sel:[0,0,0] op_sel_hi:[0,1,1]
    v_pk_fma_f32 v[32:33], v[94:95], v[30:31], v[32:33] op_sel:[1,1,0] op_sel_hi:[1,0,1] neg_lo:[1,0,0]
    v_pk_fma_f32 v[34:35], v[94:95], v[32:33], v[34:35] op_sel:[0,0,0] op_sel_hi:[0,1,1]
    v_pk_fma_f32 v[34:35], v[94:95], v[32:33], v[34:35] op_sel:[1,1,0] op_sel_hi:[1,0,1] neg_lo:[1,0,0]
    v_pk_fma_f32 v[36:37], v[94:95], v[34:35], v[36:37] op_sel:[0,0,0] op_sel_hi:[0,1,1]
    v_pk_fma_f32 v[36:37], v[94:95], v[34:35], v[36:37] op_sel:[1,1,0] op_sel_hi:[1,0,1] neg_lo:[1,0,0]
    v_pk_fma_f32 v[38:39], v[94:95], v[36:37], v[38:39] op_sel:[0,0,0] op_sel_hi:[0,1,1]
    v_pk_fma_f32 v[38:39], v[94:95], v[36:37], v[38:39] op_sel:[1,1,0] op_sel_hi:[1,0,1] neg_lo:[1,0,0]
    v_pk_fma_f32 v[40:41], v[94:95], v[38:39], v[40:41] op_sel:[0,0,0] op_sel_hi:[0,1,1]
    v_pk_fma_f32 v[40:41], v[94:95], v[38:39], v[40:41] op_sel:[1,1,0] op_sel_hi:[1,0,1] neg_lo:[1,0,0]
    v_pk_fma_f32 v[42:43], v[94:95], v[40:41], v[42:43] op_sel:[0,0,0] op_sel_hi:[0,1,1]
    v_pk_fma_f32 v[42:43], v[94:95], v[40:41], v[42:43] op_sel:[1,1,0] op_sel_hi:[1,0,1] neg_lo:[1,0,0]
    v_add_u32 v7, 0, v5
    ds_bpermute_b32 v44, v7, v42
    ds_bpermute_b32 v45, v7, v43
    v_add_u32 v7, 64, v5
    ds_bpermute_b32 v46, v7, v42
    ds_bpermute_b32 v47, v7, v43
    v_add_u32 v7, 128, v5
    ds_bpermute_b32 v48, v7, v42
    ds_bpermute_b32 v49, v7, v43
    v_add_u32 v7, 192, v5
    ds_bpermute_b32 v50, v7, v42
    ds_bpermute_b32 v51, v7, v43
    s_waitcnt lgkmcnt(0)
    v_pk_fma_f32 v[46:47], v[96:97], v[44:45], v[46:47] op_sel:[0,0,0] op_sel_hi:[0,1,1]
    v_pk_fma_f32 v[46:47], v[96:97], v[44:45], v[46:47] op_sel:[1,1,0] op_sel_hi:[1,0,1] neg_lo:[1,0,0]
    v_pk_fma_f32 v[48:49], v[96:97], v[46:47], v[48:49] op_sel:[0,0,0] op_sel_hi:[0,1,1]
    v_pk_fma_f32 v[48:49], v[96:97], v[46:47], v[48:49] op_sel:[1,1,0] op_sel_hi:[1,0,1] neg_lo:[1,0,0]
    v_pk_fma_f32 v[50:51], v[96:97], v[48:49], v[50:51] op_sel:[0,0,0] op_sel_hi:[0,1,1]
    v_pk_fma_f32 v[50:51], v[96:97], v[48:49], v[50:51] op_sel:[1,1,0] op_sel_hi:[1,0,1] neg_lo:[1,0,0]
    v_pk_fma_f32 v[74:75], v[98:99], v[50:51], v[74:75] op_sel:[0,0,0] op_sel_hi:[0,1,1]
    v_pk_fma_f32 v[74:75], v[98:99], v[50:51], v[74:75] op_sel:[1,1,0] op_sel_hi:[1,0,1] neg_lo:[1,0,0]
    s_mul_i32 s13, s18, 72
    s_add_u32 s13, s13, s28
    s_lshl_b32 s13, s13, 11
    s_add_u32 s13, s13, 9461760
    s_add_u32 s14, s13, 73728
    v_fmac_f32 v132, v88, v74
    v_fmac_f32 v148, v88, v75
    v_fma_f32 v132, -v89, v75, v132
    v_fmac_f32 v148, v89, v74
    v_fmac_f32 v133, v88, v132
    v_fmac_f32 v149, v88, v148
    v_fma_f32 v133, -v89, v148, v133
    v_fmac_f32 v149, v89, v132
    v_cvt_pk_bf16_f32 v12, v132, v133
    v_cvt_pk_bf16_f32 v20, v148, v149
    v_fmac_f32 v134, v88, v133
    v_fmac_f32 v150, v88, v149
    v_fma_f32 v134, -v89, v149, v134
    v_fmac_f32 v150, v89, v133
    v_fmac_f32 v135, v88, v134
    v_fmac_f32 v151, v88, v150
    v_fma_f32 v135, -v89, v150, v135
    v_fmac_f32 v151, v89, v134
    v_cvt_pk_bf16_f32 v13, v134, v135
    v_cvt_pk_bf16_f32 v21, v150, v151
    v_fmac_f32 v136, v88, v135
    v_fmac_f32 v152, v88, v151
    v_fma_f32 v136, -v89, v151, v136
    v_fmac_f32 v152, v89, v135
    v_fmac_f32 v137, v88, v136
    v_fmac_f32 v153, v88, v152
    v_fma_f32 v137, -v89, v152, v137
    v_fmac_f32 v153, v89, v136
    v_cvt_pk_bf16_f32 v14, v136, v137
    v_cvt_pk_bf16_f32 v22, v152, v153
    v_fmac_f32 v138, v88, v137
    v_fmac_f32 v154, v88, v153
    v_fma_f32 v138, -v89, v153, v138
    v_fmac_f32 v154, v89, v137
    v_fmac_f32 v139, v88, v138
    v_fmac_f32 v155, v88, v154
    v_fma_f32 v139, -v89, v154, v139
    v_fmac_f32 v155, v89, v138
    v_cvt_pk_bf16_f32 v15, v138, v139
    v_cvt_pk_bf16_f32 v23, v154, v155
    v_fmac_f32 v140, v88, v139
    v_fmac_f32 v156, v88, v155
    v_fma_f32 v140, -v89, v155, v140
    v_fmac_f32 v156, v89, v139
    v_fmac_f32 v141, v88, v140
    v_fmac_f32 v157, v88, v156
    v_fma_f32 v141, -v89, v156, v141
    v_fmac_f32 v157, v89, v140
    v_cvt_pk_bf16_f32 v16, v140, v141
    v_cvt_pk_bf16_f32 v24, v156, v157
    v_fmac_f32 v142, v88, v141
    v_fmac_f32 v158, v88, v157
    v_fma_f32 v142, -v89, v157, v142
    v_fmac_f32 v158, v89, v141
    v_fmac_f32 v143, v88, v142
    v_fmac_f32 v159, v88, v158
    v_fma_f32 v143, -v89, v158, v143
    v_fmac_f32 v159, v89, v142
    v_cvt_pk_bf16_f32 v17, v142, v143
    v_cvt_pk_bf16_f32 v25, v158, v159
    v_fmac_f32 v144, v88, v143
    v_fmac_f32 v160, v88, v159
    v_fma_f32 v144, -v89, v159, v144
    v_fmac_f32 v160, v89, v143
    v_fmac_f32 v145, v88, v144
    v_fmac_f32 v161, v88, v160
    v_fma_f32 v145, -v89, v160, v145
    v_fmac_f32 v161, v89, v144
    v_cvt_pk_bf16_f32 v18, v144, v145
    v_cvt_pk_bf16_f32 v26, v160, v161
    v_fmac_f32 v146, v88, v145
    v_fmac_f32 v162, v88, v161
    v_fma_f32 v146, -v89, v161, v146
    v_fmac_f32 v162, v89, v145
    v_fmac_f32 v147, v88, v146
    v_fmac_f32 v163, v88, v162
    v_fma_f32 v147, -v89, v162, v147
    v_fmac_f32 v163, v89, v146
    v_cvt_pk_bf16_f32 v19, v146, v147
    v_cvt_pk_bf16_f32 v27, v162, v163
    ds_write_b128 v60, v[12:15]
    ds_write_b128 v61, v[16:19]
    ds_read_b64_tr_b16 v[28:29], v62 offset:0
    ds_read_b64_tr_b16 v[30:31], v62 offset:1024
    ds_read_b64_tr_b16 v[32:33], v63 offset:0
    ds_read_b64_tr_b16 v[34:35], v63 offset:1024
    ds_write_b128 v60, v[20:23]
    ds_write_b128 v61, v[24:27]
    ds_read_b64_tr_b16 v[36:37], v62 offset:0
    ds_read_b64_tr_b16 v[38:39], v62 offset:1024
    ds_read_b64_tr_b16 v[40:41], v63 offset:0
    ds_read_b64_tr_b16 v[42:43], v63 offset:1024
    s_waitcnt lgkmcnt(6)
    buffer_store_dwordx4 v[28:31], v2, s[4:7], s13 offen offset:0 sc1
    buffer_store_dwordx4 v[32:35], v2, s[4:7], s14 offen offset:0 sc1
    s_waitcnt lgkmcnt(0)
    buffer_store_dwordx4 v[36:39], v2, s[4:7], s13 offen offset:1024 sc1
    buffer_store_dwordx4 v[40:43], v2, s[4:7], s14 offen offset:1024 sc1
p2_h_one2:
    s_mul_i32 s13, s18, 72
    s_add_u32 s13, s13, s28
    s_lshl_b32 s13, s13, 11
    s_add_u32 s13, s13, 9469952
    s_add_u32 s14, s13, 73728
    v_fmac_f32 v100, v76, v72
    v_fmac_f32 v116, v76, v73
    v_fma_f32 v100, -v77, v73, v100
    v_fmac_f32 v116, v77, v72
    v_fmac_f32 v101, v76, v100
    v_fmac_f32 v117, v76, v116
    v_fma_f32 v101, -v77, v116, v101
    v_fmac_f32 v117, v77, v100
    v_cvt_pk_bf16_f32 v12, v100, v101
    v_cvt_pk_bf16_f32 v20, v116, v117
    v_fmac_f32 v102, v76, v101
    v_fmac_f32 v118, v76, v117
    v_fma_f32 v102, -v77, v117, v102
    v_fmac_f32 v118, v77, v101
    v_fmac_f32 v103, v76, v102
    v_fmac_f32 v119, v76, v118
    v_fma_f32 v103, -v77, v118, v103
    v_fmac_f32 v119, v77, v102
    v_cvt_pk_bf16_f32 v13, v102, v103
    v_cvt_pk_bf16_f32 v21, v118, v119
    v_fmac_f32 v104, v76, v103
    v_fmac_f32 v120, v76, v119
    v_fma_f32 v104, -v77, v119, v104
    v_fmac_f32 v120, v77, v103
    v_fmac_f32 v105, v76, v104
    v_fmac_f32 v121, v76, v120
    v_fma_f32 v105, -v77, v120, v105
    v_fmac_f32 v121, v77, v104
    v_cvt_pk_bf16_f32 v14, v104, v105
    v_cvt_pk_bf16_f32 v22, v120, v121
    v_fmac_f32 v106, v76, v105
    v_fmac_f32 v122, v76, v121
    v_fma_f32 v106, -v77, v121, v106
    v_fmac_f32 v122, v77, v105
    v_fmac_f32 v107, v76, v106
    v_fmac_f32 v123, v76, v122
    v_fma_f32 v107, -v77, v122, v107
    v_fmac_f32 v123, v77, v106
    v_cvt_pk_bf16_f32 v15, v106, v107
    v_cvt_pk_bf16_f32 v23, v122, v123
    v_fmac_f32 v108, v76, v107
    v_fmac_f32 v124, v76, v123
    v_fma_f32 v108, -v77, v123, v108
    v_fmac_f32 v124, v77, v107
    v_fmac_f32 v109, v76, v108
    v_fmac_f32 v125, v76, v124
    v_fma_f32 v109, -v77, v124, v109
    v_fmac_f32 v125, v77, v108
    v_cvt_pk_bf16_f32 v16, v108, v109
    v_cvt_pk_bf16_f32 v24, v124, v125
    v_fmac_f32 v110, v76, v109
    v_fmac_f32 v126, v76, v125
    v_fma_f32 v110, -v77, v125, v110
    v_fmac_f32 v126, v77, v109
    v_fmac_f32 v111, v76, v110
    v_fmac_f32 v127, v76, v126
    v_fma_f32 v111, -v77, v126, v111
    v_fmac_f32 v127, v77, v110
    v_cvt_pk_bf16_f32 v17, v110, v111
    v_cvt_pk_bf16_f32 v25, v126, v127
    v_fmac_f32 v112, v76, v111
    v_fmac_f32 v128, v76, v127
    v_fma_f32 v112, -v77, v127, v112
    v_fmac_f32 v128, v77, v111
    v_fmac_f32 v113, v76, v112
    v_fmac_f32 v129, v76, v128
    v_fma_f32 v113, -v77, v128, v113
    v_fmac_f32 v129, v77, v112
    v_cvt_pk_bf16_f32 v18, v112, v113
    v_cvt_pk_bf16_f32 v26, v128, v129
    v_fmac_f32 v114, v76, v113
    v_fmac_f32 v130, v76, v129
    v_fma_f32 v114, -v77, v129, v114
    v_fmac_f32 v130, v77, v113
    v_fmac_f32 v115, v76, v114
    v_fmac_f32 v131, v76, v130
    v_fma_f32 v115, -v77, v130, v115
    v_fmac_f32 v131, v77, v114
    v_cvt_pk_bf16_f32 v19, v114, v115
    v_cvt_pk_bf16_f32 v27, v130, v131
    ds_write_b128 v60, v[12:15]
    ds_write_b128 v61, v[16:19]
    ds_read_b64_tr_b16 v[28:29], v62 offset:0
    ds_read_b64_tr_b16 v[30:31], v62 offset:1024
    ds_read_b64_tr_b16 v[32:33], v63 offset:0
    ds_read_b64_tr_b16 v[34:35], v63 offset:1024
    ds_write_b128 v60, v[20:23]
    ds_write_b128 v61, v[24:27]
    ds_read_b64_tr_b16 v[36:37], v62 offset:0
    ds_read_b64_tr_b16 v[38:39], v62 offset:1024
    ds_read_b64_tr_b16 v[40:41], v63 offset:0
    ds_read_b64_tr_b16 v[42:43], v63 offset:1024
    s_waitcnt lgkmcnt(6)
    buffer_store_dwordx4 v[28:31], v2, s[4:7], s13 offen offset:0 sc1
    buffer_store_dwordx4 v[32:35], v2, s[4:7], s14 offen offset:0 sc1
    s_waitcnt lgkmcnt(0)
    buffer_store_dwordx4 v[36:39], v2, s[4:7], s13 offen offset:1024 sc1
    buffer_store_dwordx4 v[40:43], v2, s[4:7], s14 offen offset:1024 sc1
p2_h_scandone:
    s_waitcnt lgkmcnt(0)
    s_load_dwordx2 s[52:53], s[0:1], 96
    s_mov_b32 s54, 1152
    s_mov_b32 s55, 0x20000
    s_waitcnt lgkmcnt(0)
    s_cmp_lg_u32 s36, 0
    s_cbranch_scc1 k2_h_nogate
    v_lshrrev_b32 v5, 3, v1
    s_lshl_b32 s41, s18, 3
    s_add_u32 s41, s41, s23
    s_lshl_b32 s41, s41, 3
    v_add_u32 v5, s41, v5
    v_and_b32 v4, 7, v1
    v_lshlrev_b32 v4, 4, v4
    v_mul_u32_u24 v3, 1152, v5
    v_add_u32 v3, v3, v4
    buffer_load_dwordx4 v[8:11], v4, s[52:55], 0 offen offset:0
    buffer_load_dwordx4 v[100:103], v3, s[8:11], 0 offen offset:0
    buffer_load_dwordx4 v[12:15], v4, s[52:55], 0 offen offset:128
    buffer_load_dwordx4 v[104:107], v3, s[8:11], 0 offen offset:128
    buffer_load_dwordx4 v[16:19], v4, s[52:55], 0 offen offset:256
    buffer_load_dwordx4 v[108:111], v3, s[8:11], 0 offen offset:256
    buffer_load_dwordx4 v[20:23], v4, s[52:55], 0 offen offset:384
    buffer_load_dwordx4 v[112:115], v3, s[8:11], 0 offen offset:384
    buffer_load_dwordx4 v[24:27], v4, s[52:55], 0 offen offset:512
    buffer_load_dwordx4 v[116:119], v3, s[8:11], 0 offen offset:512
    buffer_load_dwordx4 v[28:31], v4, s[52:55], 0 offen offset:640
    buffer_load_dwordx4 v[120:123], v3, s[8:11], 0 offen offset:640
    buffer_load_dwordx4 v[32:35], v4, s[52:55], 0 offen offset:768
    buffer_load_dwordx4 v[124:127], v3, s[8:11], 0 offen offset:768
    buffer_load_dwordx4 v[36:39], v4, s[52:55], 0 offen offset:896
    buffer_load_dwordx4 v[128:131], v3, s[8:11], 0 offen offset:896
    buffer_load_dwordx4 v[40:43], v4, s[52:55], 0 offen offset:1024
    buffer_load_dwordx4 v[132:135], v3, s[8:11], 0 offen offset:1024
    v_mov_b32 v6, 0
    s_waitcnt vmcnt(0)
    v_dot2_f32_bf16 v6, v8, v100, v6
    v_dot2_f32_bf16 v6, v9, v101, v6
    v_dot2_f32_bf16 v6, v10, v102, v6
    v_dot2_f32_bf16 v6, v11, v103, v6
    v_dot2_f32_bf16 v6, v12, v104, v6
    v_dot2_f32_bf16 v6, v13, v105, v6
    v_dot2_f32_bf16 v6, v14, v106, v6
    v_dot2_f32_bf16 v6, v15, v107, v6
    v_dot2_f32_bf16 v6, v16, v108, v6
    v_dot2_f32_bf16 v6, v17, v109, v6
    v_dot2_f32_bf16 v6, v18, v110, v6
    v_dot2_f32_bf16 v6, v19, v111, v6
    v_dot2_f32_bf16 v6, v20, v112, v6
    v_dot2_f32_bf16 v6, v21, v113, v6
    v_dot2_f32_bf16 v6, v22, v114, v6
    v_dot2_f32_bf16 v6, v23, v115, v6
    v_dot2_f32_bf16 v6, v24, v116, v6
    v_dot2_f32_bf16 v6, v25, v117, v6
    v_dot2_f32_bf16 v6, v26, v118, v6
    v_dot2_f32_bf16 v6, v27, v119, v6
    v_dot2_f32_bf16 v6, v28, v120, v6
    v_dot2_f32_bf16 v6, v29, v121, v6
    v_dot2_f32_bf16 v6, v30, v122, v6
    v_dot2_f32_bf16 v6, v31, v123, v6
    v_dot2_f32_bf16 v6, v32, v124, v6
    v_dot2_f32_bf16 v6, v33, v125, v6
    v_dot2_f32_bf16 v6, v34, v126, v6
    v_dot2_f32_bf16 v6, v35, v127, v6
    v_dot2_f32_bf16 v6, v36, v128, v6
    v_dot2_f32_bf16 v6, v37, v129, v6
    v_dot2_f32_bf16 v6, v38, v130, v6
    v_dot2_f32_bf16 v6, v39, v131, v6
    v_dot2_f32_bf16 v6, v40, v132, v6
    v_dot2_f32_bf16 v6, v41, v133, v6
    v_dot2_f32_bf16 v6, v42, v134, v6
    v_dot2_f32_bf16 v6, v43, v135, v6
    s_nop 2
    v_add_f32_dpp v6, v6, v6 quad_perm:[1,0,3,2] row_mask:0xf bank_mask:0xf
    s_nop 1
    v_add_f32_dpp v6, v6, v6 quad_perm:[2,3,0,1] row_mask:0xf bank_mask:0xf
    s_nop 1
    v_add_f32_dpp v6, v6, v6 row_half_mirror row_mask:0xf bank_mask:0xf
    v_mul_f32 v6, 0xbfb8aa3b, v6
    v_exp_f32 v6, v6
    s_nop 0
    v_add_f32 v6, 1.0, v6
    v_rcp_f32 v6, v6
    v_lshlrev_b32 v5, 2, v5
    s_mov_b32 s41, 17457152
    s_mov_b32 exec_lo, 0x01010101
    s_mov_b32 exec_hi, 0x01010101
    buffer_store_dword v6, v5, s[4:7], s41 offen sc1
k2_h_nogate:
    s_lshl_b32 s13, s18, 8
    s_add_u32 s13, s13, 17471488
    s_mov_b64 exec, 1
    v_mov_b32 v7, 160772
    v_mov_b32 v10, 1
    s_waitcnt vmcnt(0)
    ds_add_rtn_u32 v11, v7, v10
    s_waitcnt lgkmcnt(0)
    v_readfirstlane_b32 s14, v11
    s_mov_b64 exec, -1
    s_cmp_lg_u32 s14, 3
    s_cbranch_scc1 p2_nosig_h
    v_mov_b32 v7, 0
    v_mov_b32 v10, 1
    s_mov_b64 exec, 1
    buffer_atomic_add v10, v7, s[4:7], s13 offen sc1
    s_mov_b64 exec, -1
p2_nosig_h:
    s_branch p3_start
k2_att:
    v_bfe_u32 v6, v1, 4, 1
    v_and_b32 v7, 1, v1
    v_lshl_add_u32 v6, v6, 1, v7
    v_mul_u32_u24 v6, 288, v6
    v_lshrrev_b32 v7, 5, v1
    v_lshl_add_u32 v6, v7, 7, v6
    v_mul_u32_u24 v5, 304, v7
    v_bfe_u32 v7, v1, 2, 2
    v_lshl_add_u32 v6, v7, 4, v6
    v_bfe_u32 v7, v1, 1, 1
    v_lshl_add_u32 v4, v7, 3, v6
    v_and_b32 v7, 31, v1
    v_lshl_add_u32 v5, v7, 4, v5
    v_add_u32 v5, 73728, v5
    s_mul_i32 s13, s3, 1152
    s_add_u32 s13, s13, 151552
    v_add_u32 v6, s13, v4
    s_mov_b32 s38, 0x7ffff
    s_mov_b32 s39, 0x7ffff
    v_mov_b32 v28, 0
    v_mov_b32 v84, 0
    v_mov_b32 v29, 0
    v_mov_b32 v85, 0
    v_mov_b32 v30, 0
    v_mov_b32 v86, 0
    v_mov_b32 v31, 0
    v_mov_b32 v87, 0
    v_mov_b32 v32, 0
    v_mov_b32 v88, 0
    v_mov_b32 v33, 0
    v_mov_b32 v89, 0
    v_mov_b32 v34, 0
    v_mov_b32 v90, 0
    v_mov_b32 v35, 0
    v_mov_b32 v91, 0
    v_mov_b32 v36, 0
    v_mov_b32 v92, 0
    v_mov_b32 v37, 0
    v_mov_b32 v93, 0
    v_mov_b32 v38, 0
    v_mov_b32 v94, 0
    v_mov_b32 v39, 0
    v_mov_b32 v95, 0
    v_mov_b32 v40, 0
    v_mov_b32 v96, 0
    v_mov_b32 v41, 0
    v_mov_b32 v97, 0
    v_mov_b32 v42, 0
    v_mov_b32 v98, 0
    v_mov_b32 v43, 0
    v_mov_b32 v99, 0
    v_mov_b32 v48, 0
    v_mov_b32 v49, 0
    v_mov_b32 v50, 0
    v_mov_b32 v51, 0
    s_cmp_ge_u32 s3, 4
    s_cbranch_scc1 k2_att_y
    v_mul_u32_u24 v8, 3641, v1
    v_lshrrev_b32 v8, 16, v8
    v_mul_u32_u24 v8, 8928, v8
    s_mul_i32 s13, s26, 288
    v_add3_u32 v8, v8, v2, s13
    v_mul_u32_u24 v9, 3450, v1
    v_lshrrev_b32 v9, 16, v9
    v_mul_u32_u24 v10, 19, v9
    v_sub_u32 v10, v1, v10
    v_cmp_eq_u32 vcc, 18, v10
    v_lshl_add_u32 v10, v10, 4, s13
    v_mov_b32 v11, 9216
    v_cndmask_b32 v10, v10, v11, vcc
    v_mul_u32_u24 v9, 9344, v9
    v_add_u32 v9, v9, v10
    s_mov_b32 s44, -1
    s_mov_b32 s45, 4194303
    s_mov_b32 s46, -1
    s_mov_b32 s47, 33554431
    s_mul_i32 s42, s3, 3
    s_cmp_lg_u32 s3, 0
    s_cbranch_scc1 k2_att_go
    s_mul_i32 s13, s26, 18
    s_mov_b32 s15, 0x200
    s_add_u32 s14, s13, 0
    s_lshr_b32 s14, s14, 7
    s_bitset1_b32 s15, s14
    s_add_u32 s14, s13, 17
    s_lshr_b32 s14, s14, 7
    s_bitset1_b32 s15, s14
    s_add_u32 s14, s13, 576
    s_lshr_b32 s14, s14, 7
    s_bitset1_b32 s15, s14
    s_add_u32 s14, s13, 593
    s_lshr_b32 s14, s14, 7
    s_bitset1_b32 s15, s14
    s_add_u32 s14, s13, 1152
    s_lshr_b32 s14, s14, 7
    s_bitset1_b32 s15, s14
    s_add_u32 s14, s13, 1169
    s_lshr_b32 s14, s14, 7
    s_bitset1_b32 s15, s14
    v_lshlrev_b32 v10, 8, v1
    s_mov_b32 s17, 17465344
    s_mov_b32 exec_lo, s15
    s_mov_b32 exec_hi, 0
    s_mov_b32 s21, 0
poll_qkv:
    buffer_load_dword v11, v10, s[4:7], s17 offen sc1
    s_add_u32 s21, s21, 1
    s_waitcnt vmcnt(0)
    v_cmp_gt_u32 vcc, 16, v11
    s_cbranch_vccz polled_qkv
    s_sleep 1
    s_cmp_lt_u32 s21, 524288
    s_cbranch_scc1 poll_qkv
polled_qkv:
    s_mov_b64 exec, -1
k2_att_go:
    s_barrier
    s_mul_i32 s14, s42, 288
    s_mul_i32 s15, s42, 9216
    s_add_u32 m0, s14, 0
    s_add_u32 s15, s15, 2359296
    s_mov_b64 exec, s[44:45]
    buffer_load_dwordx4 v8, s[4:7], s15 offen sc1 lds
    s_mul_i32 s14, s42, 304
    s_mul_i32 s15, s42, 9344
    s_add_u32 m0, s14, 73728
    s_add_u32 s15, s15, 4718592
    s_mov_b64 exec, s[46:47]
    buffer_load_dwordx4 v9, s[4:7], s15 offen sc1 lds
    s_mov_b64 exec, s[44:45]
    s_mul_i32 s16, s27, 294912
    s_add_u32 s13, s42, 0
    s_mul_i32 s14, s13, 288
    s_mul_i32 s15, s13, 9216
    s_add_u32 m0, s14, 151552
    s_add_u32 s15, s15, s16
    buffer_load_dwordx4 v8, s[4:7], s15 offen sc1 lds
    s_add_u32 s13, s42, 12
    s_mul_i32 s14, s13, 288
    s_mul_i32 s15, s13, 9216
    s_add_u32 m0, s14, 151552
    s_add_u32 s15, s15, s16
    buffer_load_dwordx4 v8, s[4:7], s15 offen sc1 lds
    s_add_u32 s13, s42, 24
    s_min_u32 s13, s13, 29
    s_mul_i32 s14, s13, 288
    s_mul_i32 s15, s13, 9216
    s_add_u32 m0, s14, 151552
    s_add_u32 s15, s15, s16
    buffer_load_dwordx4 v8, s[4:7], s15 offen sc1 lds
    s_mul_i32 s14, s42, 288
    s_mul_i32 s15, s42, 9216
    s_add_u32 m0, s14, 3456
    s_add_u32 s15, s15, 2469888
    s_mov_b64 exec, s[44:45]
    buffer_load_dwordx4 v8, s[4:7], s15 offen sc1 lds
    s_mul_i32 s14, s42, 304
    s_mul_i32 s15, s42, 9344
    s_add_u32 m0, s14, 77376
    s_add_u32 s15, s15, 4830720
    s_mov_b64 exec, s[46:47]
    buffer_load_dwordx4 v9, s[4:7], s15 offen sc1 lds
    s_mul_i32 s14, s42, 288
    s_mul_i32 s15, s42, 9216
    s_add_u32 m0, s14, 6912
    s_add_u32 s15, s15, 2580480
    s_mov_b64 exec, s[44:45]
    buffer_load_dwordx4 v8, s[4:7], s15 offen sc1 lds
    s_mul_i32 s14, s42, 304
    s_mul_i32 s15, s42, 9344
    s_add_u32 m0, s14, 81024
    s_add_u32 s15, s15, 4942848
    s_mov_b64 exec, s[46:47]
    buffer_load_dwordx4 v9, s[4:7], s15 offen sc1 lds
    s_mul_i32 s14, s42, 288
    s_mul_i32 s15, s42, 9216
    s_add_u32 m0, s14, 10368
    s_add_u32 s15, s15, 2691072
    s_mov_b64 exec, s[44:45]
    buffer_load_dwordx4 v8, s[4:7], s15 offen sc1 lds
    s_mul_i32 s14, s42, 304
    s_mul_i32 s15, s42, 9344
    s_add_u32 m0, s14, 84672
    s_add_u32 s15, s15, 5054976
    s_mov_b64 exec, s[46:47]
    buffer_load_dwordx4 v9, s[4:7], s15 offen sc1 lds
    s_mul_i32 s14, s42, 288
    s_mul_i32 s15, s42, 9216
    s_add_u32 m0, s14, 13824
    s_add_u32 s15, s15, 2801664
    s_mov_b64 exec, s[44:45]
    buffer_load_dwordx4 v8, s[4:7], s15 offen sc1 lds
    s_mul_i32 s14, s42, 304
    s_mul_i32 s15, s42, 9344
    s_add_u32 m0, s14, 88320
    s_add_u32 s15, s15, 5167104
    s_mov_b64 exec, s[46:47]
    buffer_load_dwordx4 v9, s[4:7], s15 offen sc1 lds
    s_mul_i32 s14, s42, 288
    s_mul_i32 s15, s42, 9216
    s_add_u32 m0, s14, 17280
    s_add_u32 s15, s15, 2912256
    s_mov_b64 exec, s[44:45]
    buffer_load_dwordx4 v8, s[4:7], s15 offen sc1 lds
    s_mul_i32 s14, s42, 304
    s_mul_i32 s15, s42, 9344
    s_add_u32 m0, s14, 91968
    s_add_u32 s15, s15, 5279232
    s_mov_b64 exec, s[46:47]
    buffer_load_dwordx4 v9, s[4:7], s15 offen sc1 lds
    s_mov_b64 exec, -1
    s_waitcnt vmcnt(4)
    s_branch k2_att_b1
k2_att_y:
    s_barrier
    v_mov_b32 v7, 160768
    ds_write_b128 v7, v[84:87]
    ds_write_b128 v7, v[84:87] offset:16
    ds_write_b128 v7, v[84:87] offset:32
    ds_write_b128 v7, v[84:87] offset:48
    ds_write_b128 v7, v[84:87] offset:64
    s_waitcnt lgkmcnt(0)
k2_att_b1:
    s_mov_b32 s21, 0
    s_barrier
    ds_read_b64_tr_b16 v[8:9], v6 offset:0
    ds_read_b64_tr_b16 v[10:11], v6 offset:64
    ds_read_b64_tr_b16 v[12:13], v6 offset:256
    ds_read_b64_tr_b16 v[14:15], v4 offset:0
    ds_read_b64_tr_b16 v[16:17], v4 offset:64
    ds_read_b64_tr_b16 v[18:19], v4 offset:256
    ds_read_b64_tr_b16 v[20:21], v4 offset:1152
    ds_read_b64_tr_b16 v[22:23], v4 offset:1216
    ds_read_b64_tr_b16 v[24:25], v4 offset:1408
    s_mov_b64 exec, s[38:39]
    ds_read_b128 v[28:31], v5 offset:0
    ds_read_b128 v[32:35], v5 offset:608
    s_mov_b64 exec, -1
    s_waitcnt lgkmcnt(5)
    v_mov_b32 v13, 0
    s_mov_b32 exec_lo, 0
    v_mov_b32 v12, 0
    s_mov_b32 exec_lo, -1
    v_mfma_f32_32x32x16_bf16 v[52:67], v[14:17], v[8:11], 0
    v_mfma_f32_32x32x8_bf16 v[52:67], v[18:19], v[12:13], v[52:67]
    s_nop 1
.p2align 6
k2_loop:
    s_waitcnt lgkmcnt(0)
    s_setprio 0
    ds_read_b64_tr_b16 v[14:15], v4 offset:2304
    ds_read_b64_tr_b16 v[16:17], v4 offset:2368
    ds_read_b64_tr_b16 v[18:19], v4 offset:2560
    v_mfma_f32_32x32x16_bf16 v[84:99], v[40:43], v[48:51], v[84:99]
    s_mov_b64 exec, s[38:39]
    ds_read_b128 v[36:39], v5 offset:1216
    ds_read_b128 v[40:43], v5 offset:1824
    s_mov_b64 exec, -1
    v_exp_f32 v52, v52
    v_exp_f32 v53, v53
    v_exp_f32 v54, v54
    s_setprio 1
    v_exp_f32 v55, v55
    v_exp_f32 v56, v56
    v_exp_f32 v57, v57
    v_mfma_f32_32x32x16_bf16 v[68:83], v[20:23], v[8:11], 0
    v_exp_f32 v58, v58
    v_exp_f32 v59, v59
    v_cvt_pk_bf16_f32 v44, v52, v53
    v_cvt_pk_bf16_f32 v45, v54, v55
    v_cvt_pk_bf16_f32 v46, v56, v57
    v_cvt_pk_bf16_f32 v47, v58, v59
    v_exp_f32 v60, v60
    v_mfma_f32_32x32x8_bf16 v[68:83], v[24:25], v[12:13], v[68:83]
    v_exp_f32 v61, v61
    v_exp_f32 v62, v62
    v_exp_f32 v63, v63
    v_exp_f32 v64, v64
    v_mfma_f32_32x32x16_bf16 v[84:99], v[28:31], v[44:47], v[84:99]
    v_exp_f32 v65, v65
    v_exp_f32 v66, v66
    v_exp_f32 v67, v67
    v_cvt_pk_bf16_f32 v48, v60, v61
    v_cvt_pk_bf16_f32 v49, v62, v63
    v_cvt_pk_bf16_f32 v50, v64, v65
    v_cvt_pk_bf16_f32 v51, v66, v67
    s_waitcnt lgkmcnt(0)
    s_setprio 0
    ds_read_b64_tr_b16 v[20:21], v4 offset:3456
    ds_read_b64_tr_b16 v[22:23], v4 offset:3520
    ds_read_b64_tr_b16 v[24:25], v4 offset:3712
    v_mfma_f32_32x32x16_bf16 v[84:99], v[32:35], v[48:51], v[84:99]
    s_mov_b64 exec, s[38:39]
    ds_read_b128 v[28:31], v5 offset:2432
    ds_read_b128 v[32:35], v5 offset:3040
    s_mov_b64 exec, -1
    v_exp_f32 v68, v68
    v_exp_f32 v69, v69
    v_exp_f32 v70, v70
    s_setprio 1
    v_exp_f32 v71, v71
    v_exp_f32 v72, v72
    v_exp_f32 v73, v73
    v_mfma_f32_32x32x16_bf16 v[52:67], v[14:17], v[8:11], 0
    v_exp_f32 v74, v74
    v_exp_f32 v75, v75
    v_cvt_pk_bf16_f32 v44, v68, v69
    v_cvt_pk_bf16_f32 v45, v70, v71
    v_cvt_pk_bf16_f32 v46, v72, v73
    v_cvt_pk_bf16_f32 v47, v74, v75
    v_exp_f32 v76, v76
    v_mfma_f32_32x32x8_bf16 v[52:67], v[18:19], v[12:13], v[52:67]
    v_exp_f32 v77, v77
    v_exp_f32 v78, v78
    v_exp_f32 v79, v79
    v_exp_f32 v80, v80
    v_mfma_f32_32x32x16_bf16 v[84:99], v[36:39], v[44:47], v[84:99]
    v_exp_f32 v81, v81
    v_exp_f32 v82, v82
    v_exp_f32 v83, v83
    v_cvt_pk_bf16_f32 v48, v76, v77
    v_cvt_pk_bf16_f32 v49, v78, v79
    v_cvt_pk_bf16_f32 v50, v80, v81
    v_cvt_pk_bf16_f32 v51, v82, v83
    s_waitcnt lgkmcnt(0)
    s_setprio 0
    ds_read_b64_tr_b16 v[14:15], v4 offset:4608
    ds_read_b64_tr_b16 v[16:17], v4 offset:4672
    ds_read_b64_tr_b16 v[18:19], v4 offset:4864
    v_mfma_f32_32x32x16_bf16 v[84:99], v[40:43], v[48:51], v[84:99]
    s_mov_b64 exec, s[38:39]
    ds_read_b128 v[36:39], v5 offset:3648
    ds_read_b128 v[40:43], v5 offset:4256
    s_mov_b64 exec, -1
    v_exp_f32 v52, v52
    v_exp_f32 v53, v53
    v_exp_f32 v54, v54
    s_setprio 1
    v_exp_f32 v55, v55
    v_exp_f32 v56, v56
    v_exp_f32 v57, v57
    v_mfma_f32_32x32x16_bf16 v[68:83], v[20:23], v[8:11], 0
    v_exp_f32 v58, v58
    v_exp_f32 v59, v59
    v_cvt_pk_bf16_f32 v44, v52, v53
    v_cvt_pk_bf16_f32 v45, v54, v55
    v_cvt_pk_bf16_f32 v46, v56, v57
    v_cvt_pk_bf16_f32 v47, v58, v59
    v_exp_f32 v60, v60
    v_mfma_f32_32x32x8_bf16 v[68:83], v[24:25], v[12:13], v[68:83]
    v_exp_f32 v61, v61
    v_exp_f32 v62, v62
    v_exp_f32 v63, v63
    v_exp_f32 v64, v64
    v_mfma_f32_32x32x16_bf16 v[84:99], v[28:31], v[44:47], v[84:99]
    v_exp_f32 v65, v65
    v_exp_f32 v66, v66
    v_exp_f32 v67, v67
    v_cvt_pk_bf16_f32 v48, v60, v61
    v_cvt_pk_bf16_f32 v49, v62, v63
    v_cvt_pk_bf16_f32 v50, v64, v65
    v_cvt_pk_bf16_f32 v51, v66, v67
    s_waitcnt lgkmcnt(0)
    s_setprio 0
    ds_read_b64_tr_b16 v[20:21], v4 offset:5760
    ds_read_b64_tr_b16 v[22:23], v4 offset:5824
    ds_read_b64_tr_b16 v[24:25], v4 offset:6016
    v_mfma_f32_32x32x16_bf16 v[84:99], v[32:35], v[48:51], v[84:99]
    s_mov_b64 exec, s[38:39]
    ds_read_b128 v[28:31], v5 offset:4864
    ds_read_b128 v[32:35], v5 offset:5472
    s_mov_b64 exec, -1
    v_exp_f32 v68, v68
    v_exp_f32 v69, v69
    v_exp_f32 v70, v70
    s_setprio 1
    v_exp_f32 v71, v71
    v_exp_f32 v72, v72
    v_exp_f32 v73, v73
    v_mfma_f32_32x32x16_bf16 v[52:67], v[14:17], v[8:11], 0
    v_exp_f32 v74, v74
    v_exp_f32 v75, v75
    v_cvt_pk_bf16_f32 v44, v68, v69
    v_cvt_pk_bf16_f32 v45, v70, v71
    v_cvt_pk_bf16_f32 v46, v72, v73
    v_cvt_pk_bf16_f32 v47, v74, v75
    v_exp_f32 v76, v76
    v_mfma_f32_32x32x8_bf16 v[52:67], v[18:19], v[12:13], v[52:67]
    v_exp_f32 v77, v77
    v_exp_f32 v78, v78
    v_exp_f32 v79, v79
    v_exp_f32 v80, v80
    v_mfma_f32_32x32x16_bf16 v[84:99], v[36:39], v[44:47], v[84:99]
    v_exp_f32 v81, v81
    v_exp_f32 v82, v82
    v_exp_f32 v83, v83
    v_cvt_pk_bf16_f32 v48, v76, v77
    v_cvt_pk_bf16_f32 v49, v78, v79
    v_cvt_pk_bf16_f32 v50, v80, v81
    v_cvt_pk_bf16_f32 v51, v82, v83
    s_waitcnt lgkmcnt(0)
    s_setprio 0
    ds_read_b64_tr_b16 v[14:15], v4 offset:6912
    ds_read_b64_tr_b16 v[16:17], v4 offset:6976
    ds_read_b64_tr_b16 v[18:19], v4 offset:7168
    v_mfma_f32_32x32x16_bf16 v[84:99], v[40:43], v[48:51], v[84:99]
    s_mov_b64 exec, s[38:39]
    ds_read_b128 v[36:39], v5 offset:6080
    ds_read_b128 v[40:43], v5 offset:6688
    s_mov_b64 exec, -1
    v_exp_f32 v52, v52
    v_exp_f32 v53, v53
    v_exp_f32 v54, v54
    s_setprio 1
    v_exp_f32 v55, v55
    v_exp_f32 v56, v56
    v_exp_f32 v57, v57
    v_mfma_f32_32x32x16_bf16 v[68:83], v[20:23], v[8:11], 0
    v_exp_f32 v58, v58
    v_exp_f32 v59, v59
    v_cvt_pk_bf16_f32 v44, v52, v53
    v_cvt_pk_bf16_f32 v45, v54, v55
    v_cvt_pk_bf16_f32 v46, v56, v57
    v_cvt_pk_bf16_f32 v47, v58, v59
    v_exp_f32 v60, v60
    v_mfma_f32_32x32x8_bf16 v[68:83], v[24:25], v[12:13], v[68:83]
    v_exp_f32 v61, v61
    v_exp_f32 v62, v62
    v_exp_f32 v63, v63
    v_exp_f32 v64, v64
    v_mfma_f32_32x32x16_bf16 v[84:99], v[28:31], v[44:47], v[84:99]
    v_exp_f32 v65, v65
    v_exp_f32 v66, v66
    v_exp_f32 v67, v67
    v_cvt_pk_bf16_f32 v48, v60, v61
    v_cvt_pk_bf16_f32 v49, v62, v63
    v_cvt_pk_bf16_f32 v50, v64, v65
    v_cvt_pk_bf16_f32 v51, v66, v67
    s_waitcnt lgkmcnt(0)
    s_setprio 0
    ds_read_b64_tr_b16 v[20:21], v4 offset:8064
    ds_read_b64_tr_b16 v[22:23], v4 offset:8128
    ds_read_b64_tr_b16 v[24:25], v4 offset:8320
    v_mfma_f32_32x32x16_bf16 v[84:99], v[32:35], v[48:51], v[84:99]
    s_mov_b64 exec, s[38:39]
    ds_read_b128 v[28:31], v5 offset:7296
    ds_read_b128 v[32:35], v5 offset:7904
    s_mov_b64 exec, -1
    v_exp_f32 v68, v68
    v_exp_f32 v69, v69
    v_exp_f32 v70, v70
    s_setprio 1
    v_exp_f32 v71, v71
    v_exp_f32 v72, v72
    v_exp_f32 v73, v73
    v_mfma_f32_32x32x16_bf16 v[52:67], v[14:17], v[8:11], 0
    v_exp_f32 v74, v74
    v_exp_f32 v75, v75
    v_cvt_pk_bf16_f32 v44, v68, v69
    v_cvt_pk_bf16_f32 v45, v70, v71
    v_cvt_pk_bf16_f32 v46, v72, v73
    v_cvt_pk_bf16_f32 v47, v74, v75
    v_exp_f32 v76, v76
    v_mfma_f32_32x32x8_bf16 v[52:67], v[18:19], v[12:13], v[52:67]
    v_exp_f32 v77, v77
    v_exp_f32 v78, v78
    v_exp_f32 v79, v79
    v_exp_f32 v80, v80
    v_mfma_f32_32x32x16_bf16 v[84:99], v[36:39], v[44:47], v[84:99]
    v_exp_f32 v81, v81
    v_exp_f32 v82, v82
    v_exp_f32 v83, v83
    v_cvt_pk_bf16_f32 v48, v76, v77
    v_cvt_pk_bf16_f32 v49, v78, v79
    v_cvt_pk_bf16_f32 v50, v80, v81
    v_cvt_pk_bf16_f32 v51, v82, v83
    s_waitcnt lgkmcnt(0)
    s_setprio 0
    ds_read_b64_tr_b16 v[14:15], v4 offset:9216
    ds_read_b64_tr_b16 v[16:17], v4 offset:9280
    ds_read_b64_tr_b16 v[18:19], v4 offset:9472
    v_mfma_f32_32x32x16_bf16 v[84:99], v[40:43], v[48:51], v[84:99]
    s_mov_b64 exec, s[38:39]
    ds_read_b128 v[36:39], v5 offset:8512
    ds_read_b128 v[40:43], v5 offset:9120
    s_mov_b64 exec, -1
    v_exp_f32 v52, v52
    v_exp_f32 v53, v53
    v_exp_f32 v54, v54
    s_setprio 1
    v_exp_f32 v55, v55
    v_exp_f32 v56, v56
    v_exp_f32 v57, v57
    v_mfma_f32_32x32x16_bf16 v[68:83], v[20:23], v[8:11], 0
    v_exp_f32 v58, v58
    v_exp_f32 v59, v59
    v_cvt_pk_bf16_f32 v44, v52, v53
    v_cvt_pk_bf16_f32 v45, v54, v55
    v_cvt_pk_bf16_f32 v46, v56, v57
    v_cvt_pk_bf16_f32 v47, v58, v59
    v_exp_f32 v60, v60
    v_mfma_f32_32x32x8_bf16 v[68:83], v[24:25], v[12:13], v[68:83]
    v_exp_f32 v61, v61
    v_exp_f32 v62, v62
    v_exp_f32 v63, v63
    v_exp_f32 v64, v64
    v_mfma_f32_32x32x16_bf16 v[84:99], v[28:31], v[44:47], v[84:99]
    v_exp_f32 v65, v65
    v_exp_f32 v66, v66
    v_exp_f32 v67, v67
    v_cvt_pk_bf16_f32 v48, v60, v61
    v_cvt_pk_bf16_f32 v49, v62, v63
    v_cvt_pk_bf16_f32 v50, v64, v65
    v_cvt_pk_bf16_f32 v51, v66, v67
    s_waitcnt lgkmcnt(0)
    s_setprio 0
    ds_read_b64_tr_b16 v[20:21], v4 offset:10368
    ds_read_b64_tr_b16 v[22:23], v4 offset:10432
    ds_read_b64_tr_b16 v[24:25], v4 offset:10624
    v_mfma_f32_32x32x16_bf16 v[84:99], v[32:35], v[48:51], v[84:99]
    s_mov_b64 exec, s[38:39]
    ds_read_b128 v[28:31], v5 offset:9728
    ds_read_b128 v[32:35], v5 offset:10336
    s_mov_b64 exec, -1
    v_exp_f32 v68, v68
    v_exp_f32 v69, v69
    v_exp_f32 v70, v70
    s_setprio 1
    v_exp_f32 v71, v71
    v_exp_f32 v72, v72
    v_exp_f32 v73, v73
    v_mfma_f32_32x32x16_bf16 v[52:67], v[14:17], v[8:11], 0
    v_exp_f32 v74, v74
    v_exp_f32 v75, v75
    v_cvt_pk_bf16_f32 v44, v68, v69
    v_cvt_pk_bf16_f32 v45, v70, v71
    v_cvt_pk_bf16_f32 v46, v72, v73
    v_cvt_pk_bf16_f32 v47, v74, v75
    v_exp_f32 v76, v76
    v_mfma_f32_32x32x8_bf16 v[52:67], v[18:19], v[12:13], v[52:67]
    v_exp_f32 v77, v77
    v_exp_f32 v78, v78
    v_exp_f32 v79, v79
    v_exp_f32 v80, v80
    v_mfma_f32_32x32x16_bf16 v[84:99], v[36:39], v[44:47], v[84:99]
    v_exp_f32 v81, v81
    v_exp_f32 v82, v82
    v_exp_f32 v83, v83
    v_cvt_pk_bf16_f32 v48, v76, v77
    v_cvt_pk_bf16_f32 v49, v78, v79
    v_cvt_pk_bf16_f32 v50, v80, v81
    v_cvt_pk_bf16_f32 v51, v82, v83
    v_add_u32 v4, 9216, v4
    v_add_u32 v5, 9728, v5
    s_bitcmp1_b32 99, s21
    s_cbranch_scc1 k2_sync
k2_nosync:
    s_add_u32 s21, s21, 1
    s_cmp_lt_u32 s21, 8
    s_cbranch_scc1 k2_loop
    v_mfma_f32_32x32x16_bf16 v[84:99], v[40:43], v[48:51], v[84:99]
    s_waitcnt lgkmcnt(0)
    s_nop 10
    v_mov_b32 v6, v94
    v_mov_b32 v7, v94
    s_nop 1
    v_permlane32_swap_b32 v6, v7
    v_mov_b32 v7, 0
    v_fmac_f32 v7, 0, v84
    v_fmac_f32 v7, 0, v85
    v_fmac_f32 v7, 0, v86
    v_fmac_f32 v7, 0, v87
    v_fmac_f32 v7, 0, v88
    v_fmac_f32 v7, 0, v89
    v_fmac_f32 v7, 0, v90
    v_fmac_f32 v7, 0, v91
    s_mov_b32 exec_hi, 0
    v_fmac_f32 v7, 0, v92
    v_fmac_f32 v7, 0, v93
    s_mov_b32 exec_hi, -1
    v_add_f32 v7, v7, v6
    s_mov_b32 s13, 0x37800000
    s_mov_b32 s14, 0x5f800000
    v_cmp_nle_f32 vcc, s13, v7
    v_cmp_nge_f32 s[30:31], s14, v7
    s_nop 0
    s_or_b64 vcc, vcc, s[30:31]
    s_cbranch_vccnz k2_bad
    s_mov_b64 exec, 1
    v_mov_b32 v116, 160796
    v_mov_b32 v117, 1
    ds_add_u32 v116, v117
    s_mov_b64 exec, -1
    s_branch k2_fin
k2_bad:
    s_mov_b64 exec, 1
    v_mov_b32 v6, 160792
    v_mov_b32 v7, 1
    ds_add_u32 v6, v7
    s_mov_b64 exec, -1
    s_mov_b64 exec, 1
    v_mov_b32 v6, 160796
    v_mov_b32 v7, 1
    ds_add_u32 v6, v7
    s_mov_b64 exec, -1
    v_mov_b32 v6, 160804
    s_mov_b32 s63, 2097152
lw_k:
    ds_read_b32 v7, v6
    s_waitcnt lgkmcnt(0)
    v_readfirstlane_b32 s13, v7
    s_nop 0
    s_cmp_ge_u32 s13, 1
    s_cbranch_scc1 lw_k_ok
    s_sleep 8
    s_sub_u32 s63, s63, 1
    s_cbranch_scc0 lw_k
lw_k_ok:
    s_branch k2_redo
k2_sync:
    s_cmp_ge_u32 s21, 5
    s_cbranch_scc0 k2_sync01
    s_lshl_b32 s13, s21, 2
    s_mov_b64 exec, 1
    v_mov_b32 v6, 160764
    v_add_u32 v6, s13, v6
    v_mov_b32 v7, 1
    ds_add_u32 v6, v7
    s_mov_b64 exec, -1
    s_branch k2_nosync
k2_sync01:
    s_cmp_eq_u32 s21, 1
    s_cbranch_scc1 k2_sync1
    s_mov_b64 exec, 1
    v_mov_b32 v6, 160836
    v_mov_b32 v7, 1
    ds_add_u32 v6, v7
    s_mov_b64 exec, -1
    s_cmp_ge_u32 s3, 4
    s_cbranch_scc1 k2_sync0
    s_waitcnt vmcnt(0)
    s_mov_b64 exec, 1
    v_mov_b32 v6, 160776
    v_mov_b32 v7, 1
    ds_add_u32 v6, v7
    s_mov_b64 exec, -1
k2_sync0:
    v_mov_b32 v6, 160776
    s_mov_b32 s63, 2097152
lw_a:
    ds_read_b32 v7, v6
    s_waitcnt lgkmcnt(0)
    v_readfirstlane_b32 s13, v7
    s_nop 0
    s_cmp_ge_u32 s13, 4
    s_cbranch_scc1 lw_a_ok
    s_sleep 1
    s_sub_u32 s63, s63, 1
    s_cbranch_scc0 lw_a
lw_a_ok:
    s_branch k2_nosync
k2_sync1:
    v_mov_b32 v6, 160780
    s_mov_b32 s63, 2097152
lw_b:
    ds_read_b32 v7, v6
    s_waitcnt lgkmcnt(0)
    v_readfirstlane_b32 s13, v7
    s_nop 0
    s_cmp_ge_u32 s13, 4
    s_cbranch_scc1 lw_b_ok
    s_sleep 1
    s_sub_u32 s63, s63, 1
    s_cbranch_scc0 lw_b
lw_b_ok:
    s_branch k2_nosync
k2_redo:
    v_add_u32 v4, 4294893568, v4
    v_add_u32 v5, 4294889472, v5
    v_mov_b32 v116, 0xff800000
    v_mov_b32 v6, v4
    s_mov_b32 s21, 0
k2_max:
    ds_read_b64_tr_b16 v[14:15], v6 offset:0
    ds_read_b64_tr_b16 v[16:17], v6 offset:64
    ds_read_b64_tr_b16 v[18:19], v6 offset:256
    v_add_u32 v6, 1152, v6
    s_waitcnt lgkmcnt(0)
    v_mfma_f32_32x32x16_bf16 v[52:67], v[14:17], v[8:11], 0
    v_mfma_f32_32x32x8_bf16 v[52:67], v[18:19], v[12:13], v[52:67]
    s_add_u32 s21, s21, 1
    s_nop 10
    v_max3_f32 v116, v116, v52, v53
    v_max3_f32 v116, v116, v54, v55
    v_max3_f32 v116, v116, v56, v57
    v_max3_f32 v116, v116, v58, v59
    v_max3_f32 v116, v116, v60, v61
    v_max3_f32 v116, v116, v62, v63
    v_max3_f32 v116, v116, v64, v65
    v_max3_f32 v116, v116, v66, v67
    s_cmp_lt_u32 s21, 64
    s_cbranch_scc1 k2_max
    v_mov_b32 v6, v116
    s_nop 1
    v_permlane32_swap_b32 v6, v116
    v_max_f32 v116, v6, v116
    v_mov_b32 v84, 0
    v_mov_b32 v85, 0
    v_mov_b32 v86, 0
    v_mov_b32 v87, 0
    v_mov_b32 v88, 0
    v_mov_b32 v89, 0
    v_mov_b32 v90, 0
    v_mov_b32 v91, 0
    v_mov_b32 v92, 0
    v_mov_b32 v93, 0
    v_mov_b32 v94, 0
    v_mov_b32 v95, 0
    v_mov_b32 v96, 0
    v_mov_b32 v97, 0
    v_mov_b32 v98, 0
    v_mov_b32 v99, 0
    s_mov_b32 s21, 0
k2_slow:
    ds_read_b64_tr_b16 v[14:15], v4 offset:0
    ds_read_b64_tr_b16 v[16:17], v4 offset:64
    ds_read_b64_tr_b16 v[18:19], v4 offset:256
    s_mov_b64 exec, s[38:39]
    ds_read_b128 v[28:31], v5 offset:0
    ds_read_b128 v[32:35], v5 offset:608
    s_mov_b64 exec, -1
    v_add_u32 v4, 1152, v4
    v_add_u32 v5, 1216, v5
    s_waitcnt lgkmcnt(0)
    v_mfma_f32_32x32x16_bf16 v[52:67], v[14:17], v[8:11], 0
    v_mfma_f32_32x32x8_bf16 v[52:67], v[18:19], v[12:13], v[52:67]
    s_add_u32 s21, s21, 1
    s_nop 10
    v_sub_f32 v52, v52, v116
    v_sub_f32 v53, v53, v116
    v_sub_f32 v54, v54, v116
    v_sub_f32 v55, v55, v116
    v_sub_f32 v56, v56, v116
    v_sub_f32 v57, v57, v116
    v_sub_f32 v58, v58, v116
    v_sub_f32 v59, v59, v116
    v_sub_f32 v60, v60, v116
    v_sub_f32 v61, v61, v116
    v_sub_f32 v62, v62, v116
    v_sub_f32 v63, v63, v116
    v_sub_f32 v64, v64, v116
    v_sub_f32 v65, v65, v116
    v_sub_f32 v66, v66, v116
    v_sub_f32 v67, v67, v116
    v_exp_f32 v52, v52
    v_exp_f32 v53, v53
    v_exp_f32 v54, v54
    v_exp_f32 v55, v55
    v_exp_f32 v56, v56
    v_exp_f32 v57, v57
    v_exp_f32 v58, v58
    v_exp_f32 v59, v59
    v_exp_f32 v60, v60
    v_exp_f32 v61, v61
    v_exp_f32 v62, v62
    v_exp_f32 v63, v63
    v_exp_f32 v64, v64
    v_exp_f32 v65, v65
    v_exp_f32 v66, v66
    v_exp_f32 v67, v67
    v_cvt_pk_bf16_f32 v44, v52, v53
    v_cvt_pk_bf16_f32 v45, v54, v55
    v_cvt_pk_bf16_f32 v46, v56, v57
    v_cvt_pk_bf16_f32 v47, v58, v59
    v_cvt_pk_bf16_f32 v48, v60, v61
    v_cvt_pk_bf16_f32 v49, v62, v63
    v_cvt_pk_bf16_f32 v50, v64, v65
    v_cvt_pk_bf16_f32 v51, v66, v67
    v_mfma_f32_32x32x16_bf16 v[84:99], v[28:31], v[44:47], v[84:99]
    s_nop 0
    v_mfma_f32_32x32x16_bf16 v[84:99], v[32:35], v[48:51], v[84:99]
    s_cmp_lt_u32 s21, 64
    s_cbranch_scc1 k2_slow
    s_nop 9
    v_mov_b32 v6, v94
    v_mov_b32 v7, v94
    s_nop 1
    v_permlane32_swap_b32 v6, v7
    s_mov_b64 exec, 1
    v_mov_b32 v116, 160808
    v_mov_b32 v117, 1
    ds_add_u32 v116, v117
    s_mov_b64 exec, -1
k2_fin:
    v_rcp_f32 v6, v6
    s_lshl_b32 s13, s27, 3
    s_add_u32 s13, s13, s3
    s_mul_i32 s13, s13, 36864
    s_add_u32 s13, s13, 7110656
    s_lshl_b32 s14, s26, 10
    s_add_u32 s14, s14, s13
    v_mul_f32 v84, v6, v84
    v_mul_f32 v85, v6, v85
    v_mul_f32 v86, v6, v86
    v_mul_f32 v87, v6, v87
    v_mul_f32 v88, v6, v88
    v_mul_f32 v89, v6, v89
    v_mul_f32 v90, v6, v90
    v_mul_f32 v91, v6, v91
    v_mul_f32 v92, v6, v92
    v_mul_f32 v93, v6, v93
    v_cvt_pk_bf16_f32 v44, v84, v85
    v_cvt_pk_bf16_f32 v45, v86, v87
    v_cvt_pk_bf16_f32 v46, v88, v89
    v_cvt_pk_bf16_f32 v47, v90, v91
    v_cvt_pk_bf16_f32 v48, v92, v93
    buffer_store_dwordx4 v[44:47], v2, s[4:7], s14 offen sc1
    s_lshl_b32 s14, s26, 7
    s_add_u32 s13, s13, s14
    s_add_u32 s13, s13, 32768
    v_lshlrev_b32 v6, 2, v1
    s_mov_b32 exec_hi, 0
    buffer_store_dword v48, v6, s[4:7], s13 offen sc1
    s_lshl_b32 s13, s27, 8
    s_add_u32 s13, s13, 17479680
    s_mov_b64 exec, 1
    v_mov_b32 v7, 160800
    v_mov_b32 v10, 1
    s_waitcnt vmcnt(0)
    ds_add_rtn_u32 v11, v7, v10
    s_waitcnt lgkmcnt(0)
    v_readfirstlane_b32 s14, v11
    s_mov_b64 exec, -1
    s_cmp_lg_u32 s14, 7
    s_cbranch_scc1 p2_nosig_o
    v_mov_b32 v7, 0
    v_mov_b32 v10, 1
    s_mov_b64 exec, 1
    buffer_atomic_add v10, v7, s[4:7], s13 offen sc1
    s_mov_b64 exec, -1
p2_nosig_o:
    s_cmp_eq_u32 s3, 0
    s_cbranch_scc1 p3_oload
k2_exit:
    s_endpgm
p3_start:
    s_cmp_lt_u32 s2, 192
    s_cbranch_scc1 p3_tile
    s_cmp_lg_u32 s36, 3
    s_cbranch_scc1 p3_exit
    v_mov_b32 v3, 160796
    s_mov_b32 s63, 2097152
lw_dn:
    ds_read_b32 v4, v3
    s_waitcnt lgkmcnt(0)
    v_readfirstlane_b32 s28, v4
    s_nop 0
    s_cmp_ge_u32 s28, 8
    s_cbranch_scc1 lw_dn_ok
    s_sleep 1
    s_sub_u32 s63, s63, 1
    s_cbranch_scc0 lw_dn
lw_dn_ok:
    v_mov_b32 v3, 160792
    ds_read_b32 v4, v3
    s_waitcnt lgkmcnt(0)
    v_readfirstlane_b32 s31, v4
    s_nop 0
    s_cmp_eq_u32 s31, 0
    s_cbranch_scc1 p3_ok_n
    s_mov_b32 s32, 0
p3_re_n:
    v_mul_u32_u24 v8, 3641, v1
    v_lshrrev_b32 v8, 16, v8
    v_mul_u32_u24 v8, 8928, v8
    s_mul_i32 s28, s26, 288
    v_add3_u32 v8, v8, v2, s28
    v_mul_u32_u24 v9, 3450, v1
    v_lshrrev_b32 v9, 16, v9
    v_mul_u32_u24 v10, 19, v9
    v_sub_u32 v10, v1, v10
    v_cmp_eq_u32 vcc, 18, v10
    v_lshl_add_u32 v10, v10, 4, s28
    v_mov_b32 v11, 9216
    v_cndmask_b32 v10, v10, v11, vcc
    v_mul_u32_u24 v9, 9344, v9
    v_add_u32 v9, v9, v10
    s_mov_b32 s44, -1
    s_mov_b32 s45, 4194303
    s_mov_b32 s46, -1
    s_mov_b32 s47, 33554431
    s_mul_i32 s42, s32, 3
    s_mul_i32 s28, s42, 288
    s_mul_i32 s29, s42, 9216
    s_add_u32 m0, s28, 0
    s_add_u32 s29, s29, 2359296
    s_mov_b64 exec, s[44:45]
    buffer_load_dwordx4 v8, s[4:7], s29 offen sc1 lds
    s_mul_i32 s28, s42, 304
    s_mul_i32 s29, s42, 9344
    s_add_u32 m0, s28, 73728
    s_add_u32 s29, s29, 4718592
    s_mov_b64 exec, s[46:47]
    buffer_load_dwordx4 v9, s[4:7], s29 offen sc1 lds
    s_mul_i32 s28, s42, 288
    s_mul_i32 s29, s42, 9216
    s_add_u32 m0, s28, 3456
    s_add_u32 s29, s29, 2469888
    s_mov_b64 exec, s[44:45]
    buffer_load_dwordx4 v8, s[4:7], s29 offen sc1 lds
    s_mul_i32 s28, s42, 304
    s_mul_i32 s29, s42, 9344
    s_add_u32 m0, s28, 77376
    s_add_u32 s29, s29, 4830720
    s_mov_b64 exec, s[46:47]
    buffer_load_dwordx4 v9, s[4:7], s29 offen sc1 lds
    s_mul_i32 s28, s42, 288
    s_mul_i32 s29, s42, 9216
    s_add_u32 m0, s28, 6912
    s_add_u32 s29, s29, 2580480
    s_mov_b64 exec, s[44:45]
    buffer_load_dwordx4 v8, s[4:7], s29 offen sc1 lds
    s_mul_i32 s28, s42, 304
    s_mul_i32 s29, s42, 9344
    s_add_u32 m0, s28, 81024
    s_add_u32 s29, s29, 4942848
    s_mov_b64 exec, s[46:47]
    buffer_load_dwordx4 v9, s[4:7], s29 offen sc1 lds
    s_mul_i32 s28, s42, 288
    s_mul_i32 s29, s42, 9216
    s_add_u32 m0, s28, 10368
    s_add_u32 s29, s29, 2691072
    s_mov_b64 exec, s[44:45]
    buffer_load_dwordx4 v8, s[4:7], s29 offen sc1 lds
    s_mul_i32 s28, s42, 304
    s_mul_i32 s29, s42, 9344
    s_add_u32 m0, s28, 84672
    s_add_u32 s29, s29, 5054976
    s_mov_b64 exec, s[46:47]
    buffer_load_dwordx4 v9, s[4:7], s29 offen sc1 lds
    s_mul_i32 s28, s42, 288
    s_mul_i32 s29, s42, 9216
    s_add_u32 m0, s28, 13824
    s_add_u32 s29, s29, 2801664
    s_mov_b64 exec, s[44:45]
    buffer_load_dwordx4 v8, s[4:7], s29 offen sc1 lds
    s_mul_i32 s28, s42, 304
    s_mul_i32 s29, s42, 9344
    s_add_u32 m0, s28, 88320
    s_add_u32 s29, s29, 5167104
    s_mov_b64 exec, s[46:47]
    buffer_load_dwordx4 v9, s[4:7], s29 offen sc1 lds
    s_mul_i32 s28, s42, 288
    s_mul_i32 s29, s42, 9216
    s_add_u32 m0, s28, 17280
    s_add_u32 s29, s29, 2912256
    s_mov_b64 exec, s[44:45]
    buffer_load_dwordx4 v8, s[4:7], s29 offen sc1 lds
    s_mul_i32 s28, s42, 304
    s_mul_i32 s29, s42, 9344
    s_add_u32 m0, s28, 91968
    s_add_u32 s29, s29, 5279232
    s_mov_b64 exec, s[46:47]
    buffer_load_dwordx4 v9, s[4:7], s29 offen sc1 lds
    s_mul_i32 s28, s42, 288
    s_mul_i32 s29, s42, 9216
    s_add_u32 m0, s28, 20736
    s_add_u32 s29, s29, 3022848
    s_mov_b64 exec, s[44:45]
    buffer_load_dwordx4 v8, s[4:7], s29 offen sc1 lds
    s_mul_i32 s28, s42, 304
    s_mul_i32 s29, s42, 9344
    s_add_u32 m0, s28, 95616
    s_add_u32 s29, s29, 5391360
    s_mov_b64 exec, s[46:47]
    buffer_load_dwordx4 v9, s[4:7], s29 offen sc1 lds
    s_mul_i32 s28, s42, 288
    s_mul_i32 s29, s42, 9216
    s_add_u32 m0, s28, 24192
    s_add_u32 s29, s29, 3133440
    s_mov_b64 exec, s[44:45]
    buffer_load_dwordx4 v8, s[4:7], s29 offen sc1 lds
    s_mul_i32 s28, s42, 304
    s_mul_i32 s29, s42, 9344
    s_add_u32 m0, s28, 99264
    s_add_u32 s29, s29, 5503488
    s_mov_b64 exec, s[46:47]
    buffer_load_dwordx4 v9, s[4:7], s29 offen sc1 lds
    s_waitcnt vmcnt(16)
    s_mul_i32 s28, s42, 288
    s_mul_i32 s29, s42, 9216
    s_add_u32 m0, s28, 27648
    s_add_u32 s29, s29, 3244032
    s_mov_b64 exec, s[44:45]
    buffer_load_dwordx4 v8, s[4:7], s29 offen sc1 lds
    s_mul_i32 s28, s42, 304
    s_mul_i32 s29, s42, 9344
    s_add_u32 m0, s28, 102912
    s_add_u32 s29, s29, 5615616
    s_mov_b64 exec, s[46:47]
    buffer_load_dwordx4 v9, s[4:7], s29 offen sc1 lds
    s_mul_i32 s28, s42, 288
    s_mul_i32 s29, s42, 9216
    s_add_u32 m0, s28, 31104
    s_add_u32 s29, s29, 3354624
    s_mov_b64 exec, s[44:45]
    buffer_load_dwordx4 v8, s[4:7], s29 offen sc1 lds
    s_mul_i32 s28, s42, 304
    s_mul_i32 s29, s42, 9344
    s_add_u32 m0, s28, 106560
    s_add_u32 s29, s29, 5727744
    s_mov_b64 exec, s[46:47]
    buffer_load_dwordx4 v9, s[4:7], s29 offen sc1 lds
    s_mul_i32 s28, s42, 288
    s_mul_i32 s29, s42, 9216
    s_add_u32 m0, s28, 34560
    s_add_u32 s29, s29, 3465216
    s_mov_b64 exec, s[44:45]
    buffer_load_dwordx4 v8, s[4:7], s29 offen sc1 lds
    s_mul_i32 s28, s42, 304
    s_mul_i32 s29, s42, 9344
    s_add_u32 m0, s28, 110208
    s_add_u32 s29, s29, 5839872
    s_mov_b64 exec, s[46:47]
    buffer_load_dwordx4 v9, s[4:7], s29 offen sc1 lds
    s_mul_i32 s28, s42, 288
    s_mul_i32 s29, s42, 9216
    s_add_u32 m0, s28, 38016
    s_add_u32 s29, s29, 3575808
    s_mov_b64 exec, s[44:45]
    buffer_load_dwordx4 v8, s[4:7], s29 offen sc1 lds
    s_mul_i32 s28, s42, 304
    s_mul_i32 s29, s42, 9344
    s_add_u32 m0, s28, 113856
    s_add_u32 s29, s29, 5952000
    s_mov_b64 exec, s[46:47]
    buffer_load_dwordx4 v9, s[4:7], s29 offen sc1 lds
    s_mul_i32 s28, s42, 288
    s_mul_i32 s29, s42, 9216
    s_add_u32 m0, s28, 41472
    s_add_u32 s29, s29, 3686400
    s_mov_b64 exec, s[44:45]
    buffer_load_dwordx4 v8, s[4:7], s29 offen sc1 lds
    s_mul_i32 s28, s42, 304
    s_mul_i32 s29, s42, 9344
    s_add_u32 m0, s28, 117504
    s_add_u32 s29, s29, 6064128
    s_mov_b64 exec, s[46:47]
    buffer_load_dwordx4 v9, s[4:7], s29 offen sc1 lds
    s_mul_i32 s28, s42, 288
    s_mul_i32 s29, s42, 9216
    s_add_u32 m0, s28, 44928
    s_add_u32 s29, s29, 3796992
    s_mov_b64 exec, s[44:45]
    buffer_load_dwordx4 v8, s[4:7], s29 offen sc1 lds
    s_mul_i32 s28, s42, 304
    s_mul_i32 s29, s42, 9344
    s_add_u32 m0, s28, 121152
    s_add_u32 s29, s29, 6176256
    s_mov_b64 exec, s[46:47]
    buffer_load_dwordx4 v9, s[4:7], s29 offen sc1 lds
    s_mul_i32 s28, s42, 288
    s_mul_i32 s29, s42, 9216
    s_add_u32 m0, s28, 48384
    s_add_u32 s29, s29, 3907584
    s_mov_b64 exec, s[44:45]
    buffer_load_dwordx4 v8, s[4:7], s29 offen sc1 lds
    s_mul_i32 s28, s42, 304
    s_mul_i32 s29, s42, 9344
    s_add_u32 m0, s28, 124800
    s_add_u32 s29, s29, 6288384
    s_mov_b64 exec, s[46:47]
    buffer_load_dwordx4 v9, s[4:7], s29 offen sc1 lds
    s_mul_i32 s28, s42, 288
    s_mul_i32 s29, s42, 9216
    s_add_u32 m0, s28, 51840
    s_add_u32 s29, s29, 4018176
    s_mov_b64 exec, s[44:45]
    buffer_load_dwordx4 v8, s[4:7], s29 offen sc1 lds
    s_mul_i32 s28, s42, 304
    s_mul_i32 s29, s42, 9344
    s_add_u32 m0, s28, 128448
    s_add_u32 s29, s29, 6400512
    s_mov_b64 exec, s[46:47]
    buffer_load_dwordx4 v9, s[4:7], s29 offen sc1 lds
    s_waitcnt vmcnt(16)
    s_mul_i32 s28, s42, 288
    s_mul_i32 s29, s42, 9216
    s_add_u32 m0, s28, 55296
    s_add_u32 s29, s29, 4128768
    s_mov_b64 exec, s[44:45]
    buffer_load_dwordx4 v8, s[4:7], s29 offen sc1 lds
    s_mul_i32 s28, s42, 304
    s_mul_i32 s29, s42, 9344
    s_add_u32 m0, s28, 132096
    s_add_u32 s29, s29, 6512640
    s_mov_b64 exec, s[46:47]
    buffer_load_dwordx4 v9, s[4:7], s29 offen sc1 lds
    s_mul_i32 s28, s42, 288
    s_mul_i32 s29, s42, 9216
    s_add_u32 m0, s28, 58752
    s_add_u32 s29, s29, 4239360
    s_mov_b64 exec, s[44:45]
    buffer_load_dwordx4 v8, s[4:7], s29 offen sc1 lds
    s_mul_i32 s28, s42, 304
    s_mul_i32 s29, s42, 9344
    s_add_u32 m0, s28, 135744
    s_add_u32 s29, s29, 6624768
    s_mov_b64 exec, s[46:47]
    buffer_load_dwordx4 v9, s[4:7], s29 offen sc1 lds
    s_mul_i32 s28, s42, 288
    s_mul_i32 s29, s42, 9216
    s_add_u32 m0, s28, 62208
    s_add_u32 s29, s29, 4349952
    s_mov_b64 exec, s[44:45]
    buffer_load_dwordx4 v8, s[4:7], s29 offen sc1 lds
    s_mul_i32 s28, s42, 304
    s_mul_i32 s29, s42, 9344
    s_add_u32 m0, s28, 139392
    s_add_u32 s29, s29, 6736896
    s_mov_b64 exec, s[46:47]
    buffer_load_dwordx4 v9, s[4:7], s29 offen sc1 lds
    s_mul_i32 s28, s42, 288
    s_mul_i32 s29, s42, 9216
    s_add_u32 m0, s28, 65664
    s_add_u32 s29, s29, 4460544
    s_mov_b64 exec, s[44:45]
    buffer_load_dwordx4 v8, s[4:7], s29 offen sc1 lds
    s_mul_i32 s28, s42, 304
    s_mul_i32 s29, s42, 9344
    s_add_u32 m0, s28, 143040
    s_add_u32 s29, s29, 6849024
    s_mov_b64 exec, s[46:47]
    buffer_load_dwordx4 v9, s[4:7], s29 offen sc1 lds
    s_mul_i32 s28, s42, 288
    s_mul_i32 s29, s42, 9216
    s_add_u32 m0, s28, 69120
    s_add_u32 s29, s29, 4571136
    s_mov_b64 exec, s[44:45]
    buffer_load_dwordx4 v8, s[4:7], s29 offen sc1 lds
    s_mul_i32 s28, s42, 304
    s_mul_i32 s29, s42, 9344
    s_add_u32 m0, s28, 146688
    s_add_u32 s29, s29, 6961152
    s_mov_b64 exec, s[46:47]
    buffer_load_dwordx4 v9, s[4:7], s29 offen sc1 lds
    s_min_u32 s42, s42, 1
    s_mul_i32 s28, s42, 288
    s_mul_i32 s29, s42, 9216
    s_add_u32 m0, s28, 72576
    s_add_u32 s29, s29, 4681728
    s_mov_b64 exec, s[44:45]
    buffer_load_dwordx4 v8, s[4:7], s29 offen sc1 lds
    s_mul_i32 s28, s42, 304
    s_mul_i32 s29, s42, 9344
    s_add_u32 m0, s28, 150336
    s_add_u32 s29, s29, 7073280
    s_mov_b64 exec, s[46:47]
    buffer_load_dwordx4 v9, s[4:7], s29 offen sc1 lds
    s_mov_b64 exec, -1
    s_add_u32 s32, s32, 1
    s_cmp_lt_u32 s32, 4
    s_cbranch_scc1 p3_re_n
    s_waitcnt vmcnt(0)
    s_mov_b64 exec, 1
    v_mov_b32 v3, 160804
    v_mov_b32 v4, 1
    ds_add_u32 v3, v4
    s_mov_b64 exec, -1
    v_mov_b32 v3, 160808
    s_mov_b32 s63, 2097152
lw_xn:
    ds_read_b32 v4, v3
    s_waitcnt lgkmcnt(0)
    v_readfirstlane_b32 s28, v4
    s_nop 0
    s_cmp_ge_u32 s28, s31
    s_cbranch_scc1 lw_xn_ok
    s_sleep 8
    s_sub_u32 s63, s63, 1
    s_cbranch_scc0 lw_xn
lw_xn_ok:
p3_ok_n:
p3_exit:
    s_endpgm
p3_oload:
    s_cmp_ge_u32 s2, 192
    s_cbranch_scc1 k2_exit
    s_and_b32 s16, s2, 7
    s_lshl_b32 s16, s16, 2
    s_bfe_u32 s29, s2, 0x20003
    s_add_u32 s16, s16, s29
    v_mov_b32 v5, 160828
    s_mul_i32 s33, s16, 73728
    s_add_u32 s33, s33, 7110656
    s_add_u32 s34, s33, 36864
    v_mov_b32 v11, 160832
    s_mov_b32 s63, 2097152
lw_ok:
    ds_read_b32 v12, v11
    s_waitcnt lgkmcnt(0)
    v_readfirstlane_b32 s28, v12
    s_nop 0
    s_cmp_ge_u32 s28, 1
    s_cbranch_scc1 lw_ok_ok
    s_sleep 1
    s_sub_u32 s63, s63, 1
    s_cbranch_scc0 lw_ok
lw_ok_ok:
    v_mov_b32 v11, 160816
    s_mov_b32 s63, 2097152
lw_q:
    ds_read_b128 v[12:15], v11
    s_waitcnt lgkmcnt(0)
    v_min3_u32 v12, v12, v13, v14
    s_nop 0
    v_readfirstlane_b32 s28, v12
    s_nop 0
    s_cmp_ge_u32 s28, 6
    s_cbranch_scc1 lw_q_ok
    s_sleep 1
    s_sub_u32 s63, s63, 1
    s_cbranch_scc0 lw_q
lw_q_ok:
    s_lshr_b32 s28, s16, 2
    s_lshl_b32 s28, s28, 8
    s_add_u32 s28, s28, 17479680
    v_mov_b32 v3, 0
    s_mov_b64 exec, 1
    s_mov_b32 s32, 0
poll_o:
    buffer_load_dword v4, v3, s[4:7], s28 offen sc1
    s_add_u32 s32, s32, 1
    s_waitcnt vmcnt(0)
    v_cmp_gt_u32 vcc, 32, v4
    s_cbranch_vccz polled_o
    s_sleep 1
    s_cmp_lt_u32 s32, 524288
    s_cbranch_scc1 poll_o
polled_o:
    s_mov_b64 exec, -1
    s_mov_b32 m0, 0
    s_nop 0
    buffer_load_dwordx4 v2, s[4:7], s33 offen sc1 lds
    s_mov_b32 m0, 1024
    s_nop 0
    buffer_load_dwordx4 v2, s[4:7], s34 offen sc1 lds
    s_mov_b32 m0, 2048
    s_add_u32 s33, s33, 1024
    buffer_load_dwordx4 v2, s[4:7], s33 offen sc1 lds
    s_mov_b32 m0, 3072
    s_add_u32 s34, s34, 1024
    buffer_load_dwordx4 v2, s[4:7], s34 offen sc1 lds
    s_mov_b32 m0, 4096
    s_add_u32 s33, s33, 1024
    buffer_load_dwordx4 v2, s[4:7], s33 offen sc1 lds
    s_mov_b32 m0, 5120
    s_add_u32 s34, s34, 1024
    buffer_load_dwordx4 v2, s[4:7], s34 offen sc1 lds
    s_mov_b32 m0, 6144
    s_add_u32 s33, s33, 1024
    buffer_load_dwordx4 v2, s[4:7], s33 offen sc1 lds
    s_mov_b32 m0, 7168
    s_add_u32 s34, s34, 1024
    buffer_load_dwordx4 v2, s[4:7], s34 offen sc1 lds
    s_mov_b32 m0, 8192
    s_add_u32 s33, s33, 1024
    buffer_load_dwordx4 v2, s[4:7], s33 offen sc1 lds
    s_mov_b32 m0, 9216
    s_add_u32 s34, s34, 1024
    buffer_load_dwordx4 v2, s[4:7], s34 offen sc1 lds
    s_mov_b32 m0, 10240
    s_add_u32 s33, s33, 1024
    buffer_load_dwordx4 v2, s[4:7], s33 offen sc1 lds
    s_mov_b32 m0, 11264
    s_add_u32 s34, s34, 1024
    buffer_load_dwordx4 v2, s[4:7], s34 offen sc1 lds
    s_add_u32 s33, s33, 1024
    s_add_u32 s34, s34, 1024
    s_mov_b32 m0, 12288
    s_nop 0
    buffer_load_dwordx4 v2, s[4:7], s33 offen sc1 lds
    s_mov_b32 m0, 13312
    s_nop 0
    buffer_load_dwordx4 v2, s[4:7], s34 offen sc1 lds
    s_mov_b32 m0, 14336
    s_add_u32 s33, s33, 1024
    buffer_load_dwordx4 v2, s[4:7], s33 offen sc1 lds
    s_mov_b32 m0, 15360
    s_add_u32 s34, s34, 1024
    buffer_load_dwordx4 v2, s[4:7], s34 offen sc1 lds
    s_mov_b32 m0, 16384
    s_add_u32 s33, s33, 1024
    buffer_load_dwordx4 v2, s[4:7], s33 offen sc1 lds
    s_mov_b32 m0, 17408
    s_add_u32 s34, s34, 1024
    buffer_load_dwordx4 v2, s[4:7], s34 offen sc1 lds
    s_mov_b32 m0, 18432
    s_add_u32 s33, s33, 1024
    buffer_load_dwordx4 v2, s[4:7], s33 offen sc1 lds
    s_mov_b32 m0, 19456
    s_add_u32 s34, s34, 1024
    buffer_load_dwordx4 v2, s[4:7], s34 offen sc1 lds
    s_mov_b32 m0, 20480
    s_add_u32 s33, s33, 1024
    buffer_load_dwordx4 v2, s[4:7], s33 offen sc1 lds
    s_mov_b32 m0, 21504
    s_add_u32 s34, s34, 1024
    buffer_load_dwordx4 v2, s[4:7], s34 offen sc1 lds
    s_mov_b32 m0, 22528
    s_add_u32 s33, s33, 1024
    buffer_load_dwordx4 v2, s[4:7], s33 offen sc1 lds
    s_mov_b32 m0, 23552
    s_add_u32 s34, s34, 1024
    buffer_load_dwordx4 v2, s[4:7], s34 offen sc1 lds
    s_add_u32 s33, s33, 1024
    s_add_u32 s34, s34, 1024
    v_mov_b32 v6, 13
    s_waitcnt vmcnt(12)
    ds_write_b32 v5, v6
    s_mov_b32 m0, 24576
    s_nop 0
    buffer_load_dwordx4 v2, s[4:7], s33 offen sc1 lds
    s_mov_b32 m0, 25600
    s_nop 0
    buffer_load_dwordx4 v2, s[4:7], s34 offen sc1 lds
    s_mov_b32 m0, 26624
    s_add_u32 s33, s33, 1024
    buffer_load_dwordx4 v2, s[4:7], s33 offen sc1 lds
    s_mov_b32 m0, 27648
    s_add_u32 s34, s34, 1024
    buffer_load_dwordx4 v2, s[4:7], s34 offen sc1 lds
    s_mov_b32 m0, 28672
    s_add_u32 s33, s33, 1024
    buffer_load_dwordx4 v2, s[4:7], s33 offen sc1 lds
    s_mov_b32 m0, 29696
    s_add_u32 s34, s34, 1024
    buffer_load_dwordx4 v2, s[4:7], s34 offen sc1 lds
    s_mov_b32 m0, 30720
    s_add_u32 s33, s33, 1024
    buffer_load_dwordx4 v2, s[4:7], s33 offen sc1 lds
    s_mov_b32 m0, 31744
    s_add_u32 s34, s34, 1024
    buffer_load_dwordx4 v2, s[4:7], s34 offen sc1 lds
    s_mov_b32 m0, 32768
    s_add_u32 s33, s33, 1024
    buffer_load_dwordx4 v2, s[4:7], s33 offen sc1 lds
    s_mov_b32 m0, 33792
    s_add_u32 s34, s34, 1024
    buffer_load_dwordx4 v2, s[4:7], s34 offen sc1 lds
    s_mov_b32 m0, 34816
    s_add_u32 s33, s33, 1024
    buffer_load_dwordx4 v2, s[4:7], s33 offen sc1 lds
    s_mov_b32 m0, 35840
    s_add_u32 s34, s34, 1024
    buffer_load_dwordx4 v2, s[4:7], s34 offen sc1 lds
    s_add_u32 s33, s33, 1024
    s_add_u32 s34, s34, 1024
    v_mov_b32 v6, 14
    s_waitcnt vmcnt(12)
    ds_write_b32 v5, v6
    s_mov_b32 m0, 36864
    s_nop 0
    buffer_load_dwordx4 v2, s[4:7], s33 offen sc1 lds
    s_mov_b32 m0, 37888
    s_nop 0
    buffer_load_dwordx4 v2, s[4:7], s34 offen sc1 lds
    s_mov_b32 m0, 38912
    s_add_u32 s33, s33, 1024
    buffer_load_dwordx4 v2, s[4:7], s33 offen sc1 lds
    s_mov_b32 m0, 39936
    s_add_u32 s34, s34, 1024
    buffer_load_dwordx4 v2, s[4:7], s34 offen sc1 lds
    s_mov_b32 m0, 40960
    s_add_u32 s33, s33, 1024
    buffer_load_dwordx4 v2, s[4:7], s33 offen sc1 lds
    s_mov_b32 m0, 41984
    s_add_u32 s34, s34, 1024
    buffer_load_dwordx4 v2, s[4:7], s34 offen sc1 lds
    s_mov_b32 m0, 43008
    s_add_u32 s33, s33, 1024
    buffer_load_dwordx4 v2, s[4:7], s33 offen sc1 lds
    s_mov_b32 m0, 44032
    s_add_u32 s34, s34, 1024
    buffer_load_dwordx4 v2, s[4:7], s34 offen sc1 lds
    s_mov_b32 m0, 45056
    s_add_u32 s33, s33, 1024
    buffer_load_dwordx4 v2, s[4:7], s33 offen sc1 lds
    s_mov_b32 m0, 46080
    s_add_u32 s34, s34, 1024
    buffer_load_dwordx4 v2, s[4:7], s34 offen sc1 lds
    s_mov_b32 m0, 47104
    s_add_u32 s33, s33, 1024
    buffer_load_dwordx4 v2, s[4:7], s33 offen sc1 lds
    s_mov_b32 m0, 48128
    s_add_u32 s34, s34, 1024
    buffer_load_dwordx4 v2, s[4:7], s34 offen sc1 lds
    s_add_u32 s33, s33, 1024
    s_add_u32 s34, s34, 1024
    v_mov_b32 v6, 15
    s_waitcnt vmcnt(12)
    ds_write_b32 v5, v6
    s_mov_b32 m0, 74752
    s_nop 0
    buffer_load_dwordx4 v2, s[4:7], s33 offen sc1 lds
    s_mov_b32 m0, 75776
    s_nop 0
    buffer_load_dwordx4 v2, s[4:7], s34 offen sc1 lds
    s_mov_b32 m0, 76800
    s_add_u32 s33, s33, 1024
    buffer_load_dwordx4 v2, s[4:7], s33 offen sc1 lds
    s_mov_b32 m0, 77824
    s_add_u32 s34, s34, 1024
    buffer_load_dwordx4 v2, s[4:7], s34 offen sc1 lds
    s_mov_b32 m0, 78848
    s_add_u32 s33, s33, 1024
    buffer_load_dwordx4 v2, s[4:7], s33 offen sc1 lds
    s_mov_b32 m0, 79872
    s_add_u32 s34, s34, 1024
    buffer_load_dwordx4 v2, s[4:7], s34 offen sc1 lds
    s_mov_b32 m0, 80896
    s_add_u32 s33, s33, 1024
    buffer_load_dwordx4 v2, s[4:7], s33 offen sc1 lds
    s_mov_b32 m0, 81920
    s_add_u32 s34, s34, 1024
    buffer_load_dwordx4 v2, s[4:7], s34 offen sc1 lds
    s_mov_b32 m0, 82944
    s_add_u32 s33, s33, 1024
    buffer_load_dwordx4 v2, s[4:7], s33 offen sc1 lds
    s_mov_b32 m0, 83968
    s_add_u32 s34, s34, 1024
    buffer_load_dwordx4 v2, s[4:7], s34 offen sc1 lds
    s_mov_b32 m0, 84992
    s_add_u32 s33, s33, 1024
    buffer_load_dwordx4 v2, s[4:7], s33 offen sc1 lds
    s_mov_b32 m0, 86016
    s_add_u32 s34, s34, 1024
    buffer_load_dwordx4 v2, s[4:7], s34 offen sc1 lds
    s_add_u32 s33, s33, 1024
    s_add_u32 s34, s34, 1024
    v_mov_b32 v6, 16
    s_waitcnt vmcnt(12)
    ds_write_b32 v5, v6
    s_mov_b32 m0, 87040
    s_nop 0
    buffer_load_dwordx4 v2, s[4:7], s33 offen sc1 lds
    s_mov_b32 m0, 88064
    s_nop 0
    buffer_load_dwordx4 v2, s[4:7], s34 offen sc1 lds
    s_mov_b32 m0, 89088
    s_add_u32 s33, s33, 1024
    buffer_load_dwordx4 v2, s[4:7], s33 offen sc1 lds
    s_mov_b32 m0, 90112
    s_add_u32 s34, s34, 1024
    buffer_load_dwordx4 v2, s[4:7], s34 offen sc1 lds
    s_mov_b32 m0, 91136
    s_add_u32 s33, s33, 1024
    buffer_load_dwordx4 v2, s[4:7], s33 offen sc1 lds
    s_mov_b32 m0, 92160
    s_add_u32 s34, s34, 1024
    buffer_load_dwordx4 v2, s[4:7], s34 offen sc1 lds
    s_mov_b32 m0, 93184
    s_add_u32 s33, s33, 1024
    buffer_load_dwordx4 v2, s[4:7], s33 offen sc1 lds
    s_mov_b32 m0, 94208
    s_add_u32 s34, s34, 1024
    buffer_load_dwordx4 v2, s[4:7], s34 offen sc1 lds
    s_mov_b32 m0, 95232
    s_add_u32 s33, s33, 1024
    buffer_load_dwordx4 v2, s[4:7], s33 offen sc1 lds
    s_mov_b32 m0, 96256
    s_add_u32 s34, s34, 1024
    buffer_load_dwordx4 v2, s[4:7], s34 offen sc1 lds
    s_mov_b32 m0, 97280
    s_add_u32 s33, s33, 1024
    buffer_load_dwordx4 v2, s[4:7], s33 offen sc1 lds
    s_mov_b32 m0, 98304
    s_add_u32 s34, s34, 1024
    buffer_load_dwordx4 v2, s[4:7], s34 offen sc1 lds
    s_add_u32 s33, s33, 1024
    s_add_u32 s34, s34, 1024
    v_mov_b32 v6, 17
    s_waitcnt vmcnt(12)
    ds_write_b32 v5, v6
    v_mov_b32 v6, 18
    s_waitcnt vmcnt(0)
    ds_write_b32 v5, v6
    s_waitcnt lgkmcnt(0)
    s_endpgm
p3_tile:
    s_and_b32 s16, s2, 7
    s_lshl_b32 s16, s16, 2
    s_bfe_u32 s29, s2, 0x20003
    s_add_u32 s16, s16, s29
    s_lshr_b32 s17, s2, 5
    s_lshl_b32 s28, s16, 8
    s_add_u32 s28, s28, 17471488
    v_mov_b32 v3, 0
    s_mov_b64 exec, 1
    s_mov_b32 s32, 0
poll_h:
    buffer_load_dword v4, v3, s[4:7], s28 offen sc1
    s_add_u32 s32, s32, 1
    s_waitcnt vmcnt(0)
    v_cmp_gt_u32 vcc, 8, v4
    s_cbranch_vccz polled_h
    s_sleep 6
    s_cmp_lt_u32 s32, 524288
    s_cbranch_scc1 poll_h
polled_h:
    s_mov_b64 exec, -1
    s_mov_b32 s28, 17468928
    s_mov_b64 exec, 1
    s_mov_b32 s32, 0
poll_w:
    buffer_load_dword v4, v3, s[4:7], s28 offen sc1
    s_add_u32 s32, s32, 1
    s_waitcnt vmcnt(0)
    v_cmp_gt_u32 vcc, 32, v4
    s_cbranch_vccz polled_w
    s_sleep 16
    s_cmp_lt_u32 s32, 524288
    s_cbranch_scc1 poll_w
polled_w:
    s_mov_b64 exec, -1
    s_cmp_lt_u32 s36, 3
    s_cbranch_scc1 p3_cp
    v_mov_b32 v5, 160812
    s_mul_i32 s33, s16, 147456
    s_add_u32 s33, s33, 9469952
    s_add_u32 s34, s33, 73728
    s_add_u32 s28, s33, 61440
    buffer_load_dwordx4 v[16:19], v2, s[4:7], s28 offen offset:0 sc1
    buffer_load_dwordx4 v[24:27], v2, s[4:7], s28 offen offset:1024 sc1
    buffer_load_dwordx4 v[32:35], v2, s[4:7], s28 offen offset:2048 sc1
    buffer_load_dwordx4 v[40:43], v2, s[4:7], s28 offen offset:3072 sc1
    s_add_u32 s28, s28, 4096
    buffer_load_dwordx4 v[48:51], v2, s[4:7], s28 offen offset:0 sc1
    buffer_load_dwordx4 v[56:59], v2, s[4:7], s28 offen offset:1024 sc1
    buffer_load_dwordx4 v[64:67], v2, s[4:7], s28 offen offset:2048 sc1
    buffer_load_dwordx4 v[72:75], v2, s[4:7], s28 offen offset:3072 sc1
    s_add_u32 s28, s28, 4096
    buffer_load_dwordx4 v[80:83], v2, s[4:7], s28 offen offset:0 sc1
    buffer_load_dwordx4 v[88:91], v2, s[4:7], s28 offen offset:1024 sc1
    buffer_load_dwordx4 v[96:99], v2, s[4:7], s28 offen offset:2048 sc1
    buffer_load_dwordx4 v[104:107], v2, s[4:7], s28 offen offset:3072 sc1
    s_add_u32 s28, s28, 4096
    s_add_u32 s28, s34, 61440
    buffer_load_dwordx4 v[20:23], v2, s[4:7], s28 offen offset:0 sc1
    buffer_load_dwordx4 v[28:31], v2, s[4:7], s28 offen offset:1024 sc1
    buffer_load_dwordx4 v[36:39], v2, s[4:7], s28 offen offset:2048 sc1
    buffer_load_dwordx4 v[44:47], v2, s[4:7], s28 offen offset:3072 sc1
    s_add_u32 s28, s28, 4096
    buffer_load_dwordx4 v[52:55], v2, s[4:7], s28 offen offset:0 sc1
    buffer_load_dwordx4 v[60:63], v2, s[4:7], s28 offen offset:1024 sc1
    buffer_load_dwordx4 v[68:71], v2, s[4:7], s28 offen offset:2048 sc1
    buffer_load_dwordx4 v[76:79], v2, s[4:7], s28 offen offset:3072 sc1
    s_add_u32 s28, s28, 4096
    buffer_load_dwordx4 v[84:87], v2, s[4:7], s28 offen offset:0 sc1
    buffer_load_dwordx4 v[92:95], v2, s[4:7], s28 offen offset:1024 sc1
    buffer_load_dwordx4 v[100:103], v2, s[4:7], s28 offen offset:2048 sc1
    buffer_load_dwordx4 v[108:111], v2, s[4:7], s28 offen offset:3072 sc1
    s_add_u32 s28, s28, 4096
    v_mov_b32 v3, 160784
    s_mov_b32 s63, 2097152
lw_c:
    ds_read_b32 v4, v3
    s_waitcnt lgkmcnt(0)
    v_readfirstlane_b32 s28, v4
    s_nop 0
    s_cmp_ge_u32 s28, 8
    s_cbranch_scc1 lw_c_ok
    s_sleep 8
    s_sub_u32 s63, s63, 1
    s_cbranch_scc0 lw_c
lw_c_ok:
    s_mov_b32 m0, 0
    s_nop 0
    buffer_load_dwordx4 v2, s[4:7], s33 offen sc1 lds
    s_mov_b32 m0, 1024
    s_nop 0
    buffer_load_dwordx4 v2, s[4:7], s34 offen sc1 lds
    s_mov_b32 m0, 2048
    s_add_u32 s33, s33, 1024
    buffer_load_dwordx4 v2, s[4:7], s33 offen sc1 lds
    s_mov_b32 m0, 3072
    s_add_u32 s34, s34, 1024
    buffer_load_dwordx4 v2, s[4:7], s34 offen sc1 lds
    s_mov_b32 m0, 4096
    s_add_u32 s33, s33, 1024
    buffer_load_dwordx4 v2, s[4:7], s33 offen sc1 lds
    s_mov_b32 m0, 5120
    s_add_u32 s34, s34, 1024
    buffer_load_dwordx4 v2, s[4:7], s34 offen sc1 lds
    s_mov_b32 m0, 6144
    s_add_u32 s33, s33, 1024
    buffer_load_dwordx4 v2, s[4:7], s33 offen sc1 lds
    s_mov_b32 m0, 7168
    s_add_u32 s34, s34, 1024
    buffer_load_dwordx4 v2, s[4:7], s34 offen sc1 lds
    s_mov_b32 m0, 8192
    s_add_u32 s33, s33, 1024
    buffer_load_dwordx4 v2, s[4:7], s33 offen sc1 lds
    s_mov_b32 m0, 9216
    s_add_u32 s34, s34, 1024
    buffer_load_dwordx4 v2, s[4:7], s34 offen sc1 lds
    s_mov_b32 m0, 10240
    s_add_u32 s33, s33, 1024
    buffer_load_dwordx4 v2, s[4:7], s33 offen sc1 lds
    s_mov_b32 m0, 11264
    s_add_u32 s34, s34, 1024
    buffer_load_dwordx4 v2, s[4:7], s34 offen sc1 lds
    s_add_u32 s33, s33, 1024
    s_add_u32 s34, s34, 1024
    s_mov_b32 m0, 12288
    s_nop 0
    buffer_load_dwordx4 v2, s[4:7], s33 offen sc1 lds
    s_mov_b32 m0, 13312
    s_nop 0
    buffer_load_dwordx4 v2, s[4:7], s34 offen sc1 lds
    s_mov_b32 m0, 14336
    s_add_u32 s33, s33, 1024
    buffer_load_dwordx4 v2, s[4:7], s33 offen sc1 lds
    s_mov_b32 m0, 15360
    s_add_u32 s34, s34, 1024
    buffer_load_dwordx4 v2, s[4:7], s34 offen sc1 lds
    s_mov_b32 m0, 16384
    s_add_u32 s33, s33, 1024
    buffer_load_dwordx4 v2, s[4:7], s33 offen sc1 lds
    s_mov_b32 m0, 17408
    s_add_u32 s34, s34, 1024
    buffer_load_dwordx4 v2, s[4:7], s34 offen sc1 lds
    s_mov_b32 m0, 18432
    s_add_u32 s33, s33, 1024
    buffer_load_dwordx4 v2, s[4:7], s33 offen sc1 lds
    s_mov_b32 m0, 19456
    s_add_u32 s34, s34, 1024
    buffer_load_dwordx4 v2, s[4:7], s34 offen sc1 lds
    s_mov_b32 m0, 20480
    s_add_u32 s33, s33, 1024
    buffer_load_dwordx4 v2, s[4:7], s33 offen sc1 lds
    s_mov_b32 m0, 21504
    s_add_u32 s34, s34, 1024
    buffer_load_dwordx4 v2, s[4:7], s34 offen sc1 lds
    s_mov_b32 m0, 22528
    s_add_u32 s33, s33, 1024
    buffer_load_dwordx4 v2, s[4:7], s33 offen sc1 lds
    s_mov_b32 m0, 23552
    s_add_u32 s34, s34, 1024
    buffer_load_dwordx4 v2, s[4:7], s34 offen sc1 lds
    s_add_u32 s33, s33, 1024
    s_add_u32 s34, s34, 1024
    s_mov_b32 m0, 24576
    s_nop 0
    buffer_load_dwordx4 v2, s[4:7], s33 offen sc1 lds
    s_mov_b32 m0, 25600
    s_nop 0
    buffer_load_dwordx4 v2, s[4:7], s34 offen sc1 lds
    s_mov_b32 m0, 26624
    s_add_u32 s33, s33, 1024
    buffer_load_dwordx4 v2, s[4:7], s33 offen sc1 lds
    s_mov_b32 m0, 27648
    s_add_u32 s34, s34, 1024
    buffer_load_dwordx4 v2, s[4:7], s34 offen sc1 lds
    s_mov_b32 m0, 28672
    s_add_u32 s33, s33, 1024
    buffer_load_dwordx4 v2, s[4:7], s33 offen sc1 lds
    s_mov_b32 m0, 29696
    s_add_u32 s34, s34, 1024
    buffer_load_dwordx4 v2, s[4:7], s34 offen sc1 lds
    s_mov_b32 m0, 30720
    s_add_u32 s33, s33, 1024
    buffer_load_dwordx4 v2, s[4:7], s33 offen sc1 lds
    s_mov_b32 m0, 31744
    s_add_u32 s34, s34, 1024
    buffer_load_dwordx4 v2, s[4:7], s34 offen sc1 lds
    s_mov_b32 m0, 32768
    s_add_u32 s33, s33, 1024
    buffer_load_dwordx4 v2, s[4:7], s33 offen sc1 lds
    s_mov_b32 m0, 33792
    s_add_u32 s34, s34, 1024
    buffer_load_dwordx4 v2, s[4:7], s34 offen sc1 lds
    s_mov_b32 m0, 34816
    s_add_u32 s33, s33, 1024
    buffer_load_dwordx4 v2, s[4:7], s33 offen sc1 lds
    s_mov_b32 m0, 35840
    s_add_u32 s34, s34, 1024
    buffer_load_dwordx4 v2, s[4:7], s34 offen sc1 lds
    s_add_u32 s33, s33, 1024
    s_add_u32 s34, s34, 1024
    s_mov_b32 m0, 36864
    s_nop 0
    buffer_load_dwordx4 v2, s[4:7], s33 offen sc1 lds
    s_mov_b32 m0, 37888
    s_nop 0
    buffer_load_dwordx4 v2, s[4:7], s34 offen sc1 lds
    s_mov_b32 m0, 38912
    s_add_u32 s33, s33, 1024
    buffer_load_dwordx4 v2, s[4:7], s33 offen sc1 lds
    s_mov_b32 m0, 39936
    s_add_u32 s34, s34, 1024
    buffer_load_dwordx4 v2, s[4:7], s34 offen sc1 lds
    s_mov_b32 m0, 40960
    s_add_u32 s33, s33, 1024
    buffer_load_dwordx4 v2, s[4:7], s33 offen sc1 lds
    s_mov_b32 m0, 41984
    s_add_u32 s34, s34, 1024
    buffer_load_dwordx4 v2, s[4:7], s34 offen sc1 lds
    s_mov_b32 m0, 43008
    s_add_u32 s33, s33, 1024
    buffer_load_dwordx4 v2, s[4:7], s33 offen sc1 lds
    s_mov_b32 m0, 44032
    s_add_u32 s34, s34, 1024
    buffer_load_dwordx4 v2, s[4:7], s34 offen sc1 lds
    s_mov_b32 m0, 45056
    s_add_u32 s33, s33, 1024
    buffer_load_dwordx4 v2, s[4:7], s33 offen sc1 lds
    s_mov_b32 m0, 46080
    s_add_u32 s34, s34, 1024
    buffer_load_dwordx4 v2, s[4:7], s34 offen sc1 lds
    s_mov_b32 m0, 47104
    s_add_u32 s33, s33, 1024
    buffer_load_dwordx4 v2, s[4:7], s33 offen sc1 lds
    s_mov_b32 m0, 48128
    s_add_u32 s34, s34, 1024
    buffer_load_dwordx4 v2, s[4:7], s34 offen sc1 lds
    s_add_u32 s33, s33, 1024
    s_add_u32 s34, s34, 1024
    s_waitcnt vmcnt(36)
    s_mov_b32 m0, 74752
    s_nop 0
    buffer_load_dwordx4 v2, s[4:7], s33 offen sc1 lds
    s_mov_b32 m0, 75776
    s_nop 0
    buffer_load_dwordx4 v2, s[4:7], s34 offen sc1 lds
    s_mov_b32 m0, 76800
    s_add_u32 s33, s33, 1024
    buffer_load_dwordx4 v2, s[4:7], s33 offen sc1 lds
    s_mov_b32 m0, 77824
    s_add_u32 s34, s34, 1024
    buffer_load_dwordx4 v2, s[4:7], s34 offen sc1 lds
    s_mov_b32 m0, 78848
    s_add_u32 s33, s33, 1024
    buffer_load_dwordx4 v2, s[4:7], s33 offen sc1 lds
    s_mov_b32 m0, 79872
    s_add_u32 s34, s34, 1024
    buffer_load_dwordx4 v2, s[4:7], s34 offen sc1 lds
    s_mov_b32 m0, 80896
    s_add_u32 s33, s33, 1024
    buffer_load_dwordx4 v2, s[4:7], s33 offen sc1 lds
    s_mov_b32 m0, 81920
    s_add_u32 s34, s34, 1024
    buffer_load_dwordx4 v2, s[4:7], s34 offen sc1 lds
    s_mov_b32 m0, 82944
    s_add_u32 s33, s33, 1024
    buffer_load_dwordx4 v2, s[4:7], s33 offen sc1 lds
    s_mov_b32 m0, 83968
    s_add_u32 s34, s34, 1024
    buffer_load_dwordx4 v2, s[4:7], s34 offen sc1 lds
    s_mov_b32 m0, 84992
    s_add_u32 s33, s33, 1024
    buffer_load_dwordx4 v2, s[4:7], s33 offen sc1 lds
    s_mov_b32 m0, 86016
    s_add_u32 s34, s34, 1024
    buffer_load_dwordx4 v2, s[4:7], s34 offen sc1 lds
    s_add_u32 s33, s33, 1024
    s_add_u32 s34, s34, 1024
    s_waitcnt vmcnt(36)
    s_mov_b32 m0, 87040
    s_nop 0
    buffer_load_dwordx4 v2, s[4:7], s33 offen sc1 lds
    s_mov_b32 m0, 88064
    s_nop 0
    buffer_load_dwordx4 v2, s[4:7], s34 offen sc1 lds
    s_mov_b32 m0, 89088
    s_add_u32 s33, s33, 1024
    buffer_load_dwordx4 v2, s[4:7], s33 offen sc1 lds
    s_mov_b32 m0, 90112
    s_add_u32 s34, s34, 1024
    buffer_load_dwordx4 v2, s[4:7], s34 offen sc1 lds
    s_mov_b32 m0, 91136
    s_add_u32 s33, s33, 1024
    buffer_load_dwordx4 v2, s[4:7], s33 offen sc1 lds
    s_mov_b32 m0, 92160
    s_add_u32 s34, s34, 1024
    buffer_load_dwordx4 v2, s[4:7], s34 offen sc1 lds
    s_mov_b32 m0, 93184
    s_add_u32 s33, s33, 1024
    buffer_load_dwordx4 v2, s[4:7], s33 offen sc1 lds
    s_mov_b32 m0, 94208
    s_add_u32 s34, s34, 1024
    buffer_load_dwordx4 v2, s[4:7], s34 offen sc1 lds
    s_mov_b32 m0, 95232
    s_add_u32 s33, s33, 1024
    buffer_load_dwordx4 v2, s[4:7], s33 offen sc1 lds
    s_mov_b32 m0, 96256
    s_add_u32 s34, s34, 1024
    buffer_load_dwordx4 v2, s[4:7], s34 offen sc1 lds
    s_mov_b32 m0, 97280
    s_add_u32 s33, s33, 1024
    buffer_load_dwordx4 v2, s[4:7], s33 offen sc1 lds
    s_mov_b32 m0, 98304
    s_add_u32 s34, s34, 1024
    buffer_load_dwordx4 v2, s[4:7], s34 offen sc1 lds
    s_add_u32 s33, s33, 1024
    s_add_u32 s34, s34, 1024
    s_waitcnt vmcnt(36)
    s_mov_b32 m0, 99328
    s_nop 0
    buffer_load_dwordx4 v2, s[4:7], s33 offen sc1 lds
    s_mov_b32 m0, 100352
    s_nop 0
    buffer_load_dwordx4 v2, s[4:7], s34 offen sc1 lds
    s_mov_b32 m0, 101376
    s_add_u32 s33, s33, 1024
    buffer_load_dwordx4 v2, s[4:7], s33 offen sc1 lds
    s_mov_b32 m0, 102400
    s_add_u32 s34, s34, 1024
    buffer_load_dwordx4 v2, s[4:7], s34 offen sc1 lds
    s_mov_b32 m0, 103424
    s_add_u32 s33, s33, 1024
    buffer_load_dwordx4 v2, s[4:7], s33 offen sc1 lds
    s_mov_b32 m0, 104448
    s_add_u32 s34, s34, 1024
    buffer_load_dwordx4 v2, s[4:7], s34 offen sc1 lds
    s_mov_b32 m0, 105472
    s_add_u32 s33, s33, 1024
    buffer_load_dwordx4 v2, s[4:7], s33 offen sc1 lds
    s_mov_b32 m0, 106496
    s_add_u32 s34, s34, 1024
    buffer_load_dwordx4 v2, s[4:7], s34 offen sc1 lds
    s_mov_b32 m0, 107520
    s_add_u32 s33, s33, 1024
    buffer_load_dwordx4 v2, s[4:7], s33 offen sc1 lds
    s_mov_b32 m0, 108544
    s_add_u32 s34, s34, 1024
    buffer_load_dwordx4 v2, s[4:7], s34 offen sc1 lds
    s_mov_b32 m0, 109568
    s_add_u32 s33, s33, 1024
    buffer_load_dwordx4 v2, s[4:7], s33 offen sc1 lds
    s_mov_b32 m0, 110592
    s_add_u32 s34, s34, 1024
    buffer_load_dwordx4 v2, s[4:7], s34 offen sc1 lds
    s_add_u32 s33, s33, 1024
    s_add_u32 s34, s34, 1024
    s_waitcnt vmcnt(36)
    s_mov_b32 m0, 111616
    s_nop 0
    buffer_load_dwordx4 v2, s[4:7], s33 offen sc1 lds
    s_mov_b32 m0, 112640
    s_nop 0
    buffer_load_dwordx4 v2, s[4:7], s34 offen sc1 lds
    s_mov_b32 m0, 113664
    s_add_u32 s33, s33, 1024
    buffer_load_dwordx4 v2, s[4:7], s33 offen sc1 lds
    s_mov_b32 m0, 114688
    s_add_u32 s34, s34, 1024
    buffer_load_dwordx4 v2, s[4:7], s34 offen sc1 lds
    s_mov_b32 m0, 115712
    s_add_u32 s33, s33, 1024
    buffer_load_dwordx4 v2, s[4:7], s33 offen sc1 lds
    s_mov_b32 m0, 116736
    s_add_u32 s34, s34, 1024
    buffer_load_dwordx4 v2, s[4:7], s34 offen sc1 lds
    s_mov_b32 m0, 117760
    s_add_u32 s33, s33, 1024
    buffer_load_dwordx4 v2, s[4:7], s33 offen sc1 lds
    s_mov_b32 m0, 118784
    s_add_u32 s34, s34, 1024
    buffer_load_dwordx4 v2, s[4:7], s34 offen sc1 lds
    s_mov_b32 m0, 119808
    s_add_u32 s33, s33, 1024
    buffer_load_dwordx4 v2, s[4:7], s33 offen sc1 lds
    s_mov_b32 m0, 120832
    s_add_u32 s34, s34, 1024
    buffer_load_dwordx4 v2, s[4:7], s34 offen sc1 lds
    s_mov_b32 m0, 121856
    s_add_u32 s33, s33, 1024
    buffer_load_dwordx4 v2, s[4:7], s33 offen sc1 lds
    s_mov_b32 m0, 122880
    s_add_u32 s34, s34, 1024
    buffer_load_dwordx4 v2, s[4:7], s34 offen sc1 lds
    s_add_u32 s33, s33, 1024
    s_add_u32 s34, s34, 1024
    s_waitcnt vmcnt(36)
    v_mov_b32 v6, 8
    s_waitcnt vmcnt(0)
    ds_write_b32 v5, v6
    v_mov_b32 v3, 160788
    s_mov_b32 s63, 2097152
lw_c2:
    ds_read_b32 v4, v3
    s_waitcnt lgkmcnt(0)
    v_readfirstlane_b32 s28, v4
    s_nop 0
    s_cmp_ge_u32 s28, 8
    s_cbranch_scc1 lw_c2_ok
    s_sleep 4
    s_sub_u32 s63, s63, 1
    s_cbranch_scc0 lw_c2
lw_c2_ok:
    s_mov_b32 m0, 49152
    s_nop 0
    buffer_load_dwordx4 v2, s[4:7], s33 offen sc1 lds
    s_mov_b32 m0, 50176
    s_nop 0
    buffer_load_dwordx4 v2, s[4:7], s34 offen sc1 lds
    s_mov_b32 m0, 51200
    s_add_u32 s33, s33, 1024
    buffer_load_dwordx4 v2, s[4:7], s33 offen sc1 lds
    s_mov_b32 m0, 52224
    s_add_u32 s34, s34, 1024
    buffer_load_dwordx4 v2, s[4:7], s34 offen sc1 lds
    s_mov_b32 m0, 53248
    s_add_u32 s33, s33, 1024
    buffer_load_dwordx4 v2, s[4:7], s33 offen sc1 lds
    s_mov_b32 m0, 54272
    s_add_u32 s34, s34, 1024
    buffer_load_dwordx4 v2, s[4:7], s34 offen sc1 lds
    s_mov_b32 m0, 55296
    s_add_u32 s33, s33, 1024
    buffer_load_dwordx4 v2, s[4:7], s33 offen sc1 lds
    s_mov_b32 m0, 56320
    s_add_u32 s34, s34, 1024
    buffer_load_dwordx4 v2, s[4:7], s34 offen sc1 lds
    s_mov_b32 m0, 57344
    s_add_u32 s33, s33, 1024
    buffer_load_dwordx4 v2, s[4:7], s33 offen sc1 lds
    s_mov_b32 m0, 58368
    s_add_u32 s34, s34, 1024
    buffer_load_dwordx4 v2, s[4:7], s34 offen sc1 lds
    s_mov_b32 m0, 59392
    s_add_u32 s33, s33, 1024
    buffer_load_dwordx4 v2, s[4:7], s33 offen sc1 lds
    s_mov_b32 m0, 60416
    s_add_u32 s34, s34, 1024
    buffer_load_dwordx4 v2, s[4:7], s34 offen sc1 lds
    s_add_u32 s33, s33, 1024
    s_add_u32 s34, s34, 1024
    s_mov_b32 m0, 123904
    s_nop 0
    buffer_load_dwordx4 v2, s[4:7], s33 offen sc1 lds
    s_mov_b32 m0, 124928
    s_nop 0
    buffer_load_dwordx4 v2, s[4:7], s34 offen sc1 lds
    s_mov_b32 m0, 125952
    s_add_u32 s33, s33, 1024
    buffer_load_dwordx4 v2, s[4:7], s33 offen sc1 lds
    s_mov_b32 m0, 126976
    s_add_u32 s34, s34, 1024
    buffer_load_dwordx4 v2, s[4:7], s34 offen sc1 lds
    s_mov_b32 m0, 128000
    s_add_u32 s33, s33, 1024
    buffer_load_dwordx4 v2, s[4:7], s33 offen sc1 lds
    s_mov_b32 m0, 129024
    s_add_u32 s34, s34, 1024
    buffer_load_dwordx4 v2, s[4:7], s34 offen sc1 lds
    s_mov_b32 m0, 130048
    s_add_u32 s33, s33, 1024
    buffer_load_dwordx4 v2, s[4:7], s33 offen sc1 lds
    s_mov_b32 m0, 131072
    s_add_u32 s34, s34, 1024
    buffer_load_dwordx4 v2, s[4:7], s34 offen sc1 lds
    s_mov_b32 m0, 132096
    s_add_u32 s33, s33, 1024
    buffer_load_dwordx4 v2, s[4:7], s33 offen sc1 lds
    s_mov_b32 m0, 133120
    s_add_u32 s34, s34, 1024
    buffer_load_dwordx4 v2, s[4:7], s34 offen sc1 lds
    s_mov_b32 m0, 134144
    s_add_u32 s33, s33, 1024
    buffer_load_dwordx4 v2, s[4:7], s33 offen sc1 lds
    s_mov_b32 m0, 135168
    s_add_u32 s34, s34, 1024
    buffer_load_dwordx4 v2, s[4:7], s34 offen sc1 lds
    s_add_u32 s33, s33, 1024
    s_add_u32 s34, s34, 1024
    v_mov_b32 v6, 10
    s_waitcnt vmcnt(0)
    ds_write_b32 v5, v6
    v_mov_b32 v3, 160796
    s_mov_b32 s63, 2097152
lw_dt:
    ds_read_b32 v4, v3
    s_waitcnt lgkmcnt(0)
    v_readfirstlane_b32 s28, v4
    s_nop 0
    s_cmp_ge_u32 s28, 8
    s_cbranch_scc1 lw_dt_ok
    s_sleep 1
    s_sub_u32 s63, s63, 1
    s_cbranch_scc0 lw_dt
lw_dt_ok:
    v_mov_b32 v3, 160792
    ds_read_b32 v4, v3
    s_waitcnt lgkmcnt(0)
    v_readfirstlane_b32 s31, v4
    s_nop 0
    s_cmp_eq_u32 s31, 0
    s_cbranch_scc1 p3_ok_t
    v_mov_b32 v11, 160816
    s_mov_b32 s63, 2097152
lw_pt:
    ds_read_b128 v[12:15], v11
    s_waitcnt lgkmcnt(0)
    v_min3_u32 v12, v12, v13, v14
    s_nop 0
    v_readfirstlane_b32 s28, v12
    s_nop 0
    s_cmp_ge_u32 s28, 10
    s_cbranch_scc1 lw_pt_ok
    s_sleep 8
    s_sub_u32 s63, s63, 1
    s_cbranch_scc0 lw_pt
lw_pt_ok:
    s_mov_b32 s32, 0
p3_re_t:
    v_mul_u32_u24 v8, 3641, v1
    v_lshrrev_b32 v8, 16, v8
    v_mul_u32_u24 v8, 8928, v8
    s_mul_i32 s28, s26, 288
    v_add3_u32 v8, v8, v2, s28
    v_mul_u32_u24 v9, 3450, v1
    v_lshrrev_b32 v9, 16, v9
    v_mul_u32_u24 v10, 19, v9
    v_sub_u32 v10, v1, v10
    v_cmp_eq_u32 vcc, 18, v10
    v_lshl_add_u32 v10, v10, 4, s28
    v_mov_b32 v11, 9216
    v_cndmask_b32 v10, v10, v11, vcc
    v_mul_u32_u24 v9, 9344, v9
    v_add_u32 v9, v9, v10
    s_mov_b32 s44, -1
    s_mov_b32 s45, 4194303
    s_mov_b32 s46, -1
    s_mov_b32 s47, 33554431
    s_mul_i32 s42, s32, 3
    s_mul_i32 s28, s42, 288
    s_mul_i32 s29, s42, 9216
    s_add_u32 m0, s28, 0
    s_add_u32 s29, s29, 2359296
    s_mov_b64 exec, s[44:45]
    buffer_load_dwordx4 v8, s[4:7], s29 offen sc1 lds
    s_mul_i32 s28, s42, 304
    s_mul_i32 s29, s42, 9344
    s_add_u32 m0, s28, 73728
    s_add_u32 s29, s29, 4718592
    s_mov_b64 exec, s[46:47]
    buffer_load_dwordx4 v9, s[4:7], s29 offen sc1 lds
    s_mul_i32 s28, s42, 288
    s_mul_i32 s29, s42, 9216
    s_add_u32 m0, s28, 3456
    s_add_u32 s29, s29, 2469888
    s_mov_b64 exec, s[44:45]
    buffer_load_dwordx4 v8, s[4:7], s29 offen sc1 lds
    s_mul_i32 s28, s42, 304
    s_mul_i32 s29, s42, 9344
    s_add_u32 m0, s28, 77376
    s_add_u32 s29, s29, 4830720
    s_mov_b64 exec, s[46:47]
    buffer_load_dwordx4 v9, s[4:7], s29 offen sc1 lds
    s_mul_i32 s28, s42, 288
    s_mul_i32 s29, s42, 9216
    s_add_u32 m0, s28, 6912
    s_add_u32 s29, s29, 2580480
    s_mov_b64 exec, s[44:45]
    buffer_load_dwordx4 v8, s[4:7], s29 offen sc1 lds
    s_mul_i32 s28, s42, 304
    s_mul_i32 s29, s42, 9344
    s_add_u32 m0, s28, 81024
    s_add_u32 s29, s29, 4942848
    s_mov_b64 exec, s[46:47]
    buffer_load_dwordx4 v9, s[4:7], s29 offen sc1 lds
    s_mul_i32 s28, s42, 288
    s_mul_i32 s29, s42, 9216
    s_add_u32 m0, s28, 10368
    s_add_u32 s29, s29, 2691072
    s_mov_b64 exec, s[44:45]
    buffer_load_dwordx4 v8, s[4:7], s29 offen sc1 lds
    s_mul_i32 s28, s42, 304
    s_mul_i32 s29, s42, 9344
    s_add_u32 m0, s28, 84672
    s_add_u32 s29, s29, 5054976
    s_mov_b64 exec, s[46:47]
    buffer_load_dwordx4 v9, s[4:7], s29 offen sc1 lds
    s_mul_i32 s28, s42, 288
    s_mul_i32 s29, s42, 9216
    s_add_u32 m0, s28, 13824
    s_add_u32 s29, s29, 2801664
    s_mov_b64 exec, s[44:45]
    buffer_load_dwordx4 v8, s[4:7], s29 offen sc1 lds
    s_mul_i32 s28, s42, 304
    s_mul_i32 s29, s42, 9344
    s_add_u32 m0, s28, 88320
    s_add_u32 s29, s29, 5167104
    s_mov_b64 exec, s[46:47]
    buffer_load_dwordx4 v9, s[4:7], s29 offen sc1 lds
    s_mul_i32 s28, s42, 288
    s_mul_i32 s29, s42, 9216
    s_add_u32 m0, s28, 17280
    s_add_u32 s29, s29, 2912256
    s_mov_b64 exec, s[44:45]
    buffer_load_dwordx4 v8, s[4:7], s29 offen sc1 lds
    s_mul_i32 s28, s42, 304
    s_mul_i32 s29, s42, 9344
    s_add_u32 m0, s28, 91968
    s_add_u32 s29, s29, 5279232
    s_mov_b64 exec, s[46:47]
    buffer_load_dwordx4 v9, s[4:7], s29 offen sc1 lds
    s_mul_i32 s28, s42, 288
    s_mul_i32 s29, s42, 9216
    s_add_u32 m0, s28, 20736
    s_add_u32 s29, s29, 3022848
    s_mov_b64 exec, s[44:45]
    buffer_load_dwordx4 v8, s[4:7], s29 offen sc1 lds
    s_mul_i32 s28, s42, 304
    s_mul_i32 s29, s42, 9344
    s_add_u32 m0, s28, 95616
    s_add_u32 s29, s29, 5391360
    s_mov_b64 exec, s[46:47]
    buffer_load_dwordx4 v9, s[4:7], s29 offen sc1 lds
    s_mul_i32 s28, s42, 288
    s_mul_i32 s29, s42, 9216
    s_add_u32 m0, s28, 24192
    s_add_u32 s29, s29, 3133440
    s_mov_b64 exec, s[44:45]
    buffer_load_dwordx4 v8, s[4:7], s29 offen sc1 lds
    s_mul_i32 s28, s42, 304
    s_mul_i32 s29, s42, 9344
    s_add_u32 m0, s28, 99264
    s_add_u32 s29, s29, 5503488
    s_mov_b64 exec, s[46:47]
    buffer_load_dwordx4 v9, s[4:7], s29 offen sc1 lds
    s_waitcnt vmcnt(16)
    s_mul_i32 s28, s42, 288
    s_mul_i32 s29, s42, 9216
    s_add_u32 m0, s28, 27648
    s_add_u32 s29, s29, 3244032
    s_mov_b64 exec, s[44:45]
    buffer_load_dwordx4 v8, s[4:7], s29 offen sc1 lds
    s_mul_i32 s28, s42, 304
    s_mul_i32 s29, s42, 9344
    s_add_u32 m0, s28, 102912
    s_add_u32 s29, s29, 5615616
    s_mov_b64 exec, s[46:47]
    buffer_load_dwordx4 v9, s[4:7], s29 offen sc1 lds
    s_mul_i32 s28, s42, 288
    s_mul_i32 s29, s42, 9216
    s_add_u32 m0, s28, 31104
    s_add_u32 s29, s29, 3354624
    s_mov_b64 exec, s[44:45]
    buffer_load_dwordx4 v8, s[4:7], s29 offen sc1 lds
    s_mul_i32 s28, s42, 304
    s_mul_i32 s29, s42, 9344
    s_add_u32 m0, s28, 106560
    s_add_u32 s29, s29, 5727744
    s_mov_b64 exec, s[46:47]
    buffer_load_dwordx4 v9, s[4:7], s29 offen sc1 lds
    s_mul_i32 s28, s42, 288
    s_mul_i32 s29, s42, 9216
    s_add_u32 m0, s28, 34560
    s_add_u32 s29, s29, 3465216
    s_mov_b64 exec, s[44:45]
    buffer_load_dwordx4 v8, s[4:7], s29 offen sc1 lds
    s_mul_i32 s28, s42, 304
    s_mul_i32 s29, s42, 9344
    s_add_u32 m0, s28, 110208
    s_add_u32 s29, s29, 5839872
    s_mov_b64 exec, s[46:47]
    buffer_load_dwordx4 v9, s[4:7], s29 offen sc1 lds
    s_mul_i32 s28, s42, 288
    s_mul_i32 s29, s42, 9216
    s_add_u32 m0, s28, 38016
    s_add_u32 s29, s29, 3575808
    s_mov_b64 exec, s[44:45]
    buffer_load_dwordx4 v8, s[4:7], s29 offen sc1 lds
    s_mul_i32 s28, s42, 304
    s_mul_i32 s29, s42, 9344
    s_add_u32 m0, s28, 113856
    s_add_u32 s29, s29, 5952000
    s_mov_b64 exec, s[46:47]
    buffer_load_dwordx4 v9, s[4:7], s29 offen sc1 lds
    s_mul_i32 s28, s42, 288
    s_mul_i32 s29, s42, 9216
    s_add_u32 m0, s28, 41472
    s_add_u32 s29, s29, 3686400
    s_mov_b64 exec, s[44:45]
    buffer_load_dwordx4 v8, s[4:7], s29 offen sc1 lds
    s_mul_i32 s28, s42, 304
    s_mul_i32 s29, s42, 9344
    s_add_u32 m0, s28, 117504
    s_add_u32 s29, s29, 6064128
    s_mov_b64 exec, s[46:47]
    buffer_load_dwordx4 v9, s[4:7], s29 offen sc1 lds
    s_mul_i32 s28, s42, 288
    s_mul_i32 s29, s42, 9216
    s_add_u32 m0, s28, 44928
    s_add_u32 s29, s29, 3796992
    s_mov_b64 exec, s[44:45]
    buffer_load_dwordx4 v8, s[4:7], s29 offen sc1 lds
    s_mul_i32 s28, s42, 304
    s_mul_i32 s29, s42, 9344
    s_add_u32 m0, s28, 121152
    s_add_u32 s29, s29, 6176256
    s_mov_b64 exec, s[46:47]
    buffer_load_dwordx4 v9, s[4:7], s29 offen sc1 lds
    s_mul_i32 s28, s42, 288
    s_mul_i32 s29, s42, 9216
    s_add_u32 m0, s28, 48384
    s_add_u32 s29, s29, 3907584
    s_mov_b64 exec, s[44:45]
    buffer_load_dwordx4 v8, s[4:7], s29 offen sc1 lds
    s_mul_i32 s28, s42, 304
    s_mul_i32 s29, s42, 9344
    s_add_u32 m0, s28, 124800
    s_add_u32 s29, s29, 6288384
    s_mov_b64 exec, s[46:47]
    buffer_load_dwordx4 v9, s[4:7], s29 offen sc1 lds
    s_mul_i32 s28, s42, 288
    s_mul_i32 s29, s42, 9216
    s_add_u32 m0, s28, 51840
    s_add_u32 s29, s29, 4018176
    s_mov_b64 exec, s[44:45]
    buffer_load_dwordx4 v8, s[4:7], s29 offen sc1 lds
    s_mul_i32 s28, s42, 304
    s_mul_i32 s29, s42, 9344
    s_add_u32 m0, s28, 128448
    s_add_u32 s29, s29, 6400512
    s_mov_b64 exec, s[46:47]
    buffer_load_dwordx4 v9, s[4:7], s29 offen sc1 lds
    s_waitcnt vmcnt(16)
    s_mul_i32 s28, s42, 288
    s_mul_i32 s29, s42, 9216
    s_add_u32 m0, s28, 55296
    s_add_u32 s29, s29, 4128768
    s_mov_b64 exec, s[44:45]
    buffer_load_dwordx4 v8, s[4:7], s29 offen sc1 lds
    s_mul_i32 s28, s42, 304
    s_mul_i32 s29, s42, 9344
    s_add_u32 m0, s28, 132096
    s_add_u32 s29, s29, 6512640
    s_mov_b64 exec, s[46:47]
    buffer_load_dwordx4 v9, s[4:7], s29 offen sc1 lds
    s_mul_i32 s28, s42, 288
    s_mul_i32 s29, s42, 9216
    s_add_u32 m0, s28, 58752
    s_add_u32 s29, s29, 4239360
    s_mov_b64 exec, s[44:45]
    buffer_load_dwordx4 v8, s[4:7], s29 offen sc1 lds
    s_mul_i32 s28, s42, 304
    s_mul_i32 s29, s42, 9344
    s_add_u32 m0, s28, 135744
    s_add_u32 s29, s29, 6624768
    s_mov_b64 exec, s[46:47]
    buffer_load_dwordx4 v9, s[4:7], s29 offen sc1 lds
    s_mul_i32 s28, s42, 288
    s_mul_i32 s29, s42, 9216
    s_add_u32 m0, s28, 62208
    s_add_u32 s29, s29, 4349952
    s_mov_b64 exec, s[44:45]
    buffer_load_dwordx4 v8, s[4:7], s29 offen sc1 lds
    s_mul_i32 s28, s42, 304
    s_mul_i32 s29, s42, 9344
    s_add_u32 m0, s28, 139392
    s_add_u32 s29, s29, 6736896
    s_mov_b64 exec, s[46:47]
    buffer_load_dwordx4 v9, s[4:7], s29 offen sc1 lds
    s_mul_i32 s28, s42, 288
    s_mul_i32 s29, s42, 9216
    s_add_u32 m0, s28, 65664
    s_add_u32 s29, s29, 4460544
    s_mov_b64 exec, s[44:45]
    buffer_load_dwordx4 v8, s[4:7], s29 offen sc1 lds
    s_mul_i32 s28, s42, 304
    s_mul_i32 s29, s42, 9344
    s_add_u32 m0, s28, 143040
    s_add_u32 s29, s29, 6849024
    s_mov_b64 exec, s[46:47]
    buffer_load_dwordx4 v9, s[4:7], s29 offen sc1 lds
    s_mul_i32 s28, s42, 288
    s_mul_i32 s29, s42, 9216
    s_add_u32 m0, s28, 69120
    s_add_u32 s29, s29, 4571136
    s_mov_b64 exec, s[44:45]
    buffer_load_dwordx4 v8, s[4:7], s29 offen sc1 lds
    s_mul_i32 s28, s42, 304
    s_mul_i32 s29, s42, 9344
    s_add_u32 m0, s28, 146688
    s_add_u32 s29, s29, 6961152
    s_mov_b64 exec, s[46:47]
    buffer_load_dwordx4 v9, s[4:7], s29 offen sc1 lds
    s_min_u32 s42, s42, 1
    s_mul_i32 s28, s42, 288
    s_mul_i32 s29, s42, 9216
    s_add_u32 m0, s28, 72576
    s_add_u32 s29, s29, 4681728
    s_mov_b64 exec, s[44:45]
    buffer_load_dwordx4 v8, s[4:7], s29 offen sc1 lds
    s_mul_i32 s28, s42, 304
    s_mul_i32 s29, s42, 9344
    s_add_u32 m0, s28, 150336
    s_add_u32 s29, s29, 7073280
    s_mov_b64 exec, s[46:47]
    buffer_load_dwordx4 v9, s[4:7], s29 offen sc1 lds
    s_mov_b64 exec, -1
    s_add_u32 s32, s32, 1
    s_cmp_lt_u32 s32, 4
    s_cbranch_scc1 p3_re_t
    s_waitcnt vmcnt(0)
    s_mov_b64 exec, 1
    v_mov_b32 v3, 160804
    v_mov_b32 v4, 1
    ds_add_u32 v3, v4
    s_mov_b64 exec, -1
    v_mov_b32 v3, 160808
    s_mov_b32 s63, 2097152
lw_xt:
    ds_read_b32 v4, v3
    s_waitcnt lgkmcnt(0)
    v_readfirstlane_b32 s28, v4
    s_nop 0
    s_cmp_ge_u32 s28, s31
    s_cbranch_scc1 lw_xt_ok
    s_sleep 8
    s_sub_u32 s63, s63, 1
    s_cbranch_scc0 lw_xt
lw_xt_ok:
p3_ok_t:
    s_mov_b64 exec, 1
    v_mov_b32 v3, 160832
    v_mov_b32 v4, 1
    ds_add_u32 v3, v4
    s_mov_b64 exec, -1
    v_add_u32 v7, 61440, v2
    ds_write_b128 v7, v[16:19] offset:0
    ds_write_b128 v7, v[20:23] offset:1024
    ds_write_b128 v7, v[24:27] offset:2048
    ds_write_b128 v7, v[28:31] offset:3072
    ds_write_b128 v7, v[32:35] offset:4096
    ds_write_b128 v7, v[36:39] offset:5120
    ds_write_b128 v7, v[40:43] offset:6144
    ds_write_b128 v7, v[44:47] offset:7168
    ds_write_b128 v7, v[48:51] offset:8192
    ds_write_b128 v7, v[52:55] offset:9216
    ds_write_b128 v7, v[56:59] offset:10240
    ds_write_b128 v7, v[60:63] offset:11264
    v_mov_b32 v6, 11
    ds_write_b32 v5, v6
    v_add_u32 v7, 136192, v2
    ds_write_b128 v7, v[64:67] offset:0
    ds_write_b128 v7, v[68:71] offset:1024
    ds_write_b128 v7, v[72:75] offset:2048
    ds_write_b128 v7, v[76:79] offset:3072
    ds_write_b128 v7, v[80:83] offset:4096
    ds_write_b128 v7, v[84:87] offset:5120
    ds_write_b128 v7, v[88:91] offset:6144
    ds_write_b128 v7, v[92:95] offset:7168
    ds_write_b128 v7, v[96:99] offset:8192
    ds_write_b128 v7, v[100:103] offset:9216
    ds_write_b128 v7, v[104:107] offset:10240
    ds_write_b128 v7, v[108:111] offset:11264
    v_mov_b32 v6, 12
    ds_write_b32 v5, v6
    s_waitcnt lgkmcnt(0)
    s_endpgm
p3_cp:
    s_load_dwordx2 s[20:21], s[0:1], 88
    s_mov_b32 s22, 1152
    s_mov_b32 s23, 0x20000
    s_mul_i32 s33, s17, 3
    s_add_u32 s33, s33, s36
    s_mul_i32 s34, s33, 73728
    s_add_u32 s34, s34, 14852096
    v_add_u32 v3, 0, v2
    v_and_b32 v6, 31, v1
    v_lshrrev_b32 v7, 5, v1
    v_mul_u32_u24 v5, 1152, v6
    v_lshl_add_u32 v5, v7, 5, v5
    s_lshl_b32 s28, s33, 6
    s_mul_i32 s29, s16, 73728
    s_add_u32 s29, s29, s28
    s_add_u32 s30, s29, 36864
    v_mul_u32_u24 v4, 9216, v7
    v_lshl_add_u32 v4, v6, 2, v4
    v_lshlrev_b32 v6, 1, v6
    s_waitcnt lgkmcnt(0)
    buffer_load_ushort v0, v6, s[20:23], s28 offen
    buffer_load_dwordx4 v[40:43], v5, s[8:11], s29 offen offset:0
    buffer_load_dwordx4 v[44:47], v5, s[8:11], s29 offen offset:16
    buffer_load_dwordx4 v[48:51], v5, s[8:11], s30 offen offset:0
    buffer_load_dwordx4 v[52:55], v5, s[8:11], s30 offen offset:16
    buffer_load_dwordx4 v[96:99], v2, s[4:7], s34 offen offset:0 sc1
    buffer_load_dwordx4 v[100:103], v2, s[4:7], s34 offen offset:1024 sc1
    buffer_load_dwordx4 v[104:107], v2, s[4:7], s34 offen offset:2048 sc1
    buffer_load_dwordx4 v[108:111], v2, s[4:7], s34 offen offset:3072 sc1
    s_add_u32 s34, s34, 4096
    buffer_load_dwordx4 v[112:115], v2, s[4:7], s34 offen offset:0 sc1
    buffer_load_dwordx4 v[116:119], v2, s[4:7], s34 offen offset:1024 sc1
    buffer_load_dwordx4 v[120:123], v2, s[4:7], s34 offen offset:2048 sc1
    buffer_load_dwordx4 v[124:127], v2, s[4:7], s34 offen offset:3072 sc1
    s_add_u32 s34, s34, 4096
    buffer_load_dwordx4 v[128:131], v2, s[4:7], s34 offen offset:0 sc1
    buffer_load_dwordx4 v[132:135], v2, s[4:7], s34 offen offset:1024 sc1
    buffer_load_dwordx4 v[136:139], v2, s[4:7], s34 offen offset:2048 sc1
    buffer_load_dwordx4 v[140:143], v2, s[4:7], s34 offen offset:3072 sc1
    s_add_u32 s34, s34, 4096
    buffer_load_dwordx4 v[144:147], v2, s[4:7], s34 offen offset:0 sc1
    buffer_load_dwordx4 v[148:151], v2, s[4:7], s34 offen offset:1024 sc1
    buffer_load_dwordx4 v[152:155], v2, s[4:7], s34 offen offset:2048 sc1
    buffer_load_dwordx4 v[156:159], v2, s[4:7], s34 offen offset:3072 sc1
    s_add_u32 s34, s34, 4096
    s_mul_i32 s28, s16, 147456
    s_lshl_b32 s29, s33, 7
    s_add_u32 s28, s28, s29
    v_add_u32 v4, s28, v4
    s_lshl_b32 s31, s16, 8
    s_add_u32 s31, s31, 17457152
    s_waitcnt vmcnt(16)
    v_lshl_or_b32 v0, v0, 16, v0
    v_pk_mul_lo_u16 v56, v64, v0
    v_pk_mul_lo_u16 v57, v65, v0
    v_pk_mul_lo_u16 v58, v66, v0
    v_pk_mul_lo_u16 v59, v67, v0
    v_pk_mul_lo_u16 v60, v68, v0
    v_pk_mul_lo_u16 v61, v69, v0
    v_pk_mul_lo_u16 v62, v70, v0
    v_pk_mul_lo_u16 v63, v71, v0
    v_lshlrev_b32 v7, 4, v7
    v_mfma_f32_32x32x16_bf16 v[8:23], v[40:43], v[56:59], 0
    v_mfma_f32_32x32x16_bf16 v[24:39], v[48:51], v[56:59], 0
    v_mfma_f32_32x32x16_bf16 v[8:23], v[44:47], v[60:63], v[8:23]
    v_mfma_f32_32x32x16_bf16 v[24:39], v[52:55], v[60:63], v[24:39]
    v_mov_b32 v160, 160812
    s_lshl_b32 s28, s36, 2
    s_add_u32 s28, s28, 160816
    v_mov_b32 v164, s28
    s_setprio 0
    v_mov_b32 v162, 160812
    s_mov_b32 s63, 2097152
lw_l0:
    ds_read_b32 v163, v162
    s_waitcnt lgkmcnt(0)
    v_readfirstlane_b32 s28, v163
    s_nop 0
    s_cmp_ge_u32 s28, 8
    s_cbranch_scc1 lw_l0_ok
    s_sleep 8
    s_sub_u32 s63, s63, 1
    s_cbranch_scc0 lw_l0
lw_l0_ok:
    v_mov_b32 v162, 160796
    s_mov_b32 s63, 2097152
lw_go:
    ds_read_b32 v163, v162
    s_waitcnt lgkmcnt(0)
    v_readfirstlane_b32 s28, v163
    s_nop 0
    s_cmp_ge_u32 s28, 4
    s_cbranch_scc1 lw_go_ok
    s_sleep 2
    s_sub_u32 s63, s63, 1
    s_cbranch_scc0 lw_go
lw_go_ok:
    ds_read_b128 v[72:75], v3 offset:0
    ds_read_b128 v[76:79], v3 offset:1024
    ds_read_b128 v[80:83], v3 offset:2048
    ds_read_b128 v[84:87], v3 offset:3072
    s_waitcnt vmcnt(15) lgkmcnt(2)
    v_mfma_f32_32x32x16_bf16 v[8:23], v[72:75], v[96:99], v[8:23]
    ds_read_b128 v[88:91], v3 offset:4096
    v_mfma_f32_32x32x16_bf16 v[24:39], v[76:79], v[96:99], v[24:39]
    ds_read_b128 v[92:95], v3 offset:5120
    s_waitcnt vmcnt(14) lgkmcnt(2)
    v_mfma_f32_32x32x16_bf16 v[8:23], v[80:83], v[100:103], v[8:23]
    buffer_load_dwordx4 v[96:99], v2, s[4:7], s34 offen offset:0 sc1
    ds_read_b128 v[72:75], v3 offset:6144
    v_mfma_f32_32x32x16_bf16 v[24:39], v[84:87], v[100:103], v[24:39]
    ds_read_b128 v[76:79], v3 offset:7168
    s_waitcnt vmcnt(14) lgkmcnt(2)
    v_mfma_f32_32x32x16_bf16 v[8:23], v[88:91], v[104:107], v[8:23]
    buffer_load_dwordx4 v[100:103], v2, s[4:7], s34 offen offset:1024 sc1
    ds_read_b128 v[80:83], v3 offset:8192
    v_mfma_f32_32x32x16_bf16 v[24:39], v[92:95], v[104:107], v[24:39]
    ds_read_b128 v[84:87], v3 offset:9216
    s_waitcnt vmcnt(14) lgkmcnt(2)
    v_mfma_f32_32x32x16_bf16 v[8:23], v[72:75], v[108:111], v[8:23]
    buffer_load_dwordx4 v[104:107], v2, s[4:7], s34 offen offset:2048 sc1
    ds_read_b128 v[88:91], v3 offset:10240
    v_mfma_f32_32x32x16_bf16 v[24:39], v[76:79], v[108:111], v[24:39]
    ds_read_b128 v[92:95], v3 offset:11264
    s_waitcnt vmcnt(14) lgkmcnt(2)
    v_mfma_f32_32x32x16_bf16 v[8:23], v[80:83], v[112:115], v[8:23]
    buffer_load_dwordx4 v[108:111], v2, s[4:7], s34 offen offset:3072 sc1
    s_add_u32 s34, s34, 4096
    ds_read_b128 v[72:75], v3 offset:12288
    v_mfma_f32_32x32x16_bf16 v[24:39], v[84:87], v[112:115], v[24:39]
    ds_read_b128 v[76:79], v3 offset:13312
    s_waitcnt vmcnt(14) lgkmcnt(2)
    v_mfma_f32_32x32x16_bf16 v[8:23], v[88:91], v[116:119], v[8:23]
    buffer_load_dwordx4 v[112:115], v2, s[4:7], s34 offen offset:0 sc1
    ds_read_b128 v[80:83], v3 offset:14336
    v_mfma_f32_32x32x16_bf16 v[24:39], v[92:95], v[116:119], v[24:39]
    ds_read_b128 v[84:87], v3 offset:15360
    s_waitcnt vmcnt(14) lgkmcnt(2)
    v_mfma_f32_32x32x16_bf16 v[8:23], v[72:75], v[120:123], v[8:23]
    buffer_load_dwordx4 v[116:119], v2, s[4:7], s34 offen offset:1024 sc1
    ds_read_b128 v[88:91], v3 offset:16384
    v_mfma_f32_32x32x16_bf16 v[24:39], v[76:79], v[120:123], v[24:39]
    ds_read_b128 v[92:95], v3 offset:17408
    v_mov_b32 v165, 1
    ds_write_b32 v164, v165
    s_waitcnt vmcnt(14) lgkmcnt(3)
    v_mfma_f32_32x32x16_bf16 v[8:23], v[80:83], v[124:127], v[8:23]
    buffer_load_dwordx4 v[120:123], v2, s[4:7], s34 offen offset:2048 sc1
    ds_read_b128 v[72:75], v3 offset:18432
    v_mfma_f32_32x32x16_bf16 v[24:39], v[84:87], v[124:127], v[24:39]
    ds_read_b128 v[76:79], v3 offset:19456
    s_waitcnt vmcnt(14) lgkmcnt(3)
    v_mfma_f32_32x32x16_bf16 v[8:23], v[88:91], v[128:131], v[8:23]
    buffer_load_dwordx4 v[124:127], v2, s[4:7], s34 offen offset:3072 sc1
    s_add_u32 s34, s34, 4096
    ds_read_b128 v[80:83], v3 offset:20480
    v_mfma_f32_32x32x16_bf16 v[24:39], v[92:95], v[128:131], v[24:39]
    ds_read_b128 v[84:87], v3 offset:21504
    s_waitcnt vmcnt(14) lgkmcnt(2)
    v_mfma_f32_32x32x16_bf16 v[8:23], v[72:75], v[132:135], v[8:23]
    buffer_load_dwordx4 v[128:131], v2, s[4:7], s34 offen offset:0 sc1
    ds_read_b128 v[88:91], v3 offset:22528
    v_mfma_f32_32x32x16_bf16 v[24:39], v[76:79], v[132:135], v[24:39]
    ds_read_b128 v[92:95], v3 offset:23552
    s_waitcnt vmcnt(14) lgkmcnt(2)
    v_mfma_f32_32x32x16_bf16 v[8:23], v[80:83], v[136:139], v[8:23]
    buffer_load_dwordx4 v[132:135], v2, s[4:7], s34 offen offset:1024 sc1
    ds_read_b128 v[72:75], v3 offset:24576
    v_mfma_f32_32x32x16_bf16 v[24:39], v[84:87], v[136:139], v[24:39]
    ds_read_b128 v[76:79], v3 offset:25600
    s_waitcnt vmcnt(14) lgkmcnt(2)
    v_mfma_f32_32x32x16_bf16 v[8:23], v[88:91], v[140:143], v[8:23]
    buffer_load_dwordx4 v[136:139], v2, s[4:7], s34 offen offset:2048 sc1
    ds_read_b128 v[80:83], v3 offset:26624
    v_mfma_f32_32x32x16_bf16 v[24:39], v[92:95], v[140:143], v[24:39]
    ds_read_b128 v[84:87], v3 offset:27648
    s_waitcnt vmcnt(14) lgkmcnt(2)
    v_mfma_f32_32x32x16_bf16 v[8:23], v[72:75], v[144:147], v[8:23]
    buffer_load_dwordx4 v[140:143], v2, s[4:7], s34 offen offset:3072 sc1
    s_add_u32 s34, s34, 4096
    ds_read_b128 v[88:91], v3 offset:28672
    v_mfma_f32_32x32x16_bf16 v[24:39], v[76:79], v[144:147], v[24:39]
    ds_read_b128 v[92:95], v3 offset:29696
    v_mov_b32 v165, 2
    ds_write_b32 v164, v165
    s_waitcnt vmcnt(14) lgkmcnt(3)
    v_mfma_f32_32x32x16_bf16 v[8:23], v[80:83], v[148:151], v[8:23]
    buffer_load_dwordx4 v[144:147], v2, s[4:7], s34 offen offset:0 sc1
    ds_read_b128 v[72:75], v3 offset:30720
    v_mfma_f32_32x32x16_bf16 v[24:39], v[84:87], v[148:151], v[24:39]
    ds_read_b128 v[76:79], v3 offset:31744
    s_waitcnt vmcnt(14) lgkmcnt(3)
    v_mfma_f32_32x32x16_bf16 v[8:23], v[88:91], v[152:155], v[8:23]
    buffer_load_dwordx4 v[148:151], v2, s[4:7], s34 offen offset:1024 sc1
    ds_read_b128 v[80:83], v3 offset:32768
    v_mfma_f32_32x32x16_bf16 v[24:39], v[92:95], v[152:155], v[24:39]
    ds_read_b128 v[84:87], v3 offset:33792
    s_waitcnt vmcnt(14) lgkmcnt(2)
    v_mfma_f32_32x32x16_bf16 v[8:23], v[72:75], v[156:159], v[8:23]
    buffer_load_dwordx4 v[152:155], v2, s[4:7], s34 offen offset:2048 sc1
    ds_read_b128 v[88:91], v3 offset:34816
    v_mfma_f32_32x32x16_bf16 v[24:39], v[76:79], v[156:159], v[24:39]
    ds_read_b128 v[92:95], v3 offset:35840
    s_waitcnt vmcnt(14) lgkmcnt(2)
    v_mfma_f32_32x32x16_bf16 v[8:23], v[80:83], v[96:99], v[8:23]
    buffer_load_dwordx4 v[156:159], v2, s[4:7], s34 offen offset:3072 sc1
    s_add_u32 s34, s34, 4096
    ds_read_b128 v[72:75], v3 offset:36864
    v_mfma_f32_32x32x16_bf16 v[24:39], v[84:87], v[96:99], v[24:39]
    ds_read_b128 v[76:79], v3 offset:37888
    s_waitcnt vmcnt(14) lgkmcnt(2)
    v_mfma_f32_32x32x16_bf16 v[8:23], v[88:91], v[100:103], v[8:23]
    buffer_load_dwordx4 v[96:99], v2, s[4:7], s34 offen offset:0 sc1
    ds_read_b128 v[80:83], v3 offset:38912
    v_mfma_f32_32x32x16_bf16 v[24:39], v[92:95], v[100:103], v[24:39]
    ds_read_b128 v[84:87], v3 offset:39936
    s_waitcnt vmcnt(14) lgkmcnt(2)
    v_mfma_f32_32x32x16_bf16 v[8:23], v[72:75], v[104:107], v[8:23]
    buffer_load_dwordx4 v[100:103], v2, s[4:7], s34 offen offset:1024 sc1
    ds_read_b128 v[88:91], v3 offset:40960
    v_mfma_f32_32x32x16_bf16 v[24:39], v[76:79], v[104:107], v[24:39]
    ds_read_b128 v[92:95], v3 offset:41984
    v_mov_b32 v165, 3
    ds_write_b32 v164, v165
    s_waitcnt vmcnt(14) lgkmcnt(3)
    v_mfma_f32_32x32x16_bf16 v[8:23], v[80:83], v[108:111], v[8:23]
    buffer_load_dwordx4 v[104:107], v2, s[4:7], s34 offen offset:2048 sc1
    ds_read_b128 v[72:75], v3 offset:43008
    v_mfma_f32_32x32x16_bf16 v[24:39], v[84:87], v[108:111], v[24:39]
    ds_read_b128 v[76:79], v3 offset:44032
    s_waitcnt vmcnt(14) lgkmcnt(3)
    v_mfma_f32_32x32x16_bf16 v[8:23], v[88:91], v[112:115], v[8:23]
    buffer_load_dwordx4 v[108:111], v2, s[4:7], s34 offen offset:3072 sc1
    s_add_u32 s34, s34, 4096
    ds_read_b128 v[80:83], v3 offset:45056
    v_mfma_f32_32x32x16_bf16 v[24:39], v[92:95], v[112:115], v[24:39]
    ds_read_b128 v[84:87], v3 offset:46080
    s_waitcnt vmcnt(14) lgkmcnt(2)
    v_mfma_f32_32x32x16_bf16 v[8:23], v[72:75], v[116:119], v[8:23]
    buffer_load_dwordx4 v[112:115], v2, s[4:7], s34 offen offset:0 sc1
    ds_read_b128 v[88:91], v3 offset:47104
    v_mfma_f32_32x32x16_bf16 v[24:39], v[76:79], v[116:119], v[24:39]
    ds_read_b128 v[92:95], v3 offset:48128
    s_waitcnt vmcnt(14) lgkmcnt(2)
    v_mfma_f32_32x32x16_bf16 v[8:23], v[80:83], v[120:123], v[8:23]
    buffer_load_dwordx4 v[116:119], v2, s[4:7], s34 offen offset:1024 sc1
    v_add_u32 v3, 74752, v3
    ds_read_b128 v[72:75], v3 offset:0
    v_mfma_f32_32x32x16_bf16 v[24:39], v[84:87], v[120:123], v[24:39]
    ds_read_b128 v[76:79], v3 offset:1024
    s_waitcnt vmcnt(14) lgkmcnt(2)
    v_mfma_f32_32x32x16_bf16 v[8:23], v[88:91], v[124:127], v[8:23]
    buffer_load_dwordx4 v[120:123], v2, s[4:7], s34 offen offset:2048 sc1
    ds_read_b128 v[80:83], v3 offset:2048
    v_mfma_f32_32x32x16_bf16 v[24:39], v[92:95], v[124:127], v[24:39]
    ds_read_b128 v[84:87], v3 offset:3072
    s_waitcnt vmcnt(14) lgkmcnt(2)
    v_mfma_f32_32x32x16_bf16 v[8:23], v[72:75], v[128:131], v[8:23]
    buffer_load_dwordx4 v[124:127], v2, s[4:7], s34 offen offset:3072 sc1
    s_add_u32 s34, s34, 4096
    ds_read_b128 v[88:91], v3 offset:4096
    v_mfma_f32_32x32x16_bf16 v[24:39], v[76:79], v[128:131], v[24:39]
    ds_read_b128 v[92:95], v3 offset:5120
    v_mov_b32 v165, 4
    ds_write_b32 v164, v165
    s_waitcnt vmcnt(14) lgkmcnt(3)
    v_mfma_f32_32x32x16_bf16 v[8:23], v[80:83], v[132:135], v[8:23]
    buffer_load_dwordx4 v[128:131], v2, s[4:7], s34 offen offset:0 sc1
    ds_read_b128 v[72:75], v3 offset:6144
    v_mfma_f32_32x32x16_bf16 v[24:39], v[84:87], v[132:135], v[24:39]
    ds_read_b128 v[76:79], v3 offset:7168
    s_waitcnt vmcnt(14) lgkmcnt(3)
    v_mfma_f32_32x32x16_bf16 v[8:23], v[88:91], v[136:139], v[8:23]
    buffer_load_dwordx4 v[132:135], v2, s[4:7], s34 offen offset:1024 sc1
    ds_read_b128 v[80:83], v3 offset:8192
    v_mfma_f32_32x32x16_bf16 v[24:39], v[92:95], v[136:139], v[24:39]
    ds_read_b128 v[84:87], v3 offset:9216
    s_waitcnt vmcnt(14) lgkmcnt(2)
    v_mfma_f32_32x32x16_bf16 v[8:23], v[72:75], v[140:143], v[8:23]
    buffer_load_dwordx4 v[136:139], v2, s[4:7], s34 offen offset:2048 sc1
    ds_read_b128 v[88:91], v3 offset:10240
    v_mfma_f32_32x32x16_bf16 v[24:39], v[76:79], v[140:143], v[24:39]
    ds_read_b128 v[92:95], v3 offset:11264
    s_waitcnt vmcnt(14) lgkmcnt(2)
    v_mfma_f32_32x32x16_bf16 v[8:23], v[80:83], v[144:147], v[8:23]
    buffer_load_dwordx4 v[140:143], v2, s[4:7], s34 offen offset:3072 sc1
    s_add_u32 s34, s34, 4096
    ds_read_b128 v[72:75], v3 offset:12288
    v_mfma_f32_32x32x16_bf16 v[24:39], v[84:87], v[144:147], v[24:39]
    ds_read_b128 v[76:79], v3 offset:13312
    s_waitcnt vmcnt(14) lgkmcnt(2)
    v_mfma_f32_32x32x16_bf16 v[8:23], v[88:91], v[148:151], v[8:23]
    buffer_load_dwordx4 v[144:147], v2, s[4:7], s34 offen offset:0 sc1
    ds_read_b128 v[80:83], v3 offset:14336
    v_mfma_f32_32x32x16_bf16 v[24:39], v[92:95], v[148:151], v[24:39]
    ds_read_b128 v[84:87], v3 offset:15360
    s_waitcnt vmcnt(14) lgkmcnt(2)
    v_mfma_f32_32x32x16_bf16 v[8:23], v[72:75], v[152:155], v[8:23]
    buffer_load_dwordx4 v[148:151], v2, s[4:7], s34 offen offset:1024 sc1
    ds_read_b128 v[88:91], v3 offset:16384
    v_mfma_f32_32x32x16_bf16 v[24:39], v[76:79], v[152:155], v[24:39]
    ds_read_b128 v[92:95], v3 offset:17408
    v_mov_b32 v165, 5
    ds_write_b32 v164, v165
    s_waitcnt vmcnt(14) lgkmcnt(3)
    v_mfma_f32_32x32x16_bf16 v[8:23], v[80:83], v[156:159], v[8:23]
    buffer_load_dwordx4 v[152:155], v2, s[4:7], s34 offen offset:2048 sc1
    ds_read_b128 v[72:75], v3 offset:18432
    v_mfma_f32_32x32x16_bf16 v[24:39], v[84:87], v[156:159], v[24:39]
    ds_read_b128 v[76:79], v3 offset:19456
    s_waitcnt vmcnt(14) lgkmcnt(3)
    v_mfma_f32_32x32x16_bf16 v[8:23], v[88:91], v[96:99], v[8:23]
    buffer_load_dwordx4 v[156:159], v2, s[4:7], s34 offen offset:3072 sc1
    s_add_u32 s34, s34, 4096
    ds_read_b128 v[80:83], v3 offset:20480
    v_mfma_f32_32x32x16_bf16 v[24:39], v[92:95], v[96:99], v[24:39]
    ds_read_b128 v[84:87], v3 offset:21504
    s_waitcnt vmcnt(14) lgkmcnt(2)
    v_mfma_f32_32x32x16_bf16 v[8:23], v[72:75], v[100:103], v[8:23]
    buffer_load_dwordx4 v[96:99], v2, s[4:7], s34 offen offset:0 sc1
    ds_read_b128 v[88:91], v3 offset:22528
    v_mfma_f32_32x32x16_bf16 v[24:39], v[76:79], v[100:103], v[24:39]
    ds_read_b128 v[92:95], v3 offset:23552
    s_waitcnt vmcnt(14) lgkmcnt(2)
    v_mfma_f32_32x32x16_bf16 v[8:23], v[80:83], v[104:107], v[8:23]
    buffer_load_dwordx4 v[100:103], v2, s[4:7], s34 offen offset:1024 sc1
    ds_read_b128 v[72:75], v3 offset:24576
    v_mfma_f32_32x32x16_bf16 v[24:39], v[84:87], v[104:107], v[24:39]
    ds_read_b128 v[76:79], v3 offset:25600
    s_waitcnt vmcnt(14) lgkmcnt(2)
    v_mfma_f32_32x32x16_bf16 v[8:23], v[88:91], v[108:111], v[8:23]
    buffer_load_dwordx4 v[104:107], v2, s[4:7], s34 offen offset:2048 sc1
    ds_read_b128 v[80:83], v3 offset:26624
    v_mfma_f32_32x32x16_bf16 v[24:39], v[92:95], v[108:111], v[24:39]
    ds_read_b128 v[84:87], v3 offset:27648
    s_waitcnt vmcnt(14) lgkmcnt(2)
    v_mfma_f32_32x32x16_bf16 v[8:23], v[72:75], v[112:115], v[8:23]
    buffer_load_dwordx4 v[108:111], v2, s[4:7], s34 offen offset:3072 sc1
    s_add_u32 s34, s34, 4096
    ds_read_b128 v[88:91], v3 offset:28672
    v_mfma_f32_32x32x16_bf16 v[24:39], v[76:79], v[112:115], v[24:39]
    ds_read_b128 v[92:95], v3 offset:29696
    v_mov_b32 v165, 6
    ds_write_b32 v164, v165
    s_waitcnt vmcnt(14) lgkmcnt(3)
    v_mfma_f32_32x32x16_bf16 v[8:23], v[80:83], v[116:119], v[8:23]
    buffer_load_dwordx4 v[112:115], v2, s[4:7], s34 offen offset:0 sc1
    ds_read_b128 v[72:75], v3 offset:30720
    v_mfma_f32_32x32x16_bf16 v[24:39], v[84:87], v[116:119], v[24:39]
    ds_read_b128 v[76:79], v3 offset:31744
    s_waitcnt vmcnt(14) lgkmcnt(3)
    v_mfma_f32_32x32x16_bf16 v[8:23], v[88:91], v[120:123], v[8:23]
    buffer_load_dwordx4 v[116:119], v2, s[4:7], s34 offen offset:1024 sc1
    ds_read_b128 v[80:83], v3 offset:32768
    v_mfma_f32_32x32x16_bf16 v[24:39], v[92:95], v[120:123], v[24:39]
    ds_read_b128 v[84:87], v3 offset:33792
    s_waitcnt vmcnt(14) lgkmcnt(2)
    v_mfma_f32_32x32x16_bf16 v[8:23], v[72:75], v[124:127], v[8:23]
    buffer_load_dwordx4 v[120:123], v2, s[4:7], s34 offen offset:2048 sc1
    ds_read_b128 v[88:91], v3 offset:34816
    v_mfma_f32_32x32x16_bf16 v[24:39], v[76:79], v[124:127], v[24:39]
    ds_read_b128 v[92:95], v3 offset:35840
    s_waitcnt vmcnt(14) lgkmcnt(2)
    v_mfma_f32_32x32x16_bf16 v[8:23], v[80:83], v[128:131], v[8:23]
    buffer_load_dwordx4 v[124:127], v2, s[4:7], s34 offen offset:3072 sc1
    s_add_u32 s34, s34, 4096
    ds_read_b128 v[72:75], v3 offset:36864
    v_mfma_f32_32x32x16_bf16 v[24:39], v[84:87], v[128:131], v[24:39]
    ds_read_b128 v[76:79], v3 offset:37888
    s_waitcnt vmcnt(14) lgkmcnt(2)
    v_mfma_f32_32x32x16_bf16 v[8:23], v[88:91], v[132:135], v[8:23]
    buffer_load_dwordx4 v[128:131], v2, s[4:7], s34 offen offset:0 sc1
    ds_read_b128 v[80:83], v3 offset:38912
    v_mfma_f32_32x32x16_bf16 v[24:39], v[92:95], v[132:135], v[24:39]
    ds_read_b128 v[84:87], v3 offset:39936
    s_waitcnt vmcnt(14) lgkmcnt(2)
    v_mfma_f32_32x32x16_bf16 v[8:23], v[72:75], v[136:139], v[8:23]
    buffer_load_dwordx4 v[132:135], v2, s[4:7], s34 offen offset:1024 sc1
    ds_read_b128 v[88:91], v3 offset:40960
    v_mfma_f32_32x32x16_bf16 v[24:39], v[76:79], v[136:139], v[24:39]
    ds_read_b128 v[92:95], v3 offset:41984
    v_mov_b32 v165, 7
    ds_write_b32 v164, v165
    s_waitcnt vmcnt(14) lgkmcnt(3)
    v_mfma_f32_32x32x16_bf16 v[8:23], v[80:83], v[140:143], v[8:23]
    buffer_load_dwordx4 v[136:139], v2, s[4:7], s34 offen offset:2048 sc1
    ds_read_b128 v[72:75], v3 offset:43008
    v_mfma_f32_32x32x16_bf16 v[24:39], v[84:87], v[140:143], v[24:39]
    ds_read_b128 v[76:79], v3 offset:44032
    ds_read_b32 v161, v160 offset:0
    s_waitcnt vmcnt(14) lgkmcnt(4)
    v_mfma_f32_32x32x16_bf16 v[8:23], v[88:91], v[144:147], v[8:23]
    buffer_load_dwordx4 v[140:143], v2, s[4:7], s34 offen offset:3072 sc1
    s_add_u32 s34, s34, 4096
    ds_read_b128 v[80:83], v3 offset:45056
    v_mfma_f32_32x32x16_bf16 v[24:39], v[92:95], v[144:147], v[24:39]
    ds_read_b128 v[84:87], v3 offset:46080
    s_waitcnt vmcnt(14) lgkmcnt(3)
    v_mfma_f32_32x32x16_bf16 v[8:23], v[72:75], v[148:151], v[8:23]
    buffer_load_dwordx4 v[144:147], v2, s[4:7], s34 offen offset:0 sc1
    ds_read_b128 v[88:91], v3 offset:47104
    v_mfma_f32_32x32x16_bf16 v[24:39], v[76:79], v[148:151], v[24:39]
    ds_read_b128 v[92:95], v3 offset:48128
    s_waitcnt vmcnt(14) lgkmcnt(2)
    v_mfma_f32_32x32x16_bf16 v[8:23], v[80:83], v[152:155], v[8:23]
    buffer_load_dwordx4 v[148:151], v2, s[4:7], s34 offen offset:1024 sc1
    v_readfirstlane_b32 s28, v161
    s_nop 0
    s_cmp_gt_u32 s28, 8
    s_cbranch_scc1 p3_have8
    v_mov_b32 v162, 160812
    s_mov_b32 s63, 2097152
lw_l8:
    ds_read_b32 v163, v162
    s_waitcnt lgkmcnt(0)
    v_readfirstlane_b32 s28, v163
    s_nop 0
    s_cmp_ge_u32 s28, 9
    s_cbranch_scc1 lw_l8_ok
    s_sleep 1
    s_sub_u32 s63, s63, 1
    s_cbranch_scc0 lw_l8
lw_l8_ok:
p3_have8:
    v_add_u32 v3, 4294941696, v3
    ds_read_b128 v[72:75], v3 offset:0
    v_mfma_f32_32x32x16_bf16 v[24:39], v[84:87], v[152:155], v[24:39]
    ds_read_b128 v[76:79], v3 offset:1024
    s_waitcnt vmcnt(14) lgkmcnt(2)
    v_mfma_f32_32x32x16_bf16 v[8:23], v[88:91], v[156:159], v[8:23]
    buffer_load_dwordx4 v[152:155], v2, s[4:7], s34 offen offset:2048 sc1
    ds_read_b128 v[80:83], v3 offset:2048
    v_mfma_f32_32x32x16_bf16 v[24:39], v[92:95], v[156:159], v[24:39]
    ds_read_b128 v[84:87], v3 offset:3072
    s_waitcnt vmcnt(14) lgkmcnt(2)
    v_mfma_f32_32x32x16_bf16 v[8:23], v[72:75], v[96:99], v[8:23]
    buffer_load_dwordx4 v[156:159], v2, s[4:7], s34 offen offset:3072 sc1
    s_add_u32 s34, s34, 4096
    ds_read_b128 v[88:91], v3 offset:4096
    v_mfma_f32_32x32x16_bf16 v[24:39], v[76:79], v[96:99], v[24:39]
    ds_read_b128 v[92:95], v3 offset:5120
    v_mov_b32 v165, 8
    ds_write_b32 v164, v165
    s_waitcnt vmcnt(14) lgkmcnt(3)
    v_mfma_f32_32x32x16_bf16 v[8:23], v[80:83], v[100:103], v[8:23]
    buffer_load_dwordx4 v[96:99], v2, s[4:7], s34 offen offset:0 sc1
    ds_read_b128 v[72:75], v3 offset:6144
    v_mfma_f32_32x32x16_bf16 v[24:39], v[84:87], v[100:103], v[24:39]
    ds_read_b128 v[76:79], v3 offset:7168
    ds_read_b32 v161, v160 offset:0
    s_waitcnt vmcnt(14) lgkmcnt(4)
    v_mfma_f32_32x32x16_bf16 v[8:23], v[88:91], v[104:107], v[8:23]
    buffer_load_dwordx4 v[100:103], v2, s[4:7], s34 offen offset:1024 sc1
    ds_read_b128 v[80:83], v3 offset:8192
    v_mfma_f32_32x32x16_bf16 v[24:39], v[92:95], v[104:107], v[24:39]
    ds_read_b128 v[84:87], v3 offset:9216
    s_waitcnt vmcnt(14) lgkmcnt(3)
    v_mfma_f32_32x32x16_bf16 v[8:23], v[72:75], v[108:111], v[8:23]
    buffer_load_dwordx4 v[104:107], v2, s[4:7], s34 offen offset:2048 sc1
    ds_read_b128 v[88:91], v3 offset:10240
    v_mfma_f32_32x32x16_bf16 v[24:39], v[76:79], v[108:111], v[24:39]
    ds_read_b128 v[92:95], v3 offset:11264
    s_waitcnt vmcnt(14) lgkmcnt(2)
    v_mfma_f32_32x32x16_bf16 v[8:23], v[80:83], v[112:115], v[8:23]
    buffer_load_dwordx4 v[108:111], v2, s[4:7], s34 offen offset:3072 sc1
    s_add_u32 s34, s34, 4096
    v_readfirstlane_b32 s28, v161
    s_nop 0
    s_cmp_gt_u32 s28, 9
    s_cbranch_scc1 p3_have9
    v_mov_b32 v162, 160812
    s_mov_b32 s63, 2097152
lw_l9:
    ds_read_b32 v163, v162
    s_waitcnt lgkmcnt(0)
    v_readfirstlane_b32 s28, v163
    s_nop 0
    s_cmp_ge_u32 s28, 10
    s_cbranch_scc1 lw_l9_ok
    s_sleep 1
    s_sub_u32 s63, s63, 1
    s_cbranch_scc0 lw_l9
lw_l9_ok:
p3_have9:
    v_add_u32 v3, 74752, v3
    ds_read_b128 v[72:75], v3 offset:0
    v_mfma_f32_32x32x16_bf16 v[24:39], v[84:87], v[112:115], v[24:39]
    ds_read_b128 v[76:79], v3 offset:1024
    s_waitcnt vmcnt(14) lgkmcnt(2)
    v_mfma_f32_32x32x16_bf16 v[8:23], v[88:91], v[116:119], v[8:23]
    buffer_load_dwordx4 v[112:115], v2, s[4:7], s34 offen offset:0 sc1
    ds_read_b128 v[80:83], v3 offset:2048
    v_mfma_f32_32x32x16_bf16 v[24:39], v[92:95], v[116:119], v[24:39]
    ds_read_b128 v[84:87], v3 offset:3072
    s_waitcnt vmcnt(14) lgkmcnt(2)
    v_mfma_f32_32x32x16_bf16 v[8:23], v[72:75], v[120:123], v[8:23]
    buffer_load_dwordx4 v[116:119], v2, s[4:7], s34 offen offset:1024 sc1
    ds_read_b128 v[88:91], v3 offset:4096
    v_mfma_f32_32x32x16_bf16 v[24:39], v[76:79], v[120:123], v[24:39]
    ds_read_b128 v[92:95], v3 offset:5120
    v_mov_b32 v165, 9
    ds_write_b32 v164, v165
    s_waitcnt vmcnt(14) lgkmcnt(3)
    v_mfma_f32_32x32x16_bf16 v[8:23], v[80:83], v[124:127], v[8:23]
    buffer_load_dwordx4 v[120:123], v2, s[4:7], s34 offen offset:2048 sc1
    ds_read_b128 v[72:75], v3 offset:6144
    v_mfma_f32_32x32x16_bf16 v[24:39], v[84:87], v[124:127], v[24:39]
    ds_read_b128 v[76:79], v3 offset:7168
    ds_read_b32 v161, v160 offset:0
    s_waitcnt vmcnt(14) lgkmcnt(4)
    v_mfma_f32_32x32x16_bf16 v[8:23], v[88:91], v[128:131], v[8:23]
    buffer_load_dwordx4 v[124:127], v2, s[4:7], s34 offen offset:3072 sc1
    s_add_u32 s34, s34, 4096
    ds_read_b128 v[80:83], v3 offset:8192
    v_mfma_f32_32x32x16_bf16 v[24:39], v[92:95], v[128:131], v[24:39]
    ds_read_b128 v[84:87], v3 offset:9216
    s_waitcnt vmcnt(14) lgkmcnt(3)
    v_mfma_f32_32x32x16_bf16 v[8:23], v[72:75], v[132:135], v[8:23]
    s_mul_i32 s34, s33, 36864
    s_add_u32 s34, s34, 14188544
    buffer_load_dwordx4 v[128:131], v2, s[4:7], s34 offen offset:0 sc1
    ds_read_b128 v[88:91], v3 offset:10240
    v_mfma_f32_32x32x16_bf16 v[24:39], v[76:79], v[132:135], v[24:39]
    ds_read_b128 v[92:95], v3 offset:11264
    s_waitcnt vmcnt(14) lgkmcnt(2)
    v_mfma_f32_32x32x16_bf16 v[8:23], v[80:83], v[136:139], v[8:23]
    buffer_load_dwordx4 v[132:135], v2, s[4:7], s34 offen offset:1024 sc1
    s_waitcnt lgkmcnt(0)
    v_mov_b32 v165, 10
    ds_write_b32 v164, v165
    v_readfirstlane_b32 s28, v161
    s_nop 0
    s_cmp_gt_u32 s28, 10
    s_cbranch_scc1 p3_have10
    v_mov_b32 v162, 160812
    s_mov_b32 s63, 2097152
lw_l10:
    ds_read_b32 v163, v162
    s_waitcnt lgkmcnt(0)
    v_readfirstlane_b32 s28, v163
    s_nop 0
    s_cmp_ge_u32 s28, 11
    s_cbranch_scc1 lw_l10_ok
    s_sleep 1
    s_sub_u32 s63, s63, 1
    s_cbranch_scc0 lw_l10
lw_l10_ok:
p3_have10:
    v_add_u32 v3, 4294904832, v3
    ds_read_b128 v[72:75], v3 offset:0
    v_mfma_f32_32x32x16_bf16 v[24:39], v[84:87], v[136:139], v[24:39]
    ds_read_b128 v[76:79], v3 offset:1024
    s_waitcnt vmcnt(14) lgkmcnt(3)
    v_mfma_f32_32x32x16_bf16 v[8:23], v[88:91], v[140:143], v[8:23]
    buffer_load_dwordx4 v[136:139], v2, s[4:7], s34 offen offset:2048 sc1
    ds_read_b128 v[80:83], v3 offset:2048
    v_mfma_f32_32x32x16_bf16 v[24:39], v[92:95], v[140:143], v[24:39]
    ds_read_b128 v[84:87], v3 offset:3072
    s_waitcnt vmcnt(14) lgkmcnt(2)
    v_mfma_f32_32x32x16_bf16 v[8:23], v[72:75], v[144:147], v[8:23]
    buffer_load_dwordx4 v[140:143], v2, s[4:7], s34 offen offset:3072 sc1
    s_add_u32 s34, s34, 4096
    ds_read_b128 v[88:91], v3 offset:4096
    v_mfma_f32_32x32x16_bf16 v[24:39], v[76:79], v[144:147], v[24:39]
    ds_read_b128 v[92:95], v3 offset:5120
    s_waitcnt vmcnt(14) lgkmcnt(2)
    v_mfma_f32_32x32x16_bf16 v[8:23], v[80:83], v[148:151], v[8:23]
    buffer_load_dwordx4 v[144:147], v2, s[4:7], s34 offen offset:0 sc1
    ds_read_b128 v[72:75], v3 offset:6144
    v_mfma_f32_32x32x16_bf16 v[24:39], v[84:87], v[148:151], v[24:39]
    ds_read_b128 v[76:79], v3 offset:7168
    ds_read_b32 v161, v160 offset:0
    s_waitcnt vmcnt(14) lgkmcnt(3)
    v_mfma_f32_32x32x16_bf16 v[8:23], v[88:91], v[152:155], v[8:23]
    buffer_load_dwordx4 v[148:151], v2, s[4:7], s34 offen offset:1024 sc1
    ds_read_b128 v[80:83], v3 offset:8192
    v_mfma_f32_32x32x16_bf16 v[24:39], v[92:95], v[152:155], v[24:39]
    ds_read_b128 v[84:87], v3 offset:9216
    s_waitcnt vmcnt(14) lgkmcnt(3)
    v_mfma_f32_32x32x16_bf16 v[8:23], v[72:75], v[156:159], v[8:23]
    buffer_load_dwordx4 v[152:155], v2, s[4:7], s34 offen offset:2048 sc1
    ds_read_b128 v[88:91], v3 offset:10240
    v_mfma_f32_32x32x16_bf16 v[24:39], v[76:79], v[156:159], v[24:39]
    ds_read_b128 v[92:95], v3 offset:11264
    s_waitcnt vmcnt(14) lgkmcnt(2)
    v_mfma_f32_32x32x16_bf16 v[8:23], v[80:83], v[96:99], v[8:23]
    buffer_load_dwordx4 v[156:159], v2, s[4:7], s34 offen offset:3072 sc1
    s_add_u32 s34, s34, 4096
    v_readfirstlane_b32 s28, v161
    s_nop 0
    s_cmp_gt_u32 s28, 11
    s_cbranch_scc1 p3_have11
    v_mov_b32 v162, 160812
    s_mov_b32 s63, 2097152
lw_l11:
    ds_read_b32 v163, v162
    s_waitcnt lgkmcnt(0)
    v_readfirstlane_b32 s28, v163
    s_nop 0
    s_cmp_ge_u32 s28, 12
    s_cbranch_scc1 lw_l11_ok
    s_sleep 1
    s_sub_u32 s63, s63, 1
    s_cbranch_scc0 lw_l11
lw_l11_ok:
p3_have11:
    v_add_u32 v3, 74752, v3
    ds_read_b128 v[72:75], v3 offset:0
    v_mfma_f32_32x32x16_bf16 v[24:39], v[84:87], v[96:99], v[24:39]
    ds_read_b128 v[76:79], v3 offset:1024
    s_waitcnt vmcnt(14) lgkmcnt(2)
    v_mfma_f32_32x32x16_bf16 v[8:23], v[88:91], v[100:103], v[8:23]
    buffer_load_dwordx4 v[96:99], v2, s[4:7], s34 offen offset:0 sc1
    ds_read_b128 v[80:83], v3 offset:2048
    v_mfma_f32_32x32x16_bf16 v[24:39], v[92:95], v[100:103], v[24:39]
    ds_read_b128 v[84:87], v3 offset:3072
    s_waitcnt vmcnt(14) lgkmcnt(2)
    v_mfma_f32_32x32x16_bf16 v[8:23], v[72:75], v[104:107], v[8:23]
    buffer_load_dwordx4 v[100:103], v2, s[4:7], s34 offen offset:1024 sc1
    ds_read_b128 v[88:91], v3 offset:4096
    v_mfma_f32_32x32x16_bf16 v[24:39], v[76:79], v[104:107], v[24:39]
    ds_read_b128 v[92:95], v3 offset:5120
    s_waitcnt vmcnt(14) lgkmcnt(2)
    v_mfma_f32_32x32x16_bf16 v[8:23], v[80:83], v[108:111], v[8:23]
    buffer_load_dwordx4 v[104:107], v2, s[4:7], s34 offen offset:2048 sc1
    ds_read_b128 v[72:75], v3 offset:6144
    v_mfma_f32_32x32x16_bf16 v[24:39], v[84:87], v[108:111], v[24:39]
    ds_read_b128 v[76:79], v3 offset:7168
    ds_read_b32 v161, v160 offset:16
    s_waitcnt vmcnt(14) lgkmcnt(3)
    v_mfma_f32_32x32x16_bf16 v[8:23], v[88:91], v[112:115], v[8:23]
    buffer_load_dwordx4 v[108:111], v2, s[4:7], s34 offen offset:3072 sc1
    s_add_u32 s34, s34, 4096
    ds_read_b128 v[80:83], v3 offset:8192
    v_mfma_f32_32x32x16_bf16 v[24:39], v[92:95], v[112:115], v[24:39]
    ds_read_b128 v[84:87], v3 offset:9216
    s_waitcnt vmcnt(14) lgkmcnt(3)
    v_mfma_f32_32x32x16_bf16 v[8:23], v[72:75], v[116:119], v[8:23]
    buffer_load_dwordx4 v[112:115], v2, s[4:7], s34 offen offset:0 sc1
    ds_read_b128 v[88:91], v3 offset:10240
    v_mfma_f32_32x32x16_bf16 v[24:39], v[76:79], v[116:119], v[24:39]
    ds_read_b128 v[92:95], v3 offset:11264
    s_waitcnt vmcnt(14) lgkmcnt(2)
    v_mfma_f32_32x32x16_bf16 v[8:23], v[80:83], v[120:123], v[8:23]
    buffer_load_dwordx4 v[116:119], v2, s[4:7], s34 offen offset:1024 sc1
    v_readfirstlane_b32 s28, v161
    s_nop 0
    s_cmp_gt_u32 s28, 12
    s_cbranch_scc1 p3_have12
    v_mov_b32 v162, 160828
    s_mov_b32 s63, 2097152
lw_l12:
    ds_read_b32 v163, v162
    s_waitcnt lgkmcnt(0)
    v_readfirstlane_b32 s28, v163
    s_nop 0
    s_cmp_ge_u32 s28, 13
    s_cbranch_scc1 lw_l12_ok
    s_sleep 1
    s_sub_u32 s63, s63, 1
    s_cbranch_scc0 lw_l12
lw_l12_ok:
p3_have12:
    v_add_u32 v3, 4294831104, v3
    ds_read_b128 v[72:75], v3 offset:0
    v_mfma_f32_32x32x16_bf16 v[24:39], v[84:87], v[120:123], v[24:39]
    ds_read_b128 v[76:79], v3 offset:1024
    s_waitcnt vmcnt(14) lgkmcnt(2)
    v_mfma_f32_32x32x16_bf16 v[8:23], v[88:91], v[124:127], v[8:23]
    buffer_load_dwordx4 v[120:123], v2, s[4:7], s34 offen offset:2048 sc1
    ds_read_b128 v[80:83], v3 offset:2048
    v_mfma_f32_32x32x16_bf16 v[24:39], v[92:95], v[124:127], v[24:39]
    ds_read_b128 v[84:87], v3 offset:3072
    s_waitcnt vmcnt(14) lgkmcnt(2)
    v_mfma_f32_32x32x16_bf16 v[40:55], v[72:75], v[128:131], 0
    buffer_load_dwordx4 v[124:127], v2, s[4:7], s34 offen offset:3072 sc1
    s_add_u32 s34, s34, 4096
    ds_read_b128 v[88:91], v3 offset:4096
    v_mfma_f32_32x32x16_bf16 v[56:71], v[76:79], v[128:131], 0
    ds_read_b128 v[92:95], v3 offset:5120
    s_waitcnt vmcnt(14) lgkmcnt(2)
    v_mfma_f32_32x32x16_bf16 v[40:55], v[80:83], v[132:135], v[40:55]
    buffer_load_dwordx4 v[128:131], v2, s[4:7], s34 offen offset:0 sc1
    ds_read_b128 v[72:75], v3 offset:6144
    v_mfma_f32_32x32x16_bf16 v[56:71], v[84:87], v[132:135], v[56:71]
    ds_read_b128 v[76:79], v3 offset:7168
    ds_read_b32 v161, v160 offset:16
    s_waitcnt vmcnt(14) lgkmcnt(3)
    v_mfma_f32_32x32x16_bf16 v[40:55], v[88:91], v[136:139], v[40:55]
    buffer_load_dwordx4 v[132:135], v2, s[4:7], s34 offen offset:1024 sc1
    ds_read_b128 v[80:83], v3 offset:8192
    v_mfma_f32_32x32x16_bf16 v[56:71], v[92:95], v[136:139], v[56:71]
    ds_read_b128 v[84:87], v3 offset:9216
    s_waitcnt vmcnt(14) lgkmcnt(3)
    v_mfma_f32_32x32x16_bf16 v[40:55], v[72:75], v[140:143], v[40:55]
    buffer_load_dwordx4 v[136:139], v2, s[4:7], s34 offen offset:2048 sc1
    ds_read_b128 v[88:91], v3 offset:10240
    v_mfma_f32_32x32x16_bf16 v[56:71], v[76:79], v[140:143], v[56:71]
    ds_read_b128 v[92:95], v3 offset:11264
    s_waitcnt vmcnt(14) lgkmcnt(2)
    v_mfma_f32_32x32x16_bf16 v[40:55], v[80:83], v[144:147], v[40:55]
    buffer_load_dwordx4 v[140:143], v2, s[4:7], s34 offen offset:3072 sc1
    s_add_u32 s34, s34, 4096
    v_readfirstlane_b32 s28, v161
    s_nop 0
    s_cmp_gt_u32 s28, 13
    s_cbranch_scc1 p3_have13
    v_mov_b32 v162, 160828
    s_mov_b32 s63, 2097152
lw_l13:
    ds_read_b32 v163, v162
    s_waitcnt lgkmcnt(0)
    v_readfirstlane_b32 s28, v163
    s_nop 0
    s_cmp_ge_u32 s28, 14
    s_cbranch_scc1 lw_l13_ok
    s_sleep 1
    s_sub_u32 s63, s63, 1
    s_cbranch_scc0 lw_l13
lw_l13_ok:
p3_have13:
    ds_read_b128 v[72:75], v3 offset:12288
    v_mfma_f32_32x32x16_bf16 v[56:71], v[84:87], v[144:147], v[56:71]
    ds_read_b128 v[76:79], v3 offset:13312
    s_waitcnt vmcnt(14) lgkmcnt(2)
    v_mfma_f32_32x32x16_bf16 v[40:55], v[88:91], v[148:151], v[40:55]
    buffer_load_dwordx4 v[144:147], v2, s[4:7], s34 offen offset:0 sc1
    ds_read_b128 v[80:83], v3 offset:14336
    v_mfma_f32_32x32x16_bf16 v[56:71], v[92:95], v[148:151], v[56:71]
    ds_read_b128 v[84:87], v3 offset:15360
    s_waitcnt vmcnt(14) lgkmcnt(2)
    v_mfma_f32_32x32x16_bf16 v[40:55], v[72:75], v[152:155], v[40:55]
    buffer_load_dwordx4 v[148:151], v2, s[4:7], s34 offen offset:1024 sc1
    ds_read_b128 v[88:91], v3 offset:16384
    v_mfma_f32_32x32x16_bf16 v[56:71], v[76:79], v[152:155], v[56:71]
    ds_read_b128 v[92:95], v3 offset:17408
    s_waitcnt vmcnt(14) lgkmcnt(2)
    v_mfma_f32_32x32x16_bf16 v[40:55], v[80:83], v[156:159], v[40:55]
    buffer_load_dwordx4 v[152:155], v2, s[4:7], s34 offen offset:2048 sc1
    ds_read_b128 v[72:75], v3 offset:18432
    v_mfma_f32_32x32x16_bf16 v[56:71], v[84:87], v[156:159], v[56:71]
    ds_read_b128 v[76:79], v3 offset:19456
    ds_read_b32 v161, v160 offset:16
    s_waitcnt vmcnt(14) lgkmcnt(3)
    v_mfma_f32_32x32x16_bf16 v[40:55], v[88:91], v[96:99], v[40:55]
    buffer_load_dwordx4 v[156:159], v2, s[4:7], s34 offen offset:3072 sc1
    s_add_u32 s34, s34, 4096
    ds_read_b128 v[80:83], v3 offset:20480
    v_mfma_f32_32x32x16_bf16 v[56:71], v[92:95], v[96:99], v[56:71]
    ds_read_b128 v[84:87], v3 offset:21504
    s_waitcnt vmcnt(14) lgkmcnt(3)
    v_mfma_f32_32x32x16_bf16 v[40:55], v[72:75], v[100:103], v[40:55]
    buffer_load_dwordx4 v[96:99], v2, s[4:7], s34 offen offset:0 sc1
    ds_read_b128 v[88:91], v3 offset:22528
    v_mfma_f32_32x32x16_bf16 v[56:71], v[76:79], v[100:103], v[56:71]
    ds_read_b128 v[92:95], v3 offset:23552
    s_waitcnt vmcnt(14) lgkmcnt(2)
    v_mfma_f32_32x32x16_bf16 v[40:55], v[80:83], v[104:107], v[40:55]
    buffer_load_dwordx4 v[100:103], v2, s[4:7], s34 offen offset:1024 sc1
    v_readfirstlane_b32 s28, v161
    s_nop 0
    s_cmp_gt_u32 s28, 14
    s_cbranch_scc1 p3_have14
    v_mov_b32 v162, 160828
    s_mov_b32 s63, 2097152
lw_l14:
    ds_read_b32 v163, v162
    s_waitcnt lgkmcnt(0)
    v_readfirstlane_b32 s28, v163
    s_nop 0
    s_cmp_ge_u32 s28, 15
    s_cbranch_scc1 lw_l14_ok
    s_sleep 1
    s_sub_u32 s63, s63, 1
    s_cbranch_scc0 lw_l14
lw_l14_ok:
p3_have14:
    ds_read_b128 v[72:75], v3 offset:24576
    v_mfma_f32_32x32x16_bf16 v[56:71], v[84:87], v[104:107], v[56:71]
    ds_read_b128 v[76:79], v3 offset:25600
    s_waitcnt vmcnt(14) lgkmcnt(2)
    v_mfma_f32_32x32x16_bf16 v[40:55], v[88:91], v[108:111], v[40:55]
    buffer_load_dwordx4 v[104:107], v2, s[4:7], s34 offen offset:2048 sc1
    ds_read_b128 v[80:83], v3 offset:26624
    v_mfma_f32_32x32x16_bf16 v[56:71], v[92:95], v[108:111], v[56:71]
    ds_read_b128 v[84:87], v3 offset:27648
    s_waitcnt vmcnt(14) lgkmcnt(2)
    v_mfma_f32_32x32x16_bf16 v[40:55], v[72:75], v[112:115], v[40:55]
    buffer_load_dwordx4 v[108:111], v2, s[4:7], s34 offen offset:3072 sc1
    s_add_u32 s34, s34, 4096
    ds_read_b128 v[88:91], v3 offset:28672
    v_mfma_f32_32x32x16_bf16 v[56:71], v[76:79], v[112:115], v[56:71]
    ds_read_b128 v[92:95], v3 offset:29696
    s_waitcnt vmcnt(14) lgkmcnt(2)
    v_mfma_f32_32x32x16_bf16 v[40:55], v[80:83], v[116:119], v[40:55]
    buffer_load_dwordx4 v[112:115], v2, s[4:7], s34 offen offset:0 sc1
    ds_read_b128 v[72:75], v3 offset:30720
    v_mfma_f32_32x32x16_bf16 v[56:71], v[84:87], v[116:119], v[56:71]
    ds_read_b128 v[76:79], v3 offset:31744
    ds_read_b32 v161, v160 offset:16
    s_waitcnt vmcnt(14) lgkmcnt(3)
    v_mfma_f32_32x32x16_bf16 v[40:55], v[88:91], v[120:123], v[40:55]
    buffer_load_dwordx4 v[116:119], v2, s[4:7], s34 offen offset:1024 sc1
    ds_read_b128 v[80:83], v3 offset:32768
    v_mfma_f32_32x32x16_bf16 v[56:71], v[92:95], v[120:123], v[56:71]
    ds_read_b128 v[84:87], v3 offset:33792
    s_waitcnt vmcnt(14) lgkmcnt(3)
    v_mfma_f32_32x32x16_bf16 v[40:55], v[72:75], v[124:127], v[40:55]
    buffer_load_dwordx4 v[120:123], v2, s[4:7], s34 offen offset:2048 sc1
    ds_read_b128 v[88:91], v3 offset:34816
    v_mfma_f32_32x32x16_bf16 v[56:71], v[76:79], v[124:127], v[56:71]
    ds_read_b128 v[92:95], v3 offset:35840
    s_waitcnt vmcnt(14) lgkmcnt(2)
    v_mfma_f32_32x32x16_bf16 v[40:55], v[80:83], v[128:131], v[40:55]
    buffer_load_dwordx4 v[124:127], v2, s[4:7], s34 offen offset:3072 sc1
    s_add_u32 s34, s34, 4096
    v_readfirstlane_b32 s28, v161
    s_nop 0
    s_cmp_gt_u32 s28, 15
    s_cbranch_scc1 p3_have15
    v_mov_b32 v162, 160828
    s_mov_b32 s63, 2097152
lw_l15:
    ds_read_b32 v163, v162
    s_waitcnt lgkmcnt(0)
    v_readfirstlane_b32 s28, v163
    s_nop 0
    s_cmp_ge_u32 s28, 16
    s_cbranch_scc1 lw_l15_ok
    s_sleep 1
    s_sub_u32 s63, s63, 1
    s_cbranch_scc0 lw_l15
lw_l15_ok:
p3_have15:
    ds_read_b128 v[72:75], v3 offset:36864
    v_mfma_f32_32x32x16_bf16 v[56:71], v[84:87], v[128:131], v[56:71]
    ds_read_b128 v[76:79], v3 offset:37888
    s_waitcnt vmcnt(14) lgkmcnt(2)
    v_mfma_f32_32x32x16_bf16 v[40:55], v[88:91], v[132:135], v[40:55]
    buffer_load_dwordx4 v[128:131], v2, s[4:7], s34 offen offset:0 sc1
    ds_read_b128 v[80:83], v3 offset:38912
    v_mfma_f32_32x32x16_bf16 v[56:71], v[92:95], v[132:135], v[56:71]
    ds_read_b128 v[84:87], v3 offset:39936
    s_waitcnt vmcnt(14) lgkmcnt(2)
    v_mfma_f32_32x32x16_bf16 v[40:55], v[72:75], v[136:139], v[40:55]
    buffer_load_dwordx4 v[132:135], v2, s[4:7], s34 offen offset:1024 sc1
    ds_read_b128 v[88:91], v3 offset:40960
    v_mfma_f32_32x32x16_bf16 v[56:71], v[76:79], v[136:139], v[56:71]
    ds_read_b128 v[92:95], v3 offset:41984
    s_waitcnt vmcnt(14) lgkmcnt(2)
    v_mfma_f32_32x32x16_bf16 v[40:55], v[80:83], v[140:143], v[40:55]
    buffer_load_dwordx4 v[136:139], v2, s[4:7], s34 offen offset:2048 sc1
    ds_read_b128 v[72:75], v3 offset:43008
    v_mfma_f32_32x32x16_bf16 v[56:71], v[84:87], v[140:143], v[56:71]
    ds_read_b128 v[76:79], v3 offset:44032
    ds_read_b32 v161, v160 offset:16
    s_waitcnt vmcnt(14) lgkmcnt(3)
    v_mfma_f32_32x32x16_bf16 v[40:55], v[88:91], v[144:147], v[40:55]
    buffer_load_dwordx4 v[140:143], v2, s[4:7], s34 offen offset:3072 sc1
    s_add_u32 s34, s34, 4096
    ds_read_b128 v[80:83], v3 offset:45056
    v_mfma_f32_32x32x16_bf16 v[56:71], v[92:95], v[144:147], v[56:71]
    ds_read_b128 v[84:87], v3 offset:46080
    s_waitcnt vmcnt(14) lgkmcnt(3)
    v_mfma_f32_32x32x16_bf16 v[40:55], v[72:75], v[148:151], v[40:55]
    buffer_load_dwordx4 v[144:147], v7, s[4:7], s31 offen offset:0 sc1
    ds_read_b128 v[88:91], v3 offset:47104
    v_mfma_f32_32x32x16_bf16 v[56:71], v[76:79], v[148:151], v[56:71]
    ds_read_b128 v[92:95], v3 offset:48128
    s_waitcnt vmcnt(14) lgkmcnt(2)
    v_mfma_f32_32x32x16_bf16 v[40:55], v[80:83], v[152:155], v[40:55]
    buffer_load_dwordx4 v[148:151], v7, s[4:7], s31 offen offset:32 sc1
    v_readfirstlane_b32 s28, v161
    s_nop 0
    s_cmp_gt_u32 s28, 16
    s_cbranch_scc1 p3_have16
    v_mov_b32 v162, 160828
    s_mov_b32 s63, 2097152
lw_l16:
    ds_read_b32 v163, v162
    s_waitcnt lgkmcnt(0)
    v_readfirstlane_b32 s28, v163
    s_nop 0
    s_cmp_ge_u32 s28, 17
    s_cbranch_scc1 lw_l16_ok
    s_sleep 1
    s_sub_u32 s63, s63, 1
    s_cbranch_scc0 lw_l16
lw_l16_ok:
p3_have16:
    v_add_u32 v3, 74752, v3
    ds_read_b128 v[72:75], v3 offset:0
    v_mfma_f32_32x32x16_bf16 v[56:71], v[84:87], v[152:155], v[56:71]
    ds_read_b128 v[76:79], v3 offset:1024
    s_waitcnt vmcnt(14) lgkmcnt(2)
    v_mfma_f32_32x32x16_bf16 v[40:55], v[88:91], v[156:159], v[40:55]
    buffer_load_dwordx4 v[152:155], v7, s[4:7], s31 offen offset:64 sc1
    ds_read_b128 v[80:83], v3 offset:2048
    v_mfma_f32_32x32x16_bf16 v[56:71], v[92:95], v[156:159], v[56:71]
    ds_read_b128 v[84:87], v3 offset:3072
    s_waitcnt vmcnt(14) lgkmcnt(2)
    v_mfma_f32_32x32x16_bf16 v[40:55], v[72:75], v[96:99], v[40:55]
    buffer_load_dwordx4 v[156:159], v7, s[4:7], s31 offen offset:96 sc1
    ds_read_b128 v[88:91], v3 offset:4096
    v_mfma_f32_32x32x16_bf16 v[56:71], v[76:79], v[96:99], v[56:71]
    ds_read_b128 v[92:95], v3 offset:5120
    s_waitcnt vmcnt(14) lgkmcnt(2)
    v_mfma_f32_32x32x16_bf16 v[40:55], v[80:83], v[100:103], v[40:55]
    buffer_load_dwordx4 v[96:99], v7, s[4:7], s31 offen offset:128 sc1
    ds_read_b128 v[72:75], v3 offset:6144
    v_mfma_f32_32x32x16_bf16 v[56:71], v[84:87], v[100:103], v[56:71]
    ds_read_b128 v[76:79], v3 offset:7168
    ds_read_b32 v161, v160 offset:16
    s_waitcnt vmcnt(14) lgkmcnt(3)
    v_mfma_f32_32x32x16_bf16 v[40:55], v[88:91], v[104:107], v[40:55]
    buffer_load_dwordx4 v[100:103], v7, s[4:7], s31 offen offset:160 sc1
    ds_read_b128 v[80:83], v3 offset:8192
    v_mfma_f32_32x32x16_bf16 v[56:71], v[92:95], v[104:107], v[56:71]
    ds_read_b128 v[84:87], v3 offset:9216
    s_waitcnt vmcnt(14) lgkmcnt(3)
    v_mfma_f32_32x32x16_bf16 v[40:55], v[72:75], v[108:111], v[40:55]
    buffer_load_dwordx4 v[104:107], v7, s[4:7], s31 offen offset:192 sc1
    ds_read_b128 v[88:91], v3 offset:10240
    v_mfma_f32_32x32x16_bf16 v[56:71], v[76:79], v[108:111], v[56:71]
    ds_read_b128 v[92:95], v3 offset:11264
    s_waitcnt vmcnt(14) lgkmcnt(2)
    v_mfma_f32_32x32x16_bf16 v[40:55], v[80:83], v[112:115], v[40:55]
    buffer_load_dwordx4 v[108:111], v7, s[4:7], s31 offen offset:224 sc1
    v_readfirstlane_b32 s28, v161
    s_nop 0
    s_cmp_gt_u32 s28, 17
    s_cbranch_scc1 p3_have17
    v_mov_b32 v162, 160828
    s_mov_b32 s63, 2097152
lw_l17:
    ds_read_b32 v163, v162
    s_waitcnt lgkmcnt(0)
    v_readfirstlane_b32 s28, v163
    s_nop 0
    s_cmp_ge_u32 s28, 18
    s_cbranch_scc1 lw_l17_ok
    s_sleep 1
    s_sub_u32 s63, s63, 1
    s_cbranch_scc0 lw_l17
lw_l17_ok:
p3_have17:
    ds_read_b128 v[72:75], v3 offset:12288
    v_mfma_f32_32x32x16_bf16 v[56:71], v[84:87], v[112:115], v[56:71]
    ds_read_b128 v[76:79], v3 offset:13312
    s_waitcnt vmcnt(14) lgkmcnt(2)
    v_mfma_f32_32x32x16_bf16 v[40:55], v[88:91], v[116:119], v[40:55]
    ds_read_b128 v[80:83], v3 offset:14336
    v_mfma_f32_32x32x16_bf16 v[56:71], v[92:95], v[116:119], v[56:71]
    ds_read_b128 v[84:87], v3 offset:15360
    s_waitcnt vmcnt(13) lgkmcnt(2)
    v_mfma_f32_32x32x16_bf16 v[40:55], v[72:75], v[120:123], v[40:55]
    v_and_b32 v5, 31, v1
    v_lshlrev_b32 v5, 2, v5
    v_lshl_add_u32 v5, v7, 5, v5
    v_add_u32 v5, 91136, v5
    v_add_u32 v6, 1024, v5
    ds_read2_b32 v[88:89], v5 offset0:0 offset1:32
    ds_read2_b32 v[90:91], v5 offset0:64 offset1:96
    v_mfma_f32_32x32x16_bf16 v[56:71], v[76:79], v[120:123], v[56:71]
    ds_read2_b32 v[92:93], v6 offset0:0 offset1:32
    ds_read2_b32 v[94:95], v6 offset0:64 offset1:96
    s_waitcnt vmcnt(12) lgkmcnt(4)
    v_mfma_f32_32x32x16_bf16 v[40:55], v[80:83], v[124:127], v[40:55]
    v_add_u32 v5, 2048, v5
    v_add_u32 v6, 1024, v5
    ds_read2_b32 v[72:73], v5 offset0:0 offset1:32
    ds_read2_b32 v[74:75], v5 offset0:64 offset1:96
    v_mfma_f32_32x32x16_bf16 v[56:71], v[84:87], v[124:127], v[56:71]
    ds_read2_b32 v[76:77], v6 offset0:0 offset1:32
    ds_read2_b32 v[78:79], v6 offset0:64 offset1:96
    s_waitcnt vmcnt(11) lgkmcnt(4)
    v_mfma_f32_32x32x16_bf16 v[40:55], v[88:91], v[128:131], v[40:55]
    v_add_u32 v5, 2048, v5
    v_add_u32 v6, 1024, v5
    ds_read2_b32 v[80:81], v5 offset0:0 offset1:32
    ds_read2_b32 v[82:83], v5 offset0:64 offset1:96
    v_mfma_f32_32x32x16_bf16 v[56:71], v[92:95], v[128:131], v[56:71]
    ds_read2_b32 v[84:85], v6 offset0:0 offset1:32
    ds_read2_b32 v[86:87], v6 offset0:64 offset1:96
    s_waitcnt vmcnt(10) lgkmcnt(4)
    v_mfma_f32_32x32x16_bf16 v[40:55], v[72:75], v[132:135], v[40:55]
    v_add_u32 v5, 2048, v5
    v_add_u32 v6, 1024, v5
    ds_read2_b32 v[88:89], v5 offset0:0 offset1:32
    ds_read2_b32 v[90:91], v5 offset0:64 offset1:96
    v_mfma_f32_32x32x16_bf16 v[56:71], v[76:79], v[132:135], v[56:71]
    ds_read2_b32 v[92:93], v6 offset0:0 offset1:32
    ds_read2_b32 v[94:95], v6 offset0:64 offset1:96
    s_waitcnt vmcnt(9) lgkmcnt(4)
    v_mfma_f32_32x32x16_bf16 v[40:55], v[80:83], v[136:139], v[40:55]
    v_mfma_f32_32x32x16_bf16 v[56:71], v[84:87], v[136:139], v[56:71]
    s_waitcnt vmcnt(8) lgkmcnt(0)
    v_mfma_f32_32x32x16_bf16 v[40:55], v[88:91], v[140:143], v[40:55]
    v_mfma_f32_32x32x16_bf16 v[56:71], v[92:95], v[140:143], v[56:71]
    s_mov_b32 s40, 2304
    s_mov_b32 s41, 4608
    s_mov_b32 s42, 6912
    s_mov_b32 s43, 18432
    s_mov_b32 s44, 20736
    s_mov_b32 s45, 23040
    s_mov_b32 s46, 25344
    s_mov_b32 s47, 36864
    s_mov_b32 s48, 39168
    s_mov_b32 s49, 41472
    s_mov_b32 s50, 43776
    s_mov_b32 s51, 55296
    s_mov_b32 s52, 57600
    s_mov_b32 s53, 59904
    s_mov_b32 s54, 62208
    v_add_u32 v5, 73728, v4
    s_waitcnt vmcnt(0)
    v_pk_add_f32 v[40:41], v[40:41], v[8:9] neg_lo:[0,1] neg_hi:[0,1]
    v_pk_fma_f32 v[40:41], v[40:41], v[144:145], v[8:9]
    buffer_store_dword v40, v4, s[64:67], 0 offen sc1
    buffer_store_dword v41, v4, s[64:67], s40 offen sc1
    v_pk_add_f32 v[42:43], v[42:43], v[10:11] neg_lo:[0,1] neg_hi:[0,1]
    v_pk_fma_f32 v[42:43], v[42:43], v[146:147], v[10:11]
    buffer_store_dword v42, v4, s[64:67], s41 offen sc1
    buffer_store_dword v43, v4, s[64:67], s42 offen sc1
    v_pk_add_f32 v[44:45], v[44:45], v[12:13] neg_lo:[0,1] neg_hi:[0,1]
    v_pk_fma_f32 v[44:45], v[44:45], v[148:149], v[12:13]
    buffer_store_dword v44, v4, s[64:67], s43 offen sc1
    buffer_store_dword v45, v4, s[64:67], s44 offen sc1
    v_pk_add_f32 v[46:47], v[46:47], v[14:15] neg_lo:[0,1] neg_hi:[0,1]
    v_pk_fma_f32 v[46:47], v[46:47], v[150:151], v[14:15]
    buffer_store_dword v46, v4, s[64:67], s45 offen sc1
    buffer_store_dword v47, v4, s[64:67], s46 offen sc1
    v_pk_add_f32 v[48:49], v[48:49], v[16:17] neg_lo:[0,1] neg_hi:[0,1]
    v_pk_fma_f32 v[48:49], v[48:49], v[152:153], v[16:17]
    buffer_store_dword v48, v4, s[64:67], s47 offen sc1
    buffer_store_dword v49, v4, s[64:67], s48 offen sc1
    v_pk_add_f32 v[50:51], v[50:51], v[18:19] neg_lo:[0,1] neg_hi:[0,1]
    v_pk_fma_f32 v[50:51], v[50:51], v[154:155], v[18:19]
    buffer_store_dword v50, v4, s[64:67], s49 offen sc1
    buffer_store_dword v51, v4, s[64:67], s50 offen sc1
    v_pk_add_f32 v[52:53], v[52:53], v[20:21] neg_lo:[0,1] neg_hi:[0,1]
    v_pk_fma_f32 v[52:53], v[52:53], v[156:157], v[20:21]
    buffer_store_dword v52, v4, s[64:67], s51 offen sc1
    buffer_store_dword v53, v4, s[64:67], s52 offen sc1
    v_pk_add_f32 v[54:55], v[54:55], v[22:23] neg_lo:[0,1] neg_hi:[0,1]
    v_pk_fma_f32 v[54:55], v[54:55], v[158:159], v[22:23]
    buffer_store_dword v54, v4, s[64:67], s53 offen sc1
    buffer_store_dword v55, v4, s[64:67], s54 offen sc1
    v_pk_add_f32 v[56:57], v[56:57], v[24:25] neg_lo:[0,1] neg_hi:[0,1]
    v_pk_fma_f32 v[56:57], v[56:57], v[96:97], v[24:25]
    buffer_store_dword v56, v5, s[64:67], 0 offen sc1
    buffer_store_dword v57, v5, s[64:67], s40 offen sc1
    v_pk_add_f32 v[58:59], v[58:59], v[26:27] neg_lo:[0,1] neg_hi:[0,1]
    v_pk_fma_f32 v[58:59], v[58:59], v[98:99], v[26:27]
    buffer_store_dword v58, v5, s[64:67], s41 offen sc1
    buffer_store_dword v59, v5, s[64:67], s42 offen sc1
    v_pk_add_f32 v[60:61], v[60:61], v[28:29] neg_lo:[0,1] neg_hi:[0,1]
    v_pk_fma_f32 v[60:61], v[60:61], v[100:101], v[28:29]
    buffer_store_dword v60, v5, s[64:67], s43 offen sc1
    buffer_store_dword v61, v5, s[64:67], s44 offen sc1
    v_pk_add_f32 v[62:63], v[62:63], v[30:31] neg_lo:[0,1] neg_hi:[0,1]
    v_pk_fma_f32 v[62:63], v[62:63], v[102:103], v[30:31]
    buffer_store_dword v62, v5, s[64:67], s45 offen sc1
    buffer_store_dword v63, v5, s[64:67], s46 offen sc1
    v_pk_add_f32 v[64:65], v[64:65], v[32:33] neg_lo:[0,1] neg_hi:[0,1]
    v_pk_fma_f32 v[64:65], v[64:65], v[104:105], v[32:33]
    buffer_store_dword v64, v5, s[64:67], s47 offen sc1
    buffer_store_dword v65, v5, s[64:67], s48 offen sc1
    v_pk_add_f32 v[66:67], v[66:67], v[34:35] neg_lo:[0,1] neg_hi:[0,1]
    v_pk_fma_f32 v[66:67], v[66:67], v[106:107], v[34:35]
    buffer_store_dword v66, v5, s[64:67], s49 offen sc1
    buffer_store_dword v67, v5, s[64:67], s50 offen sc1
    v_pk_add_f32 v[68:69], v[68:69], v[36:37] neg_lo:[0,1] neg_hi:[0,1]
    v_pk_fma_f32 v[68:69], v[68:69], v[108:109], v[36:37]
    buffer_store_dword v68, v5, s[64:67], s51 offen sc1
    buffer_store_dword v69, v5, s[64:67], s52 offen sc1
    v_pk_add_f32 v[70:71], v[70:71], v[38:39] neg_lo:[0,1] neg_hi:[0,1]
    v_pk_fma_f32 v[70:71], v[70:71], v[110:111], v[38:39]
    buffer_store_dword v70, v5, s[64:67], s53 offen sc1
    buffer_store_dword v71, v5, s[64:67], s54 offen sc1
the_end:
    s_endpgm
.section .rodata,"a"
.p2align 6
.amdhsa_kernel gated_mix__mha_block__ssm_conv_s5__prompt_kernel
  .amdhsa_next_free_vgpr 168
  .amdhsa_next_free_sgpr 68
  .amdhsa_accum_offset 168
  .amdhsa_group_segment_fixed_size 0
  .amdhsa_kernarg_size 128
  .amdhsa_user_sgpr_count 2
  .amdhsa_user_sgpr_kernarg_segment_ptr 1
  .amdhsa_system_sgpr_workgroup_id_x 1
.end_amdhsa_kernel
.text
```
